```python
import torch

def _softmax(x, axis=-1):
    return torch.softmax(x, dim=axis)

def _gelu(x):
    return torch.nn.functional.gelu(x, approximate='tanh')

def _silu(x):
    return torch.nn.functional.silu(x)

def _sigmoid(x):
    return torch.sigmoid(x)

def _layernorm(x, axis=-1, eps=1e-05):
    m = x.mean(dim=axis, keepdim=True)
    v = x.var(dim=axis, keepdim=True, unbiased=False)
    return (x - m) / torch.sqrt(v + eps)

def _scatter_add(tgt, idx, src, axis=0):
    return tgt.clone().index_add_(axis, idx, src)

def _segment_sum(src, seg, n):
    out = torch.zeros((n,) + src.shape[1:], dtype=src.dtype)
    return out.index_add_(0, seg, src)

def _pad(x, pw):
    flat = tuple((v for pair in reversed(pw) for v in pair))
    return torch.nn.functional.pad(x, flat)
kernel_name = 'sequential_preLN__linear_attn_block__mixer_gmlp__prompt'

def setup_inputs():

    _w = lambda a: (lambda t: t.to(torch.bfloat16) if t.is_floating_point() else t)(torch.as_tensor(a))

    def _A_setup():
        B, S, D = (1, 2048, 512)
        return {'x': _w((lambda *s: torch.randn(*s, dtype=torch.bfloat16) * 0.05)(B, S, D)), 'wqkv': _w((lambda *s: torch.randn(*s, dtype=torch.bfloat16) * 0.05)(D, 3 * D)), 'wo': _w((lambda *s: torch.randn(*s, dtype=torch.bfloat16) * 0.05)(D, D))}
    _A_in = _A_setup()

    def _B_setup():
        B, S, D, F = (1, 2048, 512, 1792)
        Fh = F // 2
        return {'x': _w((lambda *s: torch.randn(*s, dtype=torch.bfloat16) * 0.05)(B, S, D)), 'w_in': _w((lambda *s: torch.randn(*s, dtype=torch.bfloat16) * 0.4)(D, 2 * Fh)), 'w_sp': _w(0.01 * (lambda *s: torch.randn(*s, dtype=torch.bfloat16) * 0.4)(S, S)), 'b_sp': _w(1.0 + 0.01 * (lambda *s: torch.randn(*s, dtype=torch.bfloat16) * 0.05)(S)), 'w_out': _w((lambda *s: torch.randn(*s, dtype=torch.bfloat16) * 0.05)(Fh, D))}
    _B_in = _B_setup()
    return {'A_x': _A_in['x'], 'A_wqkv': _A_in['wqkv'], 'A_wo': _A_in['wo'], 'B_x': _B_in['x'], 'B_w_in': _B_in['w_in'], 'B_w_sp': _B_in['w_sp'], 'B_b_sp': _B_in['b_sp'], 'B_w_out': _B_in['w_out']}

def reference(A_x, A_wqkv, A_wo, B_x, B_w_in, B_w_sp, B_b_sp, B_w_out):

    def _A_ref(x, wqkv, wo):
        B, S, D = x.shape
        H = 32
        Dh = D // H
        qkv = (lambda x, *d: x.permute(*d))((x @ wqkv).reshape(B, S, 3, H, Dh), 2, 0, 3, 1, 4)
        q, k, v = (qkv[0], qkv[1], qkv[2])
        phi = lambda t: torch.where(t > 0, t + 1, torch.exp(t)) + 1e-06
        pq, pk = (phi(q), phi(k))
        kv = torch.einsum('bhsd,bhse->bhde', pk, v)
        z = torch.einsum('bhsd->bhd', pk)
        num = torch.einsum('bhqd,bhde->bhqe', pq, kv)
        den = torch.einsum('bhqd,bhd->bhq', pq, z)[..., None] + 1e-06
        o = num / den
        return (lambda x, *d: x.permute(*d))(o, 0, 2, 1, 3).reshape(B, S, D) @ wo

    def _B_ref(x, w_in, w_sp, b_sp, w_out):
        B, S, D = x.shape
        F = w_in.shape[-1]
        Fh = F // 2
        z = _gelu(torch.einsum('bsd,df->bsf', x, w_in))
        z1 = z[..., :Fh].clone()
        z2 = _layernorm(z[..., Fh:], axis=-1)
        g = torch.einsum('ts,bsf->btf', w_sp, z2) + b_sp[None, :, None]
        return torch.einsum('bsf,fd->bsd', z1 * g, w_out)
    x = A_x
    h = x + _A_ref(_layernorm(x, axis=-1), A_wqkv, A_wo)
    h2 = h + _B_ref(_layernorm(h, axis=-1), B_w_in, B_w_sp, B_b_sp, B_w_out)
    return h2
```

```asm
; @launch grid=(256,1,1) block=(512,1,1) lds=163840
.amdgcn_target "amdgcn-amd-amdhsa--gfx950"
.text
.globl sequential_preLN__linear_attn_block__mixer_gmlp__prompt_kernel
.p2align 8
.type sequential_preLN__linear_attn_block__mixer_gmlp__prompt_kernel,@function
sequential_preLN__linear_attn_block__mixer_gmlp__prompt_kernel:
  s_load_dwordx16 s[48:63], s[0:1], 0
  s_load_dwordx4 s[64:67], s[0:1], 64
  s_load_dwordx2 s[68:69], s[0:1], 80
  s_cmp_ge_u32 s2, 256
  s_cbranch_scc1 L_exit
  v_lshrrev_b32 v4, 6, v0
  v_and_b32 v0, 63, v0
  v_readfirstlane_b32 s3, v4
  v_lshlrev_b32 v1, 4, v0
  v_lshrrev_b32 v2, 4, v0
  v_and_b32 v3, 15, v0
  s_and_b32 s4, s2, 7
  s_lshr_b32 s5, s2, 3
  s_lshr_b32 s70, s4, 1
  s_lshl_b32 s70, s70, 3
  s_and_b32 s6, s5, 7
  s_add_u32 s70, s70, s6
  s_and_b32 s71, s4, 1
  s_lshl_b32 s71, s71, 2
  s_lshr_b32 s6, s5, 3
  s_add_u32 s71, s71, s6
  v_lshrrev_b32 v6, 3, v0
  v_and_b32 v7, 7, v0
  v_lshlrev_b32 v8, 10, v6
  v_lshl_add_u32 v8, v7, 4, v8
  v_add_u32 v15, 8192, v8
  s_lshl_b32 s88, s70, 2
  s_and_b32 s6, s3, 3
  s_add_u32 s88, s88, s6
  s_lshl_b32 s88, s88, 14
  s_lshl_b32 s6, s71, 1
  s_add_u32 s6, s6, 0
  s_and_b32 s6, s6, 7
  s_lshl_b32 s7, s6, 7
  s_add_u32 s72, s7, s88
  s_sub_u32 s6, s6, s70
  s_and_b32 s6, s6, 7
  s_lshl_b32 s80, s6, 13
  s_lshl_b32 s6, s71, 1
  s_add_u32 s6, s6, 1
  s_and_b32 s6, s6, 7
  s_lshl_b32 s7, s6, 7
  s_add_u32 s73, s7, s88
  s_sub_u32 s6, s6, s70
  s_and_b32 s6, s6, 7
  s_lshl_b32 s81, s6, 13
  s_lshl_b32 s6, s71, 1
  s_add_u32 s6, s6, 2
  s_and_b32 s6, s6, 7
  s_lshl_b32 s7, s6, 7
  s_add_u32 s74, s7, s88
  s_sub_u32 s6, s6, s70
  s_and_b32 s6, s6, 7
  s_lshl_b32 s82, s6, 13
  s_lshl_b32 s6, s71, 1
  s_add_u32 s6, s6, 3
  s_and_b32 s6, s6, 7
  s_lshl_b32 s7, s6, 7
  s_add_u32 s75, s7, s88
  s_sub_u32 s6, s6, s70
  s_and_b32 s6, s6, 7
  s_lshl_b32 s83, s6, 13
  s_lshl_b32 s6, s71, 1
  s_add_u32 s6, s6, 4
  s_and_b32 s6, s6, 7
  s_lshl_b32 s7, s6, 7
  s_add_u32 s76, s7, s88
  s_sub_u32 s6, s6, s70
  s_and_b32 s6, s6, 7
  s_lshl_b32 s84, s6, 13
  s_lshl_b32 s6, s71, 1
  s_add_u32 s6, s6, 5
  s_and_b32 s6, s6, 7
  s_lshl_b32 s7, s6, 7
  s_add_u32 s77, s7, s88
  s_sub_u32 s6, s6, s70
  s_and_b32 s6, s6, 7
  s_lshl_b32 s85, s6, 13
  s_lshl_b32 s6, s71, 1
  s_add_u32 s6, s6, 6
  s_and_b32 s6, s6, 7
  s_lshl_b32 s7, s6, 7
  s_add_u32 s78, s7, s88
  s_sub_u32 s6, s6, s70
  s_and_b32 s6, s6, 7
  s_lshl_b32 s86, s6, 13
  s_lshl_b32 s6, s71, 1
  s_add_u32 s6, s6, 7
  s_and_b32 s6, s6, 7
  s_lshl_b32 s7, s6, 7
  s_add_u32 s79, s7, s88
  s_sub_u32 s6, s6, s70
  s_and_b32 s6, s6, 7
  s_lshl_b32 s87, s6, 13
  s_waitcnt lgkmcnt(0)
  s_mov_b32 s8, s48
  s_mov_b32 s9, s49
  s_mov_b32 s10, 0x200000
  s_mov_b32 s11, 0x20000
  s_cmp_lt_u32 s3, 4
  s_cbranch_scc0 L_skip1
  buffer_load_dwordx4 v[32:35], v8, s[8:11], s72 offen
  buffer_load_dwordx4 v[36:39], v8, s[8:11], s73 offen
  buffer_load_dwordx4 v[40:43], v8, s[8:11], s74 offen
  buffer_load_dwordx4 v[44:47], v8, s[8:11], s75 offen
  buffer_load_dwordx4 v[48:51], v8, s[8:11], s76 offen
  buffer_load_dwordx4 v[52:55], v8, s[8:11], s77 offen
  buffer_load_dwordx4 v[56:59], v8, s[8:11], s78 offen
  buffer_load_dwordx4 v[60:63], v8, s[8:11], s79 offen
  buffer_load_dwordx4 v[64:67], v15, s[8:11], s72 offen
  buffer_load_dwordx4 v[68:71], v15, s[8:11], s73 offen
  buffer_load_dwordx4 v[72:75], v15, s[8:11], s74 offen
  buffer_load_dwordx4 v[76:79], v15, s[8:11], s75 offen
  buffer_load_dwordx4 v[80:83], v15, s[8:11], s76 offen
  buffer_load_dwordx4 v[84:87], v15, s[8:11], s77 offen
  buffer_load_dwordx4 v[88:91], v15, s[8:11], s78 offen
  buffer_load_dwordx4 v[92:95], v15, s[8:11], s79 offen
L_skip1:
  s_mov_b32 s36, s68
  s_mov_b32 s37, s69
  s_mov_b32 s38, 0xb90000
  s_mov_b32 s39, 0x20000
  v_mov_b32 v28, 0
  v_mov_b32 v29, 0
  v_mov_b32 v30, 0
  v_mov_b32 v31, 0
  s_cmp_eq_u32 s3, 7
  s_cbranch_scc0 L_skip2
  s_sub_u32 s7, s2, 128
  s_cmp_lt_u32 s7, 8
  s_cbranch_scc0 L_skip3
  s_lshl_b32 s6, s7, 12
  s_add_u32 s6, s6, 0xb00000
  buffer_store_dwordx4 v[28:31], v1, s[36:39], s6 offen offset:0 sc1
  buffer_store_dwordx4 v[28:31], v1, s[36:39], s6 offen offset:1024 sc1
  buffer_store_dwordx4 v[28:31], v1, s[36:39], s6 offen offset:2048 sc1
  buffer_store_dwordx4 v[28:31], v1, s[36:39], s6 offen offset:3072 sc1
  s_lshl_b32 s6, s7, 8
  s_add_u32 s6, s6, 0xb08000
  v_lshlrev_b32 v4, 2, v0
  buffer_store_dword v28, v4, s[36:39], s6 offen sc1
L_skip3:
  s_sub_u32 s6, s2, 136
  s_cmp_lt_u32 s6, 116
  s_cbranch_scc0 L_skip4
  s_lshl_b32 s6, s6, 12
  s_add_u32 s6, s6, 0xb10000
  buffer_store_dwordx4 v[28:31], v1, s[36:39], s6 offen offset:0 sc1
  buffer_store_dwordx4 v[28:31], v1, s[36:39], s6 offen offset:1024 sc1
  buffer_store_dwordx4 v[28:31], v1, s[36:39], s6 offen offset:2048 sc1
  buffer_store_dwordx4 v[28:31], v1, s[36:39], s6 offen offset:3072 sc1
L_skip4:
L_skip2:
  s_mov_b32 s12, s50
  s_mov_b32 s13, s51
  s_mov_b32 s14, 0x180000
  s_mov_b32 s15, 0x20000
  s_mov_b32 s44, s66
  s_mov_b32 s45, s67
  s_mov_b32 s46, 0x100
  s_mov_b32 s47, 0x20000
  s_mov_b32 s16, s52
  s_mov_b32 s17, s53
  s_mov_b32 s18, 0x80000
  s_mov_b32 s19, 0x20000
  s_mov_b32 s20, s56
  s_mov_b32 s21, s57
  s_mov_b32 s22, 0x1c0000
  s_mov_b32 s23, 0x20000
  s_mov_b32 s24, s58
  s_mov_b32 s25, s59
  s_mov_b32 s26, 0x800000
  s_mov_b32 s27, 0x20000
  s_mov_b32 s40, s60
  s_mov_b32 s41, s61
  s_mov_b32 s42, 0x1000
  s_mov_b32 s43, 0x20000
  s_mov_b32 s28, s62
  s_mov_b32 s29, s63
  s_mov_b32 s30, 0xe0000
  s_mov_b32 s31, 0x20000
  s_mov_b32 s32, s64
  s_mov_b32 s33, s65
  s_mov_b32 s34, 0x200000
  s_mov_b32 s35, 0x20000
  s_cmp_ge_u32 s3, 4
  s_cbranch_scc1 L_loader
  s_barrier
  v_xor_b32 v4, v6, v7
  v_lshlrev_b32 v9, 7, v6
  v_lshl_add_u32 v9, v4, 4, v9
  s_lshl_b32 s6, s3, 11
  v_add_u32 v9, s6, v9
  v_mov_b32 v14, 0xffff0000
  v_and_b32 v10, 7, v0
  v_xor_b32 v10, v10, v2
  v_lshlrev_b32 v10, 4, v10
  v_lshl_add_u32 v10, v3, 7, v10
  v_xor_b32 v11, 64, v10
  v_bfe_u32 v12, v0, 3, 2
  v_xor_b32 v12, s3, v12
  v_lshlrev_b32 v12, 5, v12
  v_and_b32 v4, 3, v0
  v_lshl_add_u32 v12, v4, 3, v12
  v_bfe_u32 v4, v0, 2, 2
  v_lshl_add_u32 v4, v2, 3, v4
  v_lshl_add_u32 v12, v4, 7, v12
  v_add_u32 v12, 0x10000, v12
  v_add_u32 v13, 0xC000, v12
  s_waitcnt vmcnt(15)
  v_lshlrev_b32 v96, 16, v32
  v_and_b32 v97, v14, v32
  v_lshlrev_b32 v98, 16, v33
  v_and_b32 v99, v14, v33
  v_pk_mul_f32 v[20:21], v[96:97], v[96:97]
  v_lshlrev_b32 v100, 16, v34
  v_and_b32 v101, v14, v34
  v_pk_mul_f32 v[22:23], v[98:99], v[98:99]
  v_lshlrev_b32 v102, 16, v35
  v_and_b32 v103, v14, v35
  v_pk_fma_f32 v[20:21], v[100:101], v[100:101], v[20:21]
  v_pk_add_f32 v[16:17], v[100:101], v[96:97]
  s_waitcnt vmcnt(14)
  v_lshlrev_b32 v104, 16, v36
  v_and_b32 v105, v14, v36
  v_pk_fma_f32 v[22:23], v[102:103], v[102:103], v[22:23]
  v_pk_add_f32 v[18:19], v[102:103], v[98:99]
  v_lshlrev_b32 v106, 16, v37
  v_and_b32 v107, v14, v37
  v_pk_fma_f32 v[20:21], v[104:105], v[104:105], v[20:21]
  v_pk_add_f32 v[16:17], v[104:105], v[16:17]
  v_lshlrev_b32 v108, 16, v38
  v_and_b32 v109, v14, v38
  v_pk_fma_f32 v[22:23], v[106:107], v[106:107], v[22:23]
  v_pk_add_f32 v[18:19], v[106:107], v[18:19]
  v_lshlrev_b32 v110, 16, v39
  v_and_b32 v111, v14, v39
  v_pk_fma_f32 v[20:21], v[108:109], v[108:109], v[20:21]
  v_pk_add_f32 v[16:17], v[108:109], v[16:17]
  s_waitcnt vmcnt(13)
  v_lshlrev_b32 v112, 16, v40
  v_and_b32 v113, v14, v40
  v_pk_fma_f32 v[22:23], v[110:111], v[110:111], v[22:23]
  v_pk_add_f32 v[18:19], v[110:111], v[18:19]
  v_lshlrev_b32 v114, 16, v41
  v_and_b32 v115, v14, v41
  v_pk_fma_f32 v[20:21], v[112:113], v[112:113], v[20:21]
  v_pk_add_f32 v[16:17], v[112:113], v[16:17]
  v_lshlrev_b32 v116, 16, v42
  v_and_b32 v117, v14, v42
  v_pk_fma_f32 v[22:23], v[114:115], v[114:115], v[22:23]
  v_pk_add_f32 v[18:19], v[114:115], v[18:19]
  v_lshlrev_b32 v118, 16, v43
  v_and_b32 v119, v14, v43
  v_pk_fma_f32 v[20:21], v[116:117], v[116:117], v[20:21]
  v_pk_add_f32 v[16:17], v[116:117], v[16:17]
  s_waitcnt vmcnt(12)
  v_lshlrev_b32 v120, 16, v44
  v_and_b32 v121, v14, v44
  v_pk_fma_f32 v[22:23], v[118:119], v[118:119], v[22:23]
  v_pk_add_f32 v[18:19], v[118:119], v[18:19]
  v_lshlrev_b32 v122, 16, v45
  v_and_b32 v123, v14, v45
  v_pk_fma_f32 v[20:21], v[120:121], v[120:121], v[20:21]
  v_pk_add_f32 v[16:17], v[120:121], v[16:17]
  v_lshlrev_b32 v124, 16, v46
  v_and_b32 v125, v14, v46
  v_pk_fma_f32 v[22:23], v[122:123], v[122:123], v[22:23]
  v_pk_add_f32 v[18:19], v[122:123], v[18:19]
  v_lshlrev_b32 v126, 16, v47
  v_and_b32 v127, v14, v47
  v_pk_fma_f32 v[20:21], v[124:125], v[124:125], v[20:21]
  v_pk_add_f32 v[16:17], v[124:125], v[16:17]
  s_waitcnt vmcnt(11)
  v_lshlrev_b32 v128, 16, v48
  v_and_b32 v129, v14, v48
  v_pk_fma_f32 v[22:23], v[126:127], v[126:127], v[22:23]
  v_pk_add_f32 v[18:19], v[126:127], v[18:19]
  v_lshlrev_b32 v130, 16, v49
  v_and_b32 v131, v14, v49
  v_pk_fma_f32 v[20:21], v[128:129], v[128:129], v[20:21]
  v_pk_add_f32 v[16:17], v[128:129], v[16:17]
  v_lshlrev_b32 v132, 16, v50
  v_and_b32 v133, v14, v50
  v_pk_fma_f32 v[22:23], v[130:131], v[130:131], v[22:23]
  v_pk_add_f32 v[18:19], v[130:131], v[18:19]
  v_lshlrev_b32 v134, 16, v51
  v_and_b32 v135, v14, v51
  v_pk_fma_f32 v[20:21], v[132:133], v[132:133], v[20:21]
  v_pk_add_f32 v[16:17], v[132:133], v[16:17]
  s_waitcnt vmcnt(10)
  v_lshlrev_b32 v136, 16, v52
  v_and_b32 v137, v14, v52
  v_pk_fma_f32 v[22:23], v[134:135], v[134:135], v[22:23]
  v_pk_add_f32 v[18:19], v[134:135], v[18:19]
  v_lshlrev_b32 v138, 16, v53
  v_and_b32 v139, v14, v53
  v_pk_fma_f32 v[20:21], v[136:137], v[136:137], v[20:21]
  v_pk_add_f32 v[16:17], v[136:137], v[16:17]
  v_lshlrev_b32 v140, 16, v54
  v_and_b32 v141, v14, v54
  v_pk_fma_f32 v[22:23], v[138:139], v[138:139], v[22:23]
  v_pk_add_f32 v[18:19], v[138:139], v[18:19]
  v_lshlrev_b32 v142, 16, v55
  v_and_b32 v143, v14, v55
  v_pk_fma_f32 v[20:21], v[140:141], v[140:141], v[20:21]
  v_pk_add_f32 v[16:17], v[140:141], v[16:17]
  s_waitcnt vmcnt(9)
  v_lshlrev_b32 v144, 16, v56
  v_and_b32 v145, v14, v56
  v_pk_fma_f32 v[22:23], v[142:143], v[142:143], v[22:23]
  v_pk_add_f32 v[18:19], v[142:143], v[18:19]
  v_lshlrev_b32 v146, 16, v57
  v_and_b32 v147, v14, v57
  v_pk_fma_f32 v[20:21], v[144:145], v[144:145], v[20:21]
  v_pk_add_f32 v[16:17], v[144:145], v[16:17]
  v_lshlrev_b32 v148, 16, v58
  v_and_b32 v149, v14, v58
  v_pk_fma_f32 v[22:23], v[146:147], v[146:147], v[22:23]
  v_pk_add_f32 v[18:19], v[146:147], v[18:19]
  v_lshlrev_b32 v150, 16, v59
  v_and_b32 v151, v14, v59
  v_pk_fma_f32 v[20:21], v[148:149], v[148:149], v[20:21]
  v_pk_add_f32 v[16:17], v[148:149], v[16:17]
  s_waitcnt vmcnt(8)
  v_lshlrev_b32 v152, 16, v60
  v_and_b32 v153, v14, v60
  v_pk_fma_f32 v[22:23], v[150:151], v[150:151], v[22:23]
  v_pk_add_f32 v[18:19], v[150:151], v[18:19]
  v_lshlrev_b32 v154, 16, v61
  v_and_b32 v155, v14, v61
  v_pk_fma_f32 v[20:21], v[152:153], v[152:153], v[20:21]
  v_pk_add_f32 v[16:17], v[152:153], v[16:17]
  v_lshlrev_b32 v156, 16, v62
  v_and_b32 v157, v14, v62
  v_pk_fma_f32 v[22:23], v[154:155], v[154:155], v[22:23]
  v_pk_add_f32 v[18:19], v[154:155], v[18:19]
  v_lshlrev_b32 v158, 16, v63
  v_and_b32 v159, v14, v63
  v_pk_fma_f32 v[20:21], v[156:157], v[156:157], v[20:21]
  v_pk_add_f32 v[16:17], v[156:157], v[16:17]
  v_pk_fma_f32 v[22:23], v[158:159], v[158:159], v[22:23]
  v_pk_add_f32 v[18:19], v[158:159], v[18:19]
  v_pk_add_f32 v[20:21], v[20:21], v[22:23]
  v_pk_add_f32 v[16:17], v[16:17], v[18:19]
  v_add_f32 v20, v20, v21
  v_add_f32 v16, v16, v17
  s_nop 0
  v_add_f32_dpp v20, v20, v20 quad_perm:[1,0,3,2] row_mask:0xf bank_mask:0xf
  v_add_f32_dpp v16, v16, v16 quad_perm:[1,0,3,2] row_mask:0xf bank_mask:0xf
  s_nop 0
  v_add_f32_dpp v20, v20, v20 quad_perm:[2,3,0,1] row_mask:0xf bank_mask:0xf
  v_add_f32_dpp v16, v16, v16 quad_perm:[2,3,0,1] row_mask:0xf bank_mask:0xf
  s_nop 0
  v_add_f32_dpp v20, v20, v20 row_half_mirror row_mask:0xf bank_mask:0xf
  v_add_f32_dpp v16, v16, v16 row_half_mirror row_mask:0xf bank_mask:0xf
  v_mul_f32 v20, 0x3b000000, v20
  v_mul_f32 v16, 0xbb000000, v16
  v_fma_f32 v20, -v16, v16, v20
  v_max_f32 v20, 0, v20
  v_add_f32 v20, 0x3727c5ac, v20
  v_rsq_f32 v20, v20
  s_nop 0
  v_mul_f32 v16, v16, v20
  v_pk_fma_f32 v[96:97], v[96:97], v[20:21], v[16:17] op_sel_hi:[1,0,0]
  v_pk_fma_f32 v[98:99], v[98:99], v[20:21], v[16:17] op_sel_hi:[1,0,0]
  v_pk_fma_f32 v[100:101], v[100:101], v[20:21], v[16:17] op_sel_hi:[1,0,0]
  v_pk_fma_f32 v[102:103], v[102:103], v[20:21], v[16:17] op_sel_hi:[1,0,0]
  v_cvt_pk_bf16_f32 v32, v96, v97
  v_cvt_pk_bf16_f32 v33, v98, v99
  v_cvt_pk_bf16_f32 v34, v100, v101
  v_cvt_pk_bf16_f32 v35, v102, v103
  v_add_u32 v160, s80, v9
  ds_write_b128 v160, v[32:35] offset:0
  v_pk_fma_f32 v[104:105], v[104:105], v[20:21], v[16:17] op_sel_hi:[1,0,0]
  v_pk_fma_f32 v[106:107], v[106:107], v[20:21], v[16:17] op_sel_hi:[1,0,0]
  v_pk_fma_f32 v[108:109], v[108:109], v[20:21], v[16:17] op_sel_hi:[1,0,0]
  v_pk_fma_f32 v[110:111], v[110:111], v[20:21], v[16:17] op_sel_hi:[1,0,0]
  v_cvt_pk_bf16_f32 v36, v104, v105
  v_cvt_pk_bf16_f32 v37, v106, v107
  v_cvt_pk_bf16_f32 v38, v108, v109
  v_cvt_pk_bf16_f32 v39, v110, v111
  v_add_u32 v161, s81, v9
  ds_write_b128 v161, v[36:39] offset:0
  v_pk_fma_f32 v[112:113], v[112:113], v[20:21], v[16:17] op_sel_hi:[1,0,0]
  v_pk_fma_f32 v[114:115], v[114:115], v[20:21], v[16:17] op_sel_hi:[1,0,0]
  v_pk_fma_f32 v[116:117], v[116:117], v[20:21], v[16:17] op_sel_hi:[1,0,0]
  v_pk_fma_f32 v[118:119], v[118:119], v[20:21], v[16:17] op_sel_hi:[1,0,0]
  v_cvt_pk_bf16_f32 v40, v112, v113
  v_cvt_pk_bf16_f32 v41, v114, v115
  v_cvt_pk_bf16_f32 v42, v116, v117
  v_cvt_pk_bf16_f32 v43, v118, v119
  v_add_u32 v162, s82, v9
  ds_write_b128 v162, v[40:43] offset:0
  v_pk_fma_f32 v[120:121], v[120:121], v[20:21], v[16:17] op_sel_hi:[1,0,0]
  v_pk_fma_f32 v[122:123], v[122:123], v[20:21], v[16:17] op_sel_hi:[1,0,0]
  v_pk_fma_f32 v[124:125], v[124:125], v[20:21], v[16:17] op_sel_hi:[1,0,0]
  v_pk_fma_f32 v[126:127], v[126:127], v[20:21], v[16:17] op_sel_hi:[1,0,0]
  v_cvt_pk_bf16_f32 v44, v120, v121
  v_cvt_pk_bf16_f32 v45, v122, v123
  v_cvt_pk_bf16_f32 v46, v124, v125
  v_cvt_pk_bf16_f32 v47, v126, v127
  v_add_u32 v163, s83, v9
  ds_write_b128 v163, v[44:47] offset:0
  v_pk_fma_f32 v[128:129], v[128:129], v[20:21], v[16:17] op_sel_hi:[1,0,0]
  v_pk_fma_f32 v[130:131], v[130:131], v[20:21], v[16:17] op_sel_hi:[1,0,0]
  v_pk_fma_f32 v[132:133], v[132:133], v[20:21], v[16:17] op_sel_hi:[1,0,0]
  v_pk_fma_f32 v[134:135], v[134:135], v[20:21], v[16:17] op_sel_hi:[1,0,0]
  v_cvt_pk_bf16_f32 v48, v128, v129
  v_cvt_pk_bf16_f32 v49, v130, v131
  v_cvt_pk_bf16_f32 v50, v132, v133
  v_cvt_pk_bf16_f32 v51, v134, v135
  v_add_u32 v164, s84, v9
  ds_write_b128 v164, v[48:51] offset:0
  v_pk_fma_f32 v[136:137], v[136:137], v[20:21], v[16:17] op_sel_hi:[1,0,0]
  v_pk_fma_f32 v[138:139], v[138:139], v[20:21], v[16:17] op_sel_hi:[1,0,0]
  v_pk_fma_f32 v[140:141], v[140:141], v[20:21], v[16:17] op_sel_hi:[1,0,0]
  v_pk_fma_f32 v[142:143], v[142:143], v[20:21], v[16:17] op_sel_hi:[1,0,0]
  v_cvt_pk_bf16_f32 v52, v136, v137
  v_cvt_pk_bf16_f32 v53, v138, v139
  v_cvt_pk_bf16_f32 v54, v140, v141
  v_cvt_pk_bf16_f32 v55, v142, v143
  v_add_u32 v165, s85, v9
  ds_write_b128 v165, v[52:55] offset:0
  v_pk_fma_f32 v[144:145], v[144:145], v[20:21], v[16:17] op_sel_hi:[1,0,0]
  v_pk_fma_f32 v[146:147], v[146:147], v[20:21], v[16:17] op_sel_hi:[1,0,0]
  v_pk_fma_f32 v[148:149], v[148:149], v[20:21], v[16:17] op_sel_hi:[1,0,0]
  v_pk_fma_f32 v[150:151], v[150:151], v[20:21], v[16:17] op_sel_hi:[1,0,0]
  v_cvt_pk_bf16_f32 v56, v144, v145
  v_cvt_pk_bf16_f32 v57, v146, v147
  v_cvt_pk_bf16_f32 v58, v148, v149
  v_cvt_pk_bf16_f32 v59, v150, v151
  v_add_u32 v166, s86, v9
  ds_write_b128 v166, v[56:59] offset:0
  v_pk_fma_f32 v[152:153], v[152:153], v[20:21], v[16:17] op_sel_hi:[1,0,0]
  v_pk_fma_f32 v[154:155], v[154:155], v[20:21], v[16:17] op_sel_hi:[1,0,0]
  v_pk_fma_f32 v[156:157], v[156:157], v[20:21], v[16:17] op_sel_hi:[1,0,0]
  v_pk_fma_f32 v[158:159], v[158:159], v[20:21], v[16:17] op_sel_hi:[1,0,0]
  v_cvt_pk_bf16_f32 v60, v152, v153
  v_cvt_pk_bf16_f32 v61, v154, v155
  v_cvt_pk_bf16_f32 v62, v156, v157
  v_cvt_pk_bf16_f32 v63, v158, v159
  v_add_u32 v167, s87, v9
  ds_write_b128 v167, v[60:63] offset:0
  s_waitcnt vmcnt(7)
  v_lshlrev_b32 v96, 16, v64
  v_and_b32 v97, v14, v64
  v_lshlrev_b32 v98, 16, v65
  v_and_b32 v99, v14, v65
  v_pk_mul_f32 v[20:21], v[96:97], v[96:97]
  v_lshlrev_b32 v100, 16, v66
  v_and_b32 v101, v14, v66
  v_pk_mul_f32 v[22:23], v[98:99], v[98:99]
  v_lshlrev_b32 v102, 16, v67
  v_and_b32 v103, v14, v67
  v_pk_fma_f32 v[20:21], v[100:101], v[100:101], v[20:21]
  v_pk_add_f32 v[16:17], v[100:101], v[96:97]
  s_waitcnt vmcnt(6)
  v_lshlrev_b32 v104, 16, v68
  v_and_b32 v105, v14, v68
  v_pk_fma_f32 v[22:23], v[102:103], v[102:103], v[22:23]
  v_pk_add_f32 v[18:19], v[102:103], v[98:99]
  v_lshlrev_b32 v106, 16, v69
  v_and_b32 v107, v14, v69
  v_pk_fma_f32 v[20:21], v[104:105], v[104:105], v[20:21]
  v_pk_add_f32 v[16:17], v[104:105], v[16:17]
  v_lshlrev_b32 v108, 16, v70
  v_and_b32 v109, v14, v70
  v_pk_fma_f32 v[22:23], v[106:107], v[106:107], v[22:23]
  v_pk_add_f32 v[18:19], v[106:107], v[18:19]
  v_lshlrev_b32 v110, 16, v71
  v_and_b32 v111, v14, v71
  v_pk_fma_f32 v[20:21], v[108:109], v[108:109], v[20:21]
  v_pk_add_f32 v[16:17], v[108:109], v[16:17]
  s_waitcnt vmcnt(5)
  v_lshlrev_b32 v112, 16, v72
  v_and_b32 v113, v14, v72
  v_pk_fma_f32 v[22:23], v[110:111], v[110:111], v[22:23]
  v_pk_add_f32 v[18:19], v[110:111], v[18:19]
  v_lshlrev_b32 v114, 16, v73
  v_and_b32 v115, v14, v73
  v_pk_fma_f32 v[20:21], v[112:113], v[112:113], v[20:21]
  v_pk_add_f32 v[16:17], v[112:113], v[16:17]
  v_lshlrev_b32 v116, 16, v74
  v_and_b32 v117, v14, v74
  v_pk_fma_f32 v[22:23], v[114:115], v[114:115], v[22:23]
  v_pk_add_f32 v[18:19], v[114:115], v[18:19]
  v_lshlrev_b32 v118, 16, v75
  v_and_b32 v119, v14, v75
  v_pk_fma_f32 v[20:21], v[116:117], v[116:117], v[20:21]
  v_pk_add_f32 v[16:17], v[116:117], v[16:17]
  s_waitcnt vmcnt(4)
  v_lshlrev_b32 v120, 16, v76
  v_and_b32 v121, v14, v76
  v_pk_fma_f32 v[22:23], v[118:119], v[118:119], v[22:23]
  v_pk_add_f32 v[18:19], v[118:119], v[18:19]
  v_lshlrev_b32 v122, 16, v77
  v_and_b32 v123, v14, v77
  v_pk_fma_f32 v[20:21], v[120:121], v[120:121], v[20:21]
  v_pk_add_f32 v[16:17], v[120:121], v[16:17]
  v_lshlrev_b32 v124, 16, v78
  v_and_b32 v125, v14, v78
  v_pk_fma_f32 v[22:23], v[122:123], v[122:123], v[22:23]
  v_pk_add_f32 v[18:19], v[122:123], v[18:19]
  v_lshlrev_b32 v126, 16, v79
  v_and_b32 v127, v14, v79
  v_pk_fma_f32 v[20:21], v[124:125], v[124:125], v[20:21]
  v_pk_add_f32 v[16:17], v[124:125], v[16:17]
  s_waitcnt vmcnt(3)
  v_lshlrev_b32 v128, 16, v80
  v_and_b32 v129, v14, v80
  v_pk_fma_f32 v[22:23], v[126:127], v[126:127], v[22:23]
  v_pk_add_f32 v[18:19], v[126:127], v[18:19]
  v_lshlrev_b32 v130, 16, v81
  v_and_b32 v131, v14, v81
  v_pk_fma_f32 v[20:21], v[128:129], v[128:129], v[20:21]
  v_pk_add_f32 v[16:17], v[128:129], v[16:17]
  v_lshlrev_b32 v132, 16, v82
  v_and_b32 v133, v14, v82
  v_pk_fma_f32 v[22:23], v[130:131], v[130:131], v[22:23]
  v_pk_add_f32 v[18:19], v[130:131], v[18:19]
  v_lshlrev_b32 v134, 16, v83
  v_and_b32 v135, v14, v83
  v_pk_fma_f32 v[20:21], v[132:133], v[132:133], v[20:21]
  v_pk_add_f32 v[16:17], v[132:133], v[16:17]
  s_waitcnt vmcnt(2)
  v_lshlrev_b32 v136, 16, v84
  v_and_b32 v137, v14, v84
  v_pk_fma_f32 v[22:23], v[134:135], v[134:135], v[22:23]
  v_pk_add_f32 v[18:19], v[134:135], v[18:19]
  v_lshlrev_b32 v138, 16, v85
  v_and_b32 v139, v14, v85
  v_pk_fma_f32 v[20:21], v[136:137], v[136:137], v[20:21]
  v_pk_add_f32 v[16:17], v[136:137], v[16:17]
  v_lshlrev_b32 v140, 16, v86
  v_and_b32 v141, v14, v86
  v_pk_fma_f32 v[22:23], v[138:139], v[138:139], v[22:23]
  v_pk_add_f32 v[18:19], v[138:139], v[18:19]
  v_lshlrev_b32 v142, 16, v87
  v_and_b32 v143, v14, v87
  v_pk_fma_f32 v[20:21], v[140:141], v[140:141], v[20:21]
  v_pk_add_f32 v[16:17], v[140:141], v[16:17]
  s_waitcnt vmcnt(1)
  v_lshlrev_b32 v144, 16, v88
  v_and_b32 v145, v14, v88
  v_pk_fma_f32 v[22:23], v[142:143], v[142:143], v[22:23]
  v_pk_add_f32 v[18:19], v[142:143], v[18:19]
  v_lshlrev_b32 v146, 16, v89
  v_and_b32 v147, v14, v89
  v_pk_fma_f32 v[20:21], v[144:145], v[144:145], v[20:21]
  v_pk_add_f32 v[16:17], v[144:145], v[16:17]
  v_lshlrev_b32 v148, 16, v90
  v_and_b32 v149, v14, v90
  v_pk_fma_f32 v[22:23], v[146:147], v[146:147], v[22:23]
  v_pk_add_f32 v[18:19], v[146:147], v[18:19]
  v_lshlrev_b32 v150, 16, v91
  v_and_b32 v151, v14, v91
  v_pk_fma_f32 v[20:21], v[148:149], v[148:149], v[20:21]
  v_pk_add_f32 v[16:17], v[148:149], v[16:17]
  s_waitcnt vmcnt(0)
  v_lshlrev_b32 v152, 16, v92
  v_and_b32 v153, v14, v92
  v_pk_fma_f32 v[22:23], v[150:151], v[150:151], v[22:23]
  v_pk_add_f32 v[18:19], v[150:151], v[18:19]
  v_lshlrev_b32 v154, 16, v93
  v_and_b32 v155, v14, v93
  v_pk_fma_f32 v[20:21], v[152:153], v[152:153], v[20:21]
  v_pk_add_f32 v[16:17], v[152:153], v[16:17]
  v_lshlrev_b32 v156, 16, v94
  v_and_b32 v157, v14, v94
  v_pk_fma_f32 v[22:23], v[154:155], v[154:155], v[22:23]
  v_pk_add_f32 v[18:19], v[154:155], v[18:19]
  v_lshlrev_b32 v158, 16, v95
  v_and_b32 v159, v14, v95
  v_pk_fma_f32 v[20:21], v[156:157], v[156:157], v[20:21]
  v_pk_add_f32 v[16:17], v[156:157], v[16:17]
  v_pk_fma_f32 v[22:23], v[158:159], v[158:159], v[22:23]
  v_pk_add_f32 v[18:19], v[158:159], v[18:19]
  v_pk_add_f32 v[20:21], v[20:21], v[22:23]
  v_pk_add_f32 v[16:17], v[16:17], v[18:19]
  v_add_f32 v20, v20, v21
  v_add_f32 v16, v16, v17
  s_nop 0
  v_add_f32_dpp v20, v20, v20 quad_perm:[1,0,3,2] row_mask:0xf bank_mask:0xf
  v_add_f32_dpp v16, v16, v16 quad_perm:[1,0,3,2] row_mask:0xf bank_mask:0xf
  s_nop 0
  v_add_f32_dpp v20, v20, v20 quad_perm:[2,3,0,1] row_mask:0xf bank_mask:0xf
  v_add_f32_dpp v16, v16, v16 quad_perm:[2,3,0,1] row_mask:0xf bank_mask:0xf
  s_nop 0
  v_add_f32_dpp v20, v20, v20 row_half_mirror row_mask:0xf bank_mask:0xf
  v_add_f32_dpp v16, v16, v16 row_half_mirror row_mask:0xf bank_mask:0xf
  v_mul_f32 v20, 0x3b000000, v20
  v_mul_f32 v16, 0xbb000000, v16
  v_fma_f32 v20, -v16, v16, v20
  v_max_f32 v20, 0, v20
  v_add_f32 v20, 0x3727c5ac, v20
  v_rsq_f32 v20, v20
  s_nop 0
  v_mul_f32 v16, v16, v20
  v_pk_fma_f32 v[96:97], v[96:97], v[20:21], v[16:17] op_sel_hi:[1,0,0]
  v_pk_fma_f32 v[98:99], v[98:99], v[20:21], v[16:17] op_sel_hi:[1,0,0]
  v_pk_fma_f32 v[100:101], v[100:101], v[20:21], v[16:17] op_sel_hi:[1,0,0]
  v_pk_fma_f32 v[102:103], v[102:103], v[20:21], v[16:17] op_sel_hi:[1,0,0]
  v_cvt_pk_bf16_f32 v64, v96, v97
  v_cvt_pk_bf16_f32 v65, v98, v99
  v_cvt_pk_bf16_f32 v66, v100, v101
  v_cvt_pk_bf16_f32 v67, v102, v103
  v_add_u32 v160, s80, v9
  ds_write_b128 v160, v[64:67] offset:1024
  v_pk_fma_f32 v[104:105], v[104:105], v[20:21], v[16:17] op_sel_hi:[1,0,0]
  v_pk_fma_f32 v[106:107], v[106:107], v[20:21], v[16:17] op_sel_hi:[1,0,0]
  v_pk_fma_f32 v[108:109], v[108:109], v[20:21], v[16:17] op_sel_hi:[1,0,0]
  v_pk_fma_f32 v[110:111], v[110:111], v[20:21], v[16:17] op_sel_hi:[1,0,0]
  v_cvt_pk_bf16_f32 v68, v104, v105
  v_cvt_pk_bf16_f32 v69, v106, v107
  v_cvt_pk_bf16_f32 v70, v108, v109
  v_cvt_pk_bf16_f32 v71, v110, v111
  v_add_u32 v161, s81, v9
  ds_write_b128 v161, v[68:71] offset:1024
  v_pk_fma_f32 v[112:113], v[112:113], v[20:21], v[16:17] op_sel_hi:[1,0,0]
  v_pk_fma_f32 v[114:115], v[114:115], v[20:21], v[16:17] op_sel_hi:[1,0,0]
  v_pk_fma_f32 v[116:117], v[116:117], v[20:21], v[16:17] op_sel_hi:[1,0,0]
  v_pk_fma_f32 v[118:119], v[118:119], v[20:21], v[16:17] op_sel_hi:[1,0,0]
  v_cvt_pk_bf16_f32 v72, v112, v113
  v_cvt_pk_bf16_f32 v73, v114, v115
  v_cvt_pk_bf16_f32 v74, v116, v117
  v_cvt_pk_bf16_f32 v75, v118, v119
  v_add_u32 v162, s82, v9
  ds_write_b128 v162, v[72:75] offset:1024
  v_pk_fma_f32 v[120:121], v[120:121], v[20:21], v[16:17] op_sel_hi:[1,0,0]
  v_pk_fma_f32 v[122:123], v[122:123], v[20:21], v[16:17] op_sel_hi:[1,0,0]
  v_pk_fma_f32 v[124:125], v[124:125], v[20:21], v[16:17] op_sel_hi:[1,0,0]
  v_pk_fma_f32 v[126:127], v[126:127], v[20:21], v[16:17] op_sel_hi:[1,0,0]
  v_cvt_pk_bf16_f32 v76, v120, v121
  v_cvt_pk_bf16_f32 v77, v122, v123
  v_cvt_pk_bf16_f32 v78, v124, v125
  v_cvt_pk_bf16_f32 v79, v126, v127
  v_add_u32 v163, s83, v9
  ds_write_b128 v163, v[76:79] offset:1024
  v_pk_fma_f32 v[128:129], v[128:129], v[20:21], v[16:17] op_sel_hi:[1,0,0]
  v_pk_fma_f32 v[130:131], v[130:131], v[20:21], v[16:17] op_sel_hi:[1,0,0]
  v_pk_fma_f32 v[132:133], v[132:133], v[20:21], v[16:17] op_sel_hi:[1,0,0]
  v_pk_fma_f32 v[134:135], v[134:135], v[20:21], v[16:17] op_sel_hi:[1,0,0]
  v_cvt_pk_bf16_f32 v80, v128, v129
  v_cvt_pk_bf16_f32 v81, v130, v131
  v_cvt_pk_bf16_f32 v82, v132, v133
  v_cvt_pk_bf16_f32 v83, v134, v135
  v_add_u32 v164, s84, v9
  ds_write_b128 v164, v[80:83] offset:1024
  v_pk_fma_f32 v[136:137], v[136:137], v[20:21], v[16:17] op_sel_hi:[1,0,0]
  v_pk_fma_f32 v[138:139], v[138:139], v[20:21], v[16:17] op_sel_hi:[1,0,0]
  v_pk_fma_f32 v[140:141], v[140:141], v[20:21], v[16:17] op_sel_hi:[1,0,0]
  v_pk_fma_f32 v[142:143], v[142:143], v[20:21], v[16:17] op_sel_hi:[1,0,0]
  v_cvt_pk_bf16_f32 v84, v136, v137
  v_cvt_pk_bf16_f32 v85, v138, v139
  v_cvt_pk_bf16_f32 v86, v140, v141
  v_cvt_pk_bf16_f32 v87, v142, v143
  v_add_u32 v165, s85, v9
  ds_write_b128 v165, v[84:87] offset:1024
  v_pk_fma_f32 v[144:145], v[144:145], v[20:21], v[16:17] op_sel_hi:[1,0,0]
  v_pk_fma_f32 v[146:147], v[146:147], v[20:21], v[16:17] op_sel_hi:[1,0,0]
  v_pk_fma_f32 v[148:149], v[148:149], v[20:21], v[16:17] op_sel_hi:[1,0,0]
  v_pk_fma_f32 v[150:151], v[150:151], v[20:21], v[16:17] op_sel_hi:[1,0,0]
  v_cvt_pk_bf16_f32 v88, v144, v145
  v_cvt_pk_bf16_f32 v89, v146, v147
  v_cvt_pk_bf16_f32 v90, v148, v149
  v_cvt_pk_bf16_f32 v91, v150, v151
  v_add_u32 v166, s86, v9
  ds_write_b128 v166, v[88:91] offset:1024
  v_pk_fma_f32 v[152:153], v[152:153], v[20:21], v[16:17] op_sel_hi:[1,0,0]
  v_pk_fma_f32 v[154:155], v[154:155], v[20:21], v[16:17] op_sel_hi:[1,0,0]
  v_pk_fma_f32 v[156:157], v[156:157], v[20:21], v[16:17] op_sel_hi:[1,0,0]
  v_pk_fma_f32 v[158:159], v[158:159], v[20:21], v[16:17] op_sel_hi:[1,0,0]
  v_cvt_pk_bf16_f32 v92, v152, v153
  v_cvt_pk_bf16_f32 v93, v154, v155
  v_cvt_pk_bf16_f32 v94, v156, v157
  v_cvt_pk_bf16_f32 v95, v158, v159
  v_add_u32 v167, s87, v9
  ds_write_b128 v167, v[92:95] offset:1024
  s_waitcnt lgkmcnt(0)
  s_barrier
  ds_read_b128 v[32:35], v10 offset:0
  ds_read_b64_tr_b16 v[52:53], v12 offset:8192
  ds_read_b64_tr_b16 v[54:55], v12 offset:8704
  ds_read_b128 v[36:39], v10 offset:2048
  ds_read_b128 v[40:43], v10 offset:4096
  ds_read_b128 v[44:47], v10 offset:6144
  ds_read_b64_tr_b16 v[56:57], v12 offset:16384
  ds_read_b64_tr_b16 v[58:59], v12 offset:16896
  ds_read_b64_tr_b16 v[48:49], v12 offset:0
  ds_read_b64_tr_b16 v[50:51], v12 offset:512
  ds_read_b128 v[60:63], v11 offset:0
  s_waitcnt lgkmcnt(5)
  v_mfma_f32_16x16x32_bf16 v[96:99], v[32:35], v[52:55], 0
  ds_read_b64_tr_b16 v[80:81], v12 offset:12288
  v_mfma_f32_16x16x32_bf16 v[100:103], v[36:39], v[52:55], 0
  ds_read_b64_tr_b16 v[82:83], v12 offset:12800
  v_mfma_f32_16x16x32_bf16 v[104:107], v[40:43], v[52:55], 0
  ds_read_b128 v[64:67], v11 offset:2048
  v_mfma_f32_16x16x32_bf16 v[108:111], v[44:47], v[52:55], 0
  ds_read_b128 v[68:71], v11 offset:4096
  s_waitcnt lgkmcnt(5)
  v_mfma_f32_16x16x32_bf16 v[112:115], v[32:35], v[56:59], 0
  ds_read_b128 v[72:75], v11 offset:6144
  v_mfma_f32_16x16x32_bf16 v[116:119], v[36:39], v[56:59], 0
  ds_read_b64_tr_b16 v[84:85], v12 offset:20480
  v_mfma_f32_16x16x32_bf16 v[120:123], v[40:43], v[56:59], 0
  ds_read_b64_tr_b16 v[86:87], v12 offset:20992
  v_mfma_f32_16x16x32_bf16 v[124:127], v[44:47], v[56:59], 0
  ds_read_b64_tr_b16 v[76:77], v12 offset:4096
  v_mfma_f32_16x16x32_bf16 v[128:131], v[48:51], v[32:35], 0
  ds_read_b64_tr_b16 v[78:79], v12 offset:4608
  v_mfma_f32_16x16x32_bf16 v[132:135], v[48:51], v[36:39], 0
  v_mfma_f32_16x16x32_bf16 v[136:139], v[48:51], v[40:43], 0
  v_mfma_f32_16x16x32_bf16 v[140:143], v[48:51], v[44:47], 0
  s_barrier
  ds_read_b128 v[32:35], v10 offset:8192
  s_waitcnt lgkmcnt(5)
  v_mfma_f32_16x16x32_bf16 v[96:99], v[60:63], v[80:83], v[96:99]
  ds_read_b64_tr_b16 v[52:53], v12 offset:32768
  v_mfma_f32_16x16x32_bf16 v[100:103], v[64:67], v[80:83], v[100:103]
  ds_read_b64_tr_b16 v[54:55], v12 offset:33280
  v_mfma_f32_16x16x32_bf16 v[104:107], v[68:71], v[80:83], v[104:107]
  ds_read_b128 v[36:39], v10 offset:10240
  v_mfma_f32_16x16x32_bf16 v[108:111], v[72:75], v[80:83], v[108:111]
  ds_read_b128 v[40:43], v10 offset:12288
  s_waitcnt lgkmcnt(5)
  v_mfma_f32_16x16x32_bf16 v[112:115], v[60:63], v[84:87], v[112:115]
  ds_read_b128 v[44:47], v10 offset:14336
  v_mfma_f32_16x16x32_bf16 v[116:119], v[64:67], v[84:87], v[116:119]
  ds_read_b64_tr_b16 v[56:57], v12 offset:40960
  v_mfma_f32_16x16x32_bf16 v[120:123], v[68:71], v[84:87], v[120:123]
  ds_read_b64_tr_b16 v[58:59], v12 offset:41472
  v_mfma_f32_16x16x32_bf16 v[124:127], v[72:75], v[84:87], v[124:127]
  ds_read_b64_tr_b16 v[48:49], v12 offset:24576
  v_mfma_f32_16x16x32_bf16 v[128:131], v[76:79], v[60:63], v[128:131]
  ds_read_b64_tr_b16 v[50:51], v12 offset:25088
  v_mfma_f32_16x16x32_bf16 v[132:135], v[76:79], v[64:67], v[132:135]
  v_mfma_f32_16x16x32_bf16 v[136:139], v[76:79], v[68:71], v[136:139]
  v_mfma_f32_16x16x32_bf16 v[140:143], v[76:79], v[72:75], v[140:143]
  ds_read_b128 v[60:63], v11 offset:8192
  s_waitcnt lgkmcnt(5)
  v_mfma_f32_16x16x32_bf16 v[96:99], v[32:35], v[52:55], v[96:99]
  ds_read_b64_tr_b16 v[80:81], v12 offset:36864
  v_mfma_f32_16x16x32_bf16 v[100:103], v[36:39], v[52:55], v[100:103]
  ds_read_b64_tr_b16 v[82:83], v12 offset:37376
  v_mfma_f32_16x16x32_bf16 v[104:107], v[40:43], v[52:55], v[104:107]
  ds_read_b128 v[64:67], v11 offset:10240
  v_mfma_f32_16x16x32_bf16 v[108:111], v[44:47], v[52:55], v[108:111]
  ds_read_b128 v[68:71], v11 offset:12288
  s_waitcnt lgkmcnt(5)
  v_mfma_f32_16x16x32_bf16 v[112:115], v[32:35], v[56:59], v[112:115]
  ds_read_b128 v[72:75], v11 offset:14336
  v_mfma_f32_16x16x32_bf16 v[116:119], v[36:39], v[56:59], v[116:119]
  ds_read_b64_tr_b16 v[84:85], v12 offset:45056
  v_mfma_f32_16x16x32_bf16 v[120:123], v[40:43], v[56:59], v[120:123]
  ds_read_b64_tr_b16 v[86:87], v12 offset:45568
  v_mfma_f32_16x16x32_bf16 v[124:127], v[44:47], v[56:59], v[124:127]
  ds_read_b64_tr_b16 v[76:77], v12 offset:28672
  v_mfma_f32_16x16x32_bf16 v[128:131], v[48:51], v[32:35], v[128:131]
  ds_read_b64_tr_b16 v[78:79], v12 offset:29184
  v_mfma_f32_16x16x32_bf16 v[132:135], v[48:51], v[36:39], v[132:135]
  v_mfma_f32_16x16x32_bf16 v[136:139], v[48:51], v[40:43], v[136:139]
  v_mfma_f32_16x16x32_bf16 v[140:143], v[48:51], v[44:47], v[140:143]
  s_barrier
  ds_read_b128 v[32:35], v10 offset:16384
  s_waitcnt lgkmcnt(5)
  v_mfma_f32_16x16x32_bf16 v[96:99], v[60:63], v[80:83], v[96:99]
  ds_read_b64_tr_b16 v[52:53], v13 offset:8192
  v_mfma_f32_16x16x32_bf16 v[100:103], v[64:67], v[80:83], v[100:103]
  ds_read_b64_tr_b16 v[54:55], v13 offset:8704
  v_mfma_f32_16x16x32_bf16 v[104:107], v[68:71], v[80:83], v[104:107]
  ds_read_b128 v[36:39], v10 offset:18432
  v_mfma_f32_16x16x32_bf16 v[108:111], v[72:75], v[80:83], v[108:111]
  ds_read_b128 v[40:43], v10 offset:20480
  s_waitcnt lgkmcnt(5)
  v_mfma_f32_16x16x32_bf16 v[112:115], v[60:63], v[84:87], v[112:115]
  ds_read_b128 v[44:47], v10 offset:22528
  v_mfma_f32_16x16x32_bf16 v[116:119], v[64:67], v[84:87], v[116:119]
  ds_read_b64_tr_b16 v[56:57], v13 offset:16384
  v_mfma_f32_16x16x32_bf16 v[120:123], v[68:71], v[84:87], v[120:123]
  ds_read_b64_tr_b16 v[58:59], v13 offset:16896
  v_mfma_f32_16x16x32_bf16 v[124:127], v[72:75], v[84:87], v[124:127]
  ds_read_b64_tr_b16 v[48:49], v13 offset:0
  v_mfma_f32_16x16x32_bf16 v[128:131], v[76:79], v[60:63], v[128:131]
  ds_read_b64_tr_b16 v[50:51], v13 offset:512
  v_mfma_f32_16x16x32_bf16 v[132:135], v[76:79], v[64:67], v[132:135]
  v_mfma_f32_16x16x32_bf16 v[136:139], v[76:79], v[68:71], v[136:139]
  v_mfma_f32_16x16x32_bf16 v[140:143], v[76:79], v[72:75], v[140:143]
  ds_read_b128 v[60:63], v11 offset:16384
  s_waitcnt lgkmcnt(5)
  v_mfma_f32_16x16x32_bf16 v[96:99], v[32:35], v[52:55], v[96:99]
  ds_read_b64_tr_b16 v[80:81], v13 offset:12288
  v_mfma_f32_16x16x32_bf16 v[100:103], v[36:39], v[52:55], v[100:103]
  ds_read_b64_tr_b16 v[82:83], v13 offset:12800
  v_mfma_f32_16x16x32_bf16 v[104:107], v[40:43], v[52:55], v[104:107]
  ds_read_b128 v[64:67], v11 offset:18432
  v_mfma_f32_16x16x32_bf16 v[108:111], v[44:47], v[52:55], v[108:111]
  ds_read_b128 v[68:71], v11 offset:20480
  s_waitcnt lgkmcnt(5)
  v_mfma_f32_16x16x32_bf16 v[112:115], v[32:35], v[56:59], v[112:115]
  ds_read_b128 v[72:75], v11 offset:22528
  v_mfma_f32_16x16x32_bf16 v[116:119], v[36:39], v[56:59], v[116:119]
  ds_read_b64_tr_b16 v[84:85], v13 offset:20480
  v_mfma_f32_16x16x32_bf16 v[120:123], v[40:43], v[56:59], v[120:123]
  ds_read_b64_tr_b16 v[86:87], v13 offset:20992
  v_mfma_f32_16x16x32_bf16 v[124:127], v[44:47], v[56:59], v[124:127]
  ds_read_b64_tr_b16 v[76:77], v13 offset:4096
  v_mfma_f32_16x16x32_bf16 v[128:131], v[48:51], v[32:35], v[128:131]
  ds_read_b64_tr_b16 v[78:79], v13 offset:4608
  v_mfma_f32_16x16x32_bf16 v[132:135], v[48:51], v[36:39], v[132:135]
  v_mfma_f32_16x16x32_bf16 v[136:139], v[48:51], v[40:43], v[136:139]
  v_mfma_f32_16x16x32_bf16 v[140:143], v[48:51], v[44:47], v[140:143]
  s_barrier
  ds_read_b128 v[32:35], v10 offset:24576
  s_waitcnt lgkmcnt(5)
  v_mfma_f32_16x16x32_bf16 v[96:99], v[60:63], v[80:83], v[96:99]
  ds_read_b64_tr_b16 v[52:53], v13 offset:32768
  v_mfma_f32_16x16x32_bf16 v[100:103], v[64:67], v[80:83], v[100:103]
  ds_read_b64_tr_b16 v[54:55], v13 offset:33280
  v_mfma_f32_16x16x32_bf16 v[104:107], v[68:71], v[80:83], v[104:107]
  ds_read_b128 v[36:39], v10 offset:26624
  v_mfma_f32_16x16x32_bf16 v[108:111], v[72:75], v[80:83], v[108:111]
  ds_read_b128 v[40:43], v10 offset:28672
  s_waitcnt lgkmcnt(5)
  v_mfma_f32_16x16x32_bf16 v[112:115], v[60:63], v[84:87], v[112:115]
  ds_read_b128 v[44:47], v10 offset:30720
  v_mfma_f32_16x16x32_bf16 v[116:119], v[64:67], v[84:87], v[116:119]
  ds_read_b64_tr_b16 v[56:57], v13 offset:40960
  v_mfma_f32_16x16x32_bf16 v[120:123], v[68:71], v[84:87], v[120:123]
  ds_read_b64_tr_b16 v[58:59], v13 offset:41472
  v_mfma_f32_16x16x32_bf16 v[124:127], v[72:75], v[84:87], v[124:127]
  ds_read_b64_tr_b16 v[48:49], v13 offset:24576
  v_mfma_f32_16x16x32_bf16 v[128:131], v[76:79], v[60:63], v[128:131]
  ds_read_b64_tr_b16 v[50:51], v13 offset:25088
  v_mfma_f32_16x16x32_bf16 v[132:135], v[76:79], v[64:67], v[132:135]
  v_mfma_f32_16x16x32_bf16 v[136:139], v[76:79], v[68:71], v[136:139]
  v_mfma_f32_16x16x32_bf16 v[140:143], v[76:79], v[72:75], v[140:143]
  ds_read_b128 v[60:63], v11 offset:24576
  s_waitcnt lgkmcnt(5)
  v_mfma_f32_16x16x32_bf16 v[96:99], v[32:35], v[52:55], v[96:99]
  ds_read_b64_tr_b16 v[80:81], v13 offset:36864
  v_mfma_f32_16x16x32_bf16 v[100:103], v[36:39], v[52:55], v[100:103]
  ds_read_b64_tr_b16 v[82:83], v13 offset:37376
  v_mfma_f32_16x16x32_bf16 v[104:107], v[40:43], v[52:55], v[104:107]
  ds_read_b128 v[64:67], v11 offset:26624
  v_mfma_f32_16x16x32_bf16 v[108:111], v[44:47], v[52:55], v[108:111]
  ds_read_b128 v[68:71], v11 offset:28672
  s_waitcnt lgkmcnt(5)
  v_mfma_f32_16x16x32_bf16 v[112:115], v[32:35], v[56:59], v[112:115]
  ds_read_b128 v[72:75], v11 offset:30720
  v_mfma_f32_16x16x32_bf16 v[116:119], v[36:39], v[56:59], v[116:119]
  ds_read_b64_tr_b16 v[84:85], v13 offset:45056
  v_mfma_f32_16x16x32_bf16 v[120:123], v[40:43], v[56:59], v[120:123]
  ds_read_b64_tr_b16 v[86:87], v13 offset:45568
  v_mfma_f32_16x16x32_bf16 v[124:127], v[44:47], v[56:59], v[124:127]
  ds_read_b64_tr_b16 v[76:77], v13 offset:28672
  v_mfma_f32_16x16x32_bf16 v[128:131], v[48:51], v[32:35], v[128:131]
  ds_read_b64_tr_b16 v[78:79], v13 offset:29184
  v_mfma_f32_16x16x32_bf16 v[132:135], v[48:51], v[36:39], v[132:135]
  v_mfma_f32_16x16x32_bf16 v[136:139], v[48:51], v[40:43], v[136:139]
  v_mfma_f32_16x16x32_bf16 v[140:143], v[48:51], v[44:47], v[140:143]
  s_barrier
  ds_read_b128 v[32:35], v10 offset:32768
  s_waitcnt lgkmcnt(5)
  v_mfma_f32_16x16x32_bf16 v[96:99], v[60:63], v[80:83], v[96:99]
  ds_read_b64_tr_b16 v[52:53], v12 offset:8192
  v_mfma_f32_16x16x32_bf16 v[100:103], v[64:67], v[80:83], v[100:103]
  ds_read_b64_tr_b16 v[54:55], v12 offset:8704
  v_mfma_f32_16x16x32_bf16 v[104:107], v[68:71], v[80:83], v[104:107]
  ds_read_b128 v[36:39], v10 offset:34816
  v_mfma_f32_16x16x32_bf16 v[108:111], v[72:75], v[80:83], v[108:111]
  ds_read_b128 v[40:43], v10 offset:36864
  s_waitcnt lgkmcnt(5)
  v_mfma_f32_16x16x32_bf16 v[112:115], v[60:63], v[84:87], v[112:115]
  ds_read_b128 v[44:47], v10 offset:38912
  v_mfma_f32_16x16x32_bf16 v[116:119], v[64:67], v[84:87], v[116:119]
  ds_read_b64_tr_b16 v[56:57], v12 offset:16384
  v_mfma_f32_16x16x32_bf16 v[120:123], v[68:71], v[84:87], v[120:123]
  ds_read_b64_tr_b16 v[58:59], v12 offset:16896
  v_mfma_f32_16x16x32_bf16 v[124:127], v[72:75], v[84:87], v[124:127]
  ds_read_b64_tr_b16 v[48:49], v12 offset:0
  v_mfma_f32_16x16x32_bf16 v[128:131], v[76:79], v[60:63], v[128:131]
  ds_read_b64_tr_b16 v[50:51], v12 offset:512
  v_mfma_f32_16x16x32_bf16 v[132:135], v[76:79], v[64:67], v[132:135]
  v_mfma_f32_16x16x32_bf16 v[136:139], v[76:79], v[68:71], v[136:139]
  v_mfma_f32_16x16x32_bf16 v[140:143], v[76:79], v[72:75], v[140:143]
  ds_read_b128 v[60:63], v11 offset:32768
  s_waitcnt lgkmcnt(5)
  v_mfma_f32_16x16x32_bf16 v[96:99], v[32:35], v[52:55], v[96:99]
  ds_read_b64_tr_b16 v[80:81], v12 offset:12288
  v_mfma_f32_16x16x32_bf16 v[100:103], v[36:39], v[52:55], v[100:103]
  ds_read_b64_tr_b16 v[82:83], v12 offset:12800
  v_mfma_f32_16x16x32_bf16 v[104:107], v[40:43], v[52:55], v[104:107]
  ds_read_b128 v[64:67], v11 offset:34816
  v_mfma_f32_16x16x32_bf16 v[108:111], v[44:47], v[52:55], v[108:111]
  ds_read_b128 v[68:71], v11 offset:36864
  s_waitcnt lgkmcnt(5)
  v_mfma_f32_16x16x32_bf16 v[112:115], v[32:35], v[56:59], v[112:115]
  ds_read_b128 v[72:75], v11 offset:38912
  v_mfma_f32_16x16x32_bf16 v[116:119], v[36:39], v[56:59], v[116:119]
  ds_read_b64_tr_b16 v[84:85], v12 offset:20480
  v_mfma_f32_16x16x32_bf16 v[120:123], v[40:43], v[56:59], v[120:123]
  ds_read_b64_tr_b16 v[86:87], v12 offset:20992
  v_mfma_f32_16x16x32_bf16 v[124:127], v[44:47], v[56:59], v[124:127]
  ds_read_b64_tr_b16 v[76:77], v12 offset:4096
  v_mfma_f32_16x16x32_bf16 v[128:131], v[48:51], v[32:35], v[128:131]
  ds_read_b64_tr_b16 v[78:79], v12 offset:4608
  v_mfma_f32_16x16x32_bf16 v[132:135], v[48:51], v[36:39], v[132:135]
  v_mfma_f32_16x16x32_bf16 v[136:139], v[48:51], v[40:43], v[136:139]
  v_mfma_f32_16x16x32_bf16 v[140:143], v[48:51], v[44:47], v[140:143]
  s_barrier
  ds_read_b128 v[32:35], v10 offset:40960
  s_waitcnt lgkmcnt(5)
  v_mfma_f32_16x16x32_bf16 v[96:99], v[60:63], v[80:83], v[96:99]
  ds_read_b64_tr_b16 v[52:53], v12 offset:32768
  v_mfma_f32_16x16x32_bf16 v[100:103], v[64:67], v[80:83], v[100:103]
  ds_read_b64_tr_b16 v[54:55], v12 offset:33280
  v_mfma_f32_16x16x32_bf16 v[104:107], v[68:71], v[80:83], v[104:107]
  ds_read_b128 v[36:39], v10 offset:43008
  v_mfma_f32_16x16x32_bf16 v[108:111], v[72:75], v[80:83], v[108:111]
  ds_read_b128 v[40:43], v10 offset:45056
  s_waitcnt lgkmcnt(5)
  v_mfma_f32_16x16x32_bf16 v[112:115], v[60:63], v[84:87], v[112:115]
  ds_read_b128 v[44:47], v10 offset:47104
  v_mfma_f32_16x16x32_bf16 v[116:119], v[64:67], v[84:87], v[116:119]
  ds_read_b64_tr_b16 v[56:57], v12 offset:40960
  v_mfma_f32_16x16x32_bf16 v[120:123], v[68:71], v[84:87], v[120:123]
  ds_read_b64_tr_b16 v[58:59], v12 offset:41472
  v_mfma_f32_16x16x32_bf16 v[124:127], v[72:75], v[84:87], v[124:127]
  ds_read_b64_tr_b16 v[48:49], v12 offset:24576
  v_mfma_f32_16x16x32_bf16 v[128:131], v[76:79], v[60:63], v[128:131]
  ds_read_b64_tr_b16 v[50:51], v12 offset:25088
  v_mfma_f32_16x16x32_bf16 v[132:135], v[76:79], v[64:67], v[132:135]
  v_mfma_f32_16x16x32_bf16 v[136:139], v[76:79], v[68:71], v[136:139]
  v_mfma_f32_16x16x32_bf16 v[140:143], v[76:79], v[72:75], v[140:143]
  ds_read_b128 v[60:63], v11 offset:40960
  s_waitcnt lgkmcnt(5)
  v_mfma_f32_16x16x32_bf16 v[96:99], v[32:35], v[52:55], v[96:99]
  ds_read_b64_tr_b16 v[80:81], v12 offset:36864
  v_mfma_f32_16x16x32_bf16 v[100:103], v[36:39], v[52:55], v[100:103]
  ds_read_b64_tr_b16 v[82:83], v12 offset:37376
  v_mfma_f32_16x16x32_bf16 v[104:107], v[40:43], v[52:55], v[104:107]
  ds_read_b128 v[64:67], v11 offset:43008
  v_mfma_f32_16x16x32_bf16 v[108:111], v[44:47], v[52:55], v[108:111]
  ds_read_b128 v[68:71], v11 offset:45056
  s_waitcnt lgkmcnt(5)
  v_mfma_f32_16x16x32_bf16 v[112:115], v[32:35], v[56:59], v[112:115]
  ds_read_b128 v[72:75], v11 offset:47104
  v_mfma_f32_16x16x32_bf16 v[116:119], v[36:39], v[56:59], v[116:119]
  ds_read_b64_tr_b16 v[84:85], v12 offset:45056
  v_mfma_f32_16x16x32_bf16 v[120:123], v[40:43], v[56:59], v[120:123]
  ds_read_b64_tr_b16 v[86:87], v12 offset:45568
  v_mfma_f32_16x16x32_bf16 v[124:127], v[44:47], v[56:59], v[124:127]
  ds_read_b64_tr_b16 v[76:77], v12 offset:28672
  v_mfma_f32_16x16x32_bf16 v[128:131], v[48:51], v[32:35], v[128:131]
  ds_read_b64_tr_b16 v[78:79], v12 offset:29184
  v_mfma_f32_16x16x32_bf16 v[132:135], v[48:51], v[36:39], v[132:135]
  v_mfma_f32_16x16x32_bf16 v[136:139], v[48:51], v[40:43], v[136:139]
  v_mfma_f32_16x16x32_bf16 v[140:143], v[48:51], v[44:47], v[140:143]
  s_barrier
  ds_read_b128 v[32:35], v10 offset:49152
  s_waitcnt lgkmcnt(5)
  v_mfma_f32_16x16x32_bf16 v[96:99], v[60:63], v[80:83], v[96:99]
  ds_read_b64_tr_b16 v[52:53], v13 offset:8192
  v_mfma_f32_16x16x32_bf16 v[100:103], v[64:67], v[80:83], v[100:103]
  ds_read_b64_tr_b16 v[54:55], v13 offset:8704
  v_mfma_f32_16x16x32_bf16 v[104:107], v[68:71], v[80:83], v[104:107]
  ds_read_b128 v[36:39], v10 offset:51200
  v_mfma_f32_16x16x32_bf16 v[108:111], v[72:75], v[80:83], v[108:111]
  ds_read_b128 v[40:43], v10 offset:53248
  s_waitcnt lgkmcnt(5)
  v_mfma_f32_16x16x32_bf16 v[112:115], v[60:63], v[84:87], v[112:115]
  ds_read_b128 v[44:47], v10 offset:55296
  v_mfma_f32_16x16x32_bf16 v[116:119], v[64:67], v[84:87], v[116:119]
  ds_read_b64_tr_b16 v[56:57], v13 offset:16384
  v_mfma_f32_16x16x32_bf16 v[120:123], v[68:71], v[84:87], v[120:123]
  ds_read_b64_tr_b16 v[58:59], v13 offset:16896
  v_mfma_f32_16x16x32_bf16 v[124:127], v[72:75], v[84:87], v[124:127]
  ds_read_b64_tr_b16 v[48:49], v13 offset:0
  v_mfma_f32_16x16x32_bf16 v[128:131], v[76:79], v[60:63], v[128:131]
  ds_read_b64_tr_b16 v[50:51], v13 offset:512
  v_mfma_f32_16x16x32_bf16 v[132:135], v[76:79], v[64:67], v[132:135]
  v_mfma_f32_16x16x32_bf16 v[136:139], v[76:79], v[68:71], v[136:139]
  v_mfma_f32_16x16x32_bf16 v[140:143], v[76:79], v[72:75], v[140:143]
  ds_read_b128 v[60:63], v11 offset:49152
  s_waitcnt lgkmcnt(5)
  v_mfma_f32_16x16x32_bf16 v[96:99], v[32:35], v[52:55], v[96:99]
  ds_read_b64_tr_b16 v[80:81], v13 offset:12288
  v_mfma_f32_16x16x32_bf16 v[100:103], v[36:39], v[52:55], v[100:103]
  ds_read_b64_tr_b16 v[82:83], v13 offset:12800
  v_mfma_f32_16x16x32_bf16 v[104:107], v[40:43], v[52:55], v[104:107]
  ds_read_b128 v[64:67], v11 offset:51200
  v_mfma_f32_16x16x32_bf16 v[108:111], v[44:47], v[52:55], v[108:111]
  ds_read_b128 v[68:71], v11 offset:53248
  s_waitcnt lgkmcnt(5)
  v_mfma_f32_16x16x32_bf16 v[112:115], v[32:35], v[56:59], v[112:115]
  ds_read_b128 v[72:75], v11 offset:55296
  v_mfma_f32_16x16x32_bf16 v[116:119], v[36:39], v[56:59], v[116:119]
  ds_read_b64_tr_b16 v[84:85], v13 offset:20480
  v_mfma_f32_16x16x32_bf16 v[120:123], v[40:43], v[56:59], v[120:123]
  ds_read_b64_tr_b16 v[86:87], v13 offset:20992
  v_mfma_f32_16x16x32_bf16 v[124:127], v[44:47], v[56:59], v[124:127]
  ds_read_b64_tr_b16 v[76:77], v13 offset:4096
  v_mfma_f32_16x16x32_bf16 v[128:131], v[48:51], v[32:35], v[128:131]
  ds_read_b64_tr_b16 v[78:79], v13 offset:4608
  v_mfma_f32_16x16x32_bf16 v[132:135], v[48:51], v[36:39], v[132:135]
  v_mfma_f32_16x16x32_bf16 v[136:139], v[48:51], v[40:43], v[136:139]
  v_mfma_f32_16x16x32_bf16 v[140:143], v[48:51], v[44:47], v[140:143]
  s_barrier
  ds_read_b128 v[32:35], v10 offset:57344
  s_waitcnt lgkmcnt(5)
  v_mfma_f32_16x16x32_bf16 v[96:99], v[60:63], v[80:83], v[96:99]
  ds_read_b64_tr_b16 v[52:53], v13 offset:32768
  v_mfma_f32_16x16x32_bf16 v[100:103], v[64:67], v[80:83], v[100:103]
  ds_read_b64_tr_b16 v[54:55], v13 offset:33280
  v_mfma_f32_16x16x32_bf16 v[104:107], v[68:71], v[80:83], v[104:107]
  ds_read_b128 v[36:39], v10 offset:59392
  v_mfma_f32_16x16x32_bf16 v[108:111], v[72:75], v[80:83], v[108:111]
  ds_read_b128 v[40:43], v10 offset:61440
  s_waitcnt lgkmcnt(5)
  v_mfma_f32_16x16x32_bf16 v[112:115], v[60:63], v[84:87], v[112:115]
  ds_read_b128 v[44:47], v10 offset:63488
  v_mfma_f32_16x16x32_bf16 v[116:119], v[64:67], v[84:87], v[116:119]
  ds_read_b64_tr_b16 v[56:57], v13 offset:40960
  v_mfma_f32_16x16x32_bf16 v[120:123], v[68:71], v[84:87], v[120:123]
  ds_read_b64_tr_b16 v[58:59], v13 offset:41472
  v_mfma_f32_16x16x32_bf16 v[124:127], v[72:75], v[84:87], v[124:127]
  ds_read_b64_tr_b16 v[48:49], v13 offset:24576
  v_mfma_f32_16x16x32_bf16 v[128:131], v[76:79], v[60:63], v[128:131]
  ds_read_b64_tr_b16 v[50:51], v13 offset:25088
  v_mfma_f32_16x16x32_bf16 v[132:135], v[76:79], v[64:67], v[132:135]
  v_mfma_f32_16x16x32_bf16 v[136:139], v[76:79], v[68:71], v[136:139]
  v_mfma_f32_16x16x32_bf16 v[140:143], v[76:79], v[72:75], v[140:143]
  ds_read_b128 v[60:63], v11 offset:57344
  s_waitcnt lgkmcnt(5)
  v_mfma_f32_16x16x32_bf16 v[96:99], v[32:35], v[52:55], v[96:99]
  ds_read_b64_tr_b16 v[80:81], v13 offset:36864
  v_mfma_f32_16x16x32_bf16 v[100:103], v[36:39], v[52:55], v[100:103]
  ds_read_b64_tr_b16 v[82:83], v13 offset:37376
  v_mfma_f32_16x16x32_bf16 v[104:107], v[40:43], v[52:55], v[104:107]
  ds_read_b128 v[64:67], v11 offset:59392
  v_mfma_f32_16x16x32_bf16 v[108:111], v[44:47], v[52:55], v[108:111]
  ds_read_b128 v[68:71], v11 offset:61440
  s_waitcnt lgkmcnt(5)
  v_mfma_f32_16x16x32_bf16 v[112:115], v[32:35], v[56:59], v[112:115]
  ds_read_b128 v[72:75], v11 offset:63488
  v_mfma_f32_16x16x32_bf16 v[116:119], v[36:39], v[56:59], v[116:119]
  ds_read_b64_tr_b16 v[84:85], v13 offset:45056
  v_mfma_f32_16x16x32_bf16 v[120:123], v[40:43], v[56:59], v[120:123]
  ds_read_b64_tr_b16 v[86:87], v13 offset:45568
  v_mfma_f32_16x16x32_bf16 v[124:127], v[44:47], v[56:59], v[124:127]
  ds_read_b64_tr_b16 v[76:77], v13 offset:28672
  v_mfma_f32_16x16x32_bf16 v[128:131], v[48:51], v[32:35], v[128:131]
  ds_read_b64_tr_b16 v[78:79], v13 offset:29184
  v_mfma_f32_16x16x32_bf16 v[132:135], v[48:51], v[36:39], v[132:135]
  v_mfma_f32_16x16x32_bf16 v[136:139], v[48:51], v[40:43], v[136:139]
  v_mfma_f32_16x16x32_bf16 v[140:143], v[48:51], v[44:47], v[140:143]
  s_waitcnt lgkmcnt(4)
  v_mfma_f32_16x16x32_bf16 v[96:99], v[60:63], v[80:83], v[96:99]
  s_waitcnt lgkmcnt(0)
  s_barrier
  v_mfma_f32_16x16x32_bf16 v[100:103], v[64:67], v[80:83], v[100:103]
  v_mfma_f32_16x16x32_bf16 v[104:107], v[68:71], v[80:83], v[104:107]
  v_mfma_f32_16x16x32_bf16 v[108:111], v[72:75], v[80:83], v[108:111]
  v_mfma_f32_16x16x32_bf16 v[112:115], v[60:63], v[84:87], v[112:115]
  v_mfma_f32_16x16x32_bf16 v[116:119], v[64:67], v[84:87], v[116:119]
  v_mfma_f32_16x16x32_bf16 v[120:123], v[68:71], v[84:87], v[120:123]
  v_mfma_f32_16x16x32_bf16 v[124:127], v[72:75], v[84:87], v[124:127]
  v_mfma_f32_16x16x32_bf16 v[128:131], v[76:79], v[60:63], v[128:131]
  v_mfma_f32_16x16x32_bf16 v[132:135], v[76:79], v[64:67], v[132:135]
  v_mfma_f32_16x16x32_bf16 v[136:139], v[76:79], v[68:71], v[136:139]
  v_mfma_f32_16x16x32_bf16 v[140:143], v[76:79], v[72:75], v[140:143]
  v_mov_b32 v24, 0x3fb8aa3b
  v_mov_b32 v26, 0x358637bd
  v_mov_b32 v160, 0x3f803f80
  v_mov_b32 v161, 0x3f803f80
  v_mov_b32 v162, 0x3f803f80
  v_mov_b32 v163, 0x3f803f80
  s_lshl_b32 s6, s3, 11
  s_add_u32 s6, s6, 131072
  v_add_u32 v9, s6, v1
  v_lshlrev_b32 v11, 2, v0
  v_add_u32 v10, s6, v11
  v_lshrrev_b32 v12, 2, v3
  v_lshlrev_b32 v12, 8, v12
  v_and_b32 v4, 3, v0
  v_lshl_add_u32 v12, v4, 2, v12
  v_add_u32 v12, s6, v12
  v_cvt_pk_bf16_f32 v152, v112, v113
  v_cvt_pk_bf16_f32 v153, v114, v115
  v_cvt_pk_bf16_f32 v154, v116, v117
  v_cvt_pk_bf16_f32 v155, v118, v119
  v_cvt_pk_bf16_f32 v156, v120, v121
  v_cvt_pk_bf16_f32 v157, v122, v123
  v_cvt_pk_bf16_f32 v158, v124, v125
  v_cvt_pk_bf16_f32 v159, v126, v127
  v_pk_mul_f32 v[176:177], v[96:97], v[24:25] op_sel_hi:[1,0]
  v_pk_mul_f32 v[178:179], v[98:99], v[24:25] op_sel_hi:[1,0]
  v_pk_mul_f32 v[180:181], v[100:101], v[24:25] op_sel_hi:[1,0]
  v_pk_mul_f32 v[182:183], v[102:103], v[24:25] op_sel_hi:[1,0]
  v_pk_mul_f32 v[184:185], v[104:105], v[24:25] op_sel_hi:[1,0]
  v_pk_mul_f32 v[186:187], v[106:107], v[24:25] op_sel_hi:[1,0]
  v_pk_mul_f32 v[188:189], v[108:109], v[24:25] op_sel_hi:[1,0]
  v_pk_mul_f32 v[190:191], v[110:111], v[24:25] op_sel_hi:[1,0]
  v_exp_f32 v176, v176 clamp
  v_exp_f32 v177, v177 clamp
  v_exp_f32 v178, v178 clamp
  v_exp_f32 v179, v179 clamp
  v_exp_f32 v180, v180 clamp
  v_exp_f32 v181, v181 clamp
  v_exp_f32 v182, v182 clamp
  v_exp_f32 v183, v183 clamp
  v_exp_f32 v184, v184 clamp
  v_exp_f32 v185, v185 clamp
  v_exp_f32 v186, v186 clamp
  v_exp_f32 v187, v187 clamp
  v_exp_f32 v188, v188 clamp
  v_exp_f32 v189, v189 clamp
  v_exp_f32 v190, v190 clamp
  v_exp_f32 v191, v191 clamp
  v_max_f32 v96, 0, v96
  v_max_f32 v97, 0, v97
  v_max_f32 v98, 0, v98
  v_max_f32 v99, 0, v99
  v_max_f32 v100, 0, v100
  v_max_f32 v101, 0, v101
  v_max_f32 v102, 0, v102
  v_max_f32 v103, 0, v103
  v_max_f32 v104, 0, v104
  v_max_f32 v105, 0, v105
  v_max_f32 v106, 0, v106
  v_max_f32 v107, 0, v107
  v_max_f32 v108, 0, v108
  v_max_f32 v109, 0, v109
  v_max_f32 v110, 0, v110
  v_max_f32 v111, 0, v111
  v_pk_add_f32 v[176:177], v[176:177], v[26:27] op_sel_hi:[1,0]
  v_pk_add_f32 v[178:179], v[178:179], v[26:27] op_sel_hi:[1,0]
  v_pk_add_f32 v[180:181], v[180:181], v[26:27] op_sel_hi:[1,0]
  v_pk_add_f32 v[182:183], v[182:183], v[26:27] op_sel_hi:[1,0]
  v_pk_add_f32 v[184:185], v[184:185], v[26:27] op_sel_hi:[1,0]
  v_pk_add_f32 v[186:187], v[186:187], v[26:27] op_sel_hi:[1,0]
  v_pk_add_f32 v[188:189], v[188:189], v[26:27] op_sel_hi:[1,0]
  v_pk_add_f32 v[190:191], v[190:191], v[26:27] op_sel_hi:[1,0]
  v_pk_add_f32 v[96:97], v[96:97], v[176:177]
  v_pk_add_f32 v[98:99], v[98:99], v[178:179]
  v_pk_add_f32 v[100:101], v[100:101], v[180:181]
  v_pk_add_f32 v[102:103], v[102:103], v[182:183]
  v_pk_add_f32 v[104:105], v[104:105], v[184:185]
  v_pk_add_f32 v[106:107], v[106:107], v[186:187]
  v_pk_add_f32 v[108:109], v[108:109], v[188:189]
  v_pk_add_f32 v[110:111], v[110:111], v[190:191]
  v_cvt_pk_bf16_f32 v144, v96, v97
  v_cvt_pk_bf16_f32 v145, v98, v99
  v_cvt_pk_bf16_f32 v146, v100, v101
  v_cvt_pk_bf16_f32 v147, v102, v103
  v_cvt_pk_bf16_f32 v148, v104, v105
  v_cvt_pk_bf16_f32 v149, v106, v107
  v_cvt_pk_bf16_f32 v150, v108, v109
  v_cvt_pk_bf16_f32 v151, v110, v111
  v_mfma_f32_16x16x32_bf16 v[164:167], v[144:147], v[152:155], 0
  v_mfma_f32_16x16x32_bf16 v[168:171], v[144:147], v[160:163], 0
  v_mfma_f32_16x16x32_bf16 v[164:167], v[148:151], v[156:159], v[164:167]
  v_mfma_f32_16x16x32_bf16 v[168:171], v[148:151], v[160:163], v[168:171]
  s_lshl_b32 s6, s71, 2
  s_add_u32 s6, s6, s3
  s_lshl_b32 s50, s6, 10
  s_lshl_b32 s52, s70, 16
  s_add_u32 s52, s52, s50
  s_add_u32 s52, s52, 0x0
  s_add_u32 s53, s52, 0x8000
  s_add_u32 s50, s50, 0xb00000
  s_lshl_b32 s51, s6, 6
  s_add_u32 s51, s51, 0xb08000
  v_pk_mul_f32 v[176:177], v[128:129], v[24:25] op_sel_hi:[1,0]
  v_pk_mul_f32 v[178:179], v[130:131], v[24:25] op_sel_hi:[1,0]
  v_pk_mul_f32 v[180:181], v[132:133], v[24:25] op_sel_hi:[1,0]
  v_pk_mul_f32 v[182:183], v[134:135], v[24:25] op_sel_hi:[1,0]
  v_pk_mul_f32 v[184:185], v[136:137], v[24:25] op_sel_hi:[1,0]
  v_pk_mul_f32 v[186:187], v[138:139], v[24:25] op_sel_hi:[1,0]
  v_pk_mul_f32 v[188:189], v[140:141], v[24:25] op_sel_hi:[1,0]
  v_pk_mul_f32 v[190:191], v[142:143], v[24:25] op_sel_hi:[1,0]
  ds_write_b128 v9, v[164:167]
  ds_write_b128 v9, v[168:171] offset:1024
  ds_read_b32 v172, v10 offset:0
  ds_read_b32 v173, v10 offset:256
  ds_read_b32 v174, v10 offset:512
  ds_read_b32 v175, v10 offset:768
  ds_read_b32 v13, v12 offset:1024
  v_exp_f32 v176, v176 clamp
  v_exp_f32 v177, v177 clamp
  v_exp_f32 v178, v178 clamp
  v_exp_f32 v179, v179 clamp
  v_exp_f32 v180, v180 clamp
  v_exp_f32 v181, v181 clamp
  v_exp_f32 v182, v182 clamp
  v_exp_f32 v183, v183 clamp
  v_exp_f32 v184, v184 clamp
  v_exp_f32 v185, v185 clamp
  v_exp_f32 v186, v186 clamp
  v_exp_f32 v187, v187 clamp
  v_exp_f32 v188, v188 clamp
  v_exp_f32 v189, v189 clamp
  v_exp_f32 v190, v190 clamp
  v_exp_f32 v191, v191 clamp
  s_waitcnt lgkmcnt(0)
  buffer_atomic_add_f32 v172, v11, s[36:39], s50 offen offset:0
  buffer_atomic_add_f32 v173, v11, s[36:39], s50 offen offset:256
  buffer_atomic_add_f32 v174, v11, s[36:39], s50 offen offset:512
  buffer_atomic_add_f32 v175, v11, s[36:39], s50 offen offset:768
  s_mov_b64 exec, 0xffff
  buffer_atomic_add_f32 v13, v11, s[36:39], s51 offen
  s_mov_b64 exec, -1
  v_max_f32 v128, 0, v128
  v_max_f32 v129, 0, v129
  v_max_f32 v130, 0, v130
  v_max_f32 v131, 0, v131
  v_max_f32 v132, 0, v132
  v_max_f32 v133, 0, v133
  v_max_f32 v134, 0, v134
  v_max_f32 v135, 0, v135
  v_max_f32 v136, 0, v136
  v_max_f32 v137, 0, v137
  v_max_f32 v138, 0, v138
  v_max_f32 v139, 0, v139
  v_max_f32 v140, 0, v140
  v_max_f32 v141, 0, v141
  v_max_f32 v142, 0, v142
  v_max_f32 v143, 0, v143
  v_pk_add_f32 v[176:177], v[176:177], v[26:27] op_sel_hi:[1,0]
  v_pk_add_f32 v[178:179], v[178:179], v[26:27] op_sel_hi:[1,0]
  v_pk_add_f32 v[180:181], v[180:181], v[26:27] op_sel_hi:[1,0]
  v_pk_add_f32 v[182:183], v[182:183], v[26:27] op_sel_hi:[1,0]
  v_pk_add_f32 v[184:185], v[184:185], v[26:27] op_sel_hi:[1,0]
  v_pk_add_f32 v[186:187], v[186:187], v[26:27] op_sel_hi:[1,0]
  v_pk_add_f32 v[188:189], v[188:189], v[26:27] op_sel_hi:[1,0]
  v_pk_add_f32 v[190:191], v[190:191], v[26:27] op_sel_hi:[1,0]
  v_pk_add_f32 v[128:129], v[128:129], v[176:177]
  v_pk_add_f32 v[130:131], v[130:131], v[178:179]
  v_pk_add_f32 v[132:133], v[132:133], v[180:181]
  v_pk_add_f32 v[134:135], v[134:135], v[182:183]
  v_pk_add_f32 v[136:137], v[136:137], v[184:185]
  v_pk_add_f32 v[138:139], v[138:139], v[186:187]
  v_pk_add_f32 v[140:141], v[140:141], v[188:189]
  v_pk_add_f32 v[142:143], v[142:143], v[190:191]
  v_cvt_pk_bf16_f32 v144, v128, v129
  v_cvt_pk_bf16_f32 v145, v130, v131
  v_cvt_pk_bf16_f32 v146, v132, v133
  v_cvt_pk_bf16_f32 v147, v134, v135
  v_cvt_pk_bf16_f32 v148, v136, v137
  v_cvt_pk_bf16_f32 v149, v138, v139
  v_cvt_pk_bf16_f32 v150, v140, v141
  v_cvt_pk_bf16_f32 v151, v142, v143
  buffer_store_dwordx4 v[144:147], v1, s[36:39], s52 offen sc1
  buffer_store_dwordx4 v[148:151], v1, s[36:39], s53 offen sc1
  s_lshr_b32 s50, s2, 4
  s_lshl_b32 s51, s70, 3
  s_add_u32 s51, s51, s71
  s_lshl_b32 s51, s51, 7
  s_add_u32 s51, s51, 0xb34000
  s_lshl_b32 s50, s50, 7
  s_add_u32 s50, s50, 0xb1a000
  v_mov_b32 v4, 1
  v_mov_b32 v5, 0
  s_waitcnt vmcnt(0)
  s_barrier
  s_cmp_eq_u32 s3, 0
  s_cbranch_scc0 L_skip5
  s_mov_b64 exec, 1
  buffer_store_dword v4, v5, s[36:39], s51 offen sc1
  buffer_atomic_add v4, v5, s[36:39], s50 offen sc0
  s_waitcnt vmcnt(0)
  v_readfirstlane_b32 s6, v4
  v_mov_b32 v4, 1
  s_cmp_eq_u32 s6, 15
  s_cbranch_scc0 L_skip6
  buffer_store_dword v4, v5, s[36:39], s50 offen offset:2048 sc1
L_skip6:
  s_mov_b64 exec, -1
L_skip5:
  s_lshl_b32 s48, s4, 3
  s_and_b32 s6, s5, 7
  s_add_u32 s48, s48, s6
  s_lshr_b32 s49, s5, 3
  v_lshlrev_b32 v4, 10, v3
  v_lshl_add_u32 v4, v2, 4, v4
  s_lshl_b32 s6, s48, 15
  s_lshl_b32 s7, s49, 8
  s_add_u32 s6, s6, s7
  s_lshl_b32 s7, s3, 6
  s_add_u32 s6, s6, s7
  s_add_u32 s7, s6, 0x4000
  buffer_load_dwordx4 v[240:243], v4, s[8:11], s6 offen
  buffer_load_dwordx4 v[244:247], v4, s[8:11], s7 offen
  v_lshrrev_b32 v8, 2, v3
  v_lshlrev_b32 v8, 6, v8
  v_lshl_add_u32 v8, v2, 4, v8
  s_lshl_b32 s6, s3, 13
  s_add_u32 s50, s6, 0xb00000
  s_add_u32 s51, s50, 4096
  s_lshl_b32 s52, s48, 15
  s_add_u32 s52, s52, s6
  s_add_u32 s52, s52, 0x0
  s_add_u32 s53, s52, 4096
  s_lshl_b32 s54, s3, 9
  s_add_u32 s54, s54, 0xb08000
  s_mov_b32 s55, 0xb1a800
  s_lshl_b32 s6, s3, 12
  s_add_u32 s6, s6, 131072
  v_add_u32 v9, s6, v1
  v_add_u32 v10, 131072, v1
  v_lshrrev_b32 v4, 2, v0
  v_and_b32 v5, 3, v0
  v_lshlrev_b32 v5, 3, v5
  v_lshl_add_u32 v5, v4, 8, v5
  v_and_b32 v4, 7, v4
  s_lshl_b32 s6, s3, 1
  v_xor_b32 v4, s6, v4
  v_lshl_add_u32 v12, v4, 5, v5
  v_xor_b32 v13, 32, v12
  v_add_u32 v14, 0x10000, v12
  v_add_u32 v15, 0x10000, v13
  v_lshlrev_b32 v11, 3, v3
  v_lshrrev_b32 v4, 5, v0
  v_lshl_add_u32 v11, v4, 2, v11
  v_mov_b32 v16, 0x358637bd
  v_mov_b32 v17, 0x358637bd
  v_mov_b32 v18, 0x358637bd
  v_mov_b32 v19, 0x358637bd
  s_lshr_b32 s56, s48, 1
  s_lshl_b32 s56, s56, 10
  s_add_u32 s56, s56, 0xb34000
  s_cmp_eq_u32 s3, 0
  s_cbranch_scc0 L_skip7
  v_lshlrev_b32 v5, 7, v0
  s_mov_b32 exec_lo, 0xff
  s_mov_b32 exec_hi, 0
  s_mov_b32 s6, 131072
L_pollQ:
  buffer_load_dword v4, v5, s[36:39], s56 offen sc1
  s_sub_u32 s6, s6, 1
  s_cbranch_scc1 L_pollxQ
  s_waitcnt vmcnt(0)
  v_cmp_eq_u32 vcc, 0, v4
  s_nop 4
  s_cbranch_vccz L_pollxQ
  s_branch L_pollQ
L_pollxQ:
  s_mov_b64 exec, -1
L_skip7:
  s_barrier
  buffer_load_dwordx4 v[64:67], v1, s[36:39], s52 offen offset:0 sc1
  buffer_load_dwordx4 v[68:71], v1, s[36:39], s52 offen offset:1024 sc1
  buffer_load_dwordx4 v[72:75], v1, s[36:39], s52 offen offset:2048 sc1
  buffer_load_dwordx4 v[76:79], v1, s[36:39], s52 offen offset:3072 sc1
  buffer_load_dwordx4 v[80:83], v1, s[36:39], s53 offen offset:0 sc1
  buffer_load_dwordx4 v[84:87], v1, s[36:39], s53 offen offset:1024 sc1
  buffer_load_dwordx4 v[88:91], v1, s[36:39], s53 offen offset:2048 sc1
  buffer_load_dwordx4 v[92:95], v1, s[36:39], s53 offen offset:3072 sc1
  s_cmp_eq_u32 s3, 0
  s_cbranch_scc0 L_skip8
  v_lshlrev_b32 v5, 7, v0
  s_mov_b32 exec_lo, 0xffff
  s_mov_b32 exec_hi, 0
  s_mov_b32 s6, 131072
L_pollS1:
  buffer_load_dword v4, v5, s[36:39], s55 offen sc1
  s_sub_u32 s6, s6, 1
  s_cbranch_scc1 L_pollxS1
  s_waitcnt vmcnt(0)
  v_cmp_eq_u32 vcc, 0, v4
  s_nop 4
  s_cbranch_vccz L_pollxS1
  s_branch L_pollS1
L_pollxS1:
  s_mov_b64 exec, -1
L_skip8:
  s_barrier
  buffer_load_dwordx4 v[96:99], v8, s[36:39], s54 offen offset:0 sc1
  buffer_load_dwordx4 v[100:103], v8, s[36:39], s54 offen offset:256 sc1
  buffer_load_dwordx4 v[32:35], v1, s[36:39], s50 offen offset:0 sc1
  buffer_load_dwordx4 v[36:39], v1, s[36:39], s50 offen offset:1024 sc1
  buffer_load_dwordx4 v[40:43], v1, s[36:39], s50 offen offset:2048 sc1
  buffer_load_dwordx4 v[44:47], v1, s[36:39], s50 offen offset:3072 sc1
  buffer_load_dwordx4 v[48:51], v1, s[36:39], s51 offen offset:0 sc1
  buffer_load_dwordx4 v[52:55], v1, s[36:39], s51 offen offset:1024 sc1
  buffer_load_dwordx4 v[56:59], v1, s[36:39], s51 offen offset:2048 sc1
  buffer_load_dwordx4 v[60:63], v1, s[36:39], s51 offen offset:3072 sc1
  s_barrier
  s_waitcnt vmcnt(8)
  v_cvt_pk_bf16_f32 v96, v96, v97
  v_cvt_pk_bf16_f32 v97, v98, v99
  v_cvt_pk_bf16_f32 v100, v100, v101
  v_cvt_pk_bf16_f32 v101, v102, v103
  v_mov_b32_dpp v104, v96 row_newbcast:0 row_mask:0xf bank_mask:0xf
  v_mov_b32_dpp v105, v97 row_newbcast:0 row_mask:0xf bank_mask:0xf
  v_mov_b32_dpp v106, v96 row_newbcast:4 row_mask:0xf bank_mask:0xf
  v_mov_b32_dpp v107, v97 row_newbcast:4 row_mask:0xf bank_mask:0xf
  v_mov_b32_dpp v108, v96 row_newbcast:8 row_mask:0xf bank_mask:0xf
  v_mov_b32_dpp v109, v97 row_newbcast:8 row_mask:0xf bank_mask:0xf
  v_mov_b32_dpp v110, v96 row_newbcast:12 row_mask:0xf bank_mask:0xf
  v_mov_b32_dpp v111, v97 row_newbcast:12 row_mask:0xf bank_mask:0xf
  v_mov_b32_dpp v112, v100 row_newbcast:0 row_mask:0xf bank_mask:0xf
  v_mov_b32_dpp v113, v101 row_newbcast:0 row_mask:0xf bank_mask:0xf
  v_mov_b32_dpp v114, v100 row_newbcast:4 row_mask:0xf bank_mask:0xf
  v_mov_b32_dpp v115, v101 row_newbcast:4 row_mask:0xf bank_mask:0xf
  v_mov_b32_dpp v116, v100 row_newbcast:8 row_mask:0xf bank_mask:0xf
  v_mov_b32_dpp v117, v101 row_newbcast:8 row_mask:0xf bank_mask:0xf
  v_mov_b32_dpp v118, v100 row_newbcast:12 row_mask:0xf bank_mask:0xf
  v_mov_b32_dpp v119, v101 row_newbcast:12 row_mask:0xf bank_mask:0xf
  s_waitcnt vmcnt(7)
  v_cvt_pk_bf16_f32 v120, v32, v33
  v_cvt_pk_bf16_f32 v121, v34, v35
  v_mfma_f32_16x16x16_bf16 v[140:143], v[104:105], v[64:65], v[16:19]
  v_mfma_f32_16x16x16_bf16 v[148:151], v[104:105], v[66:67], v[16:19]
  v_mfma_f32_16x16x16_bf16 v[136:139], v[120:121], v[64:65], 0
  v_mfma_f32_16x16x16_bf16 v[144:147], v[120:121], v[66:67], 0
  s_waitcnt vmcnt(6)
  v_cvt_pk_bf16_f32 v122, v36, v37
  v_cvt_pk_bf16_f32 v123, v38, v39
  v_mfma_f32_16x16x16_bf16 v[156:159], v[106:107], v[68:69], v[16:19]
  v_mfma_f32_16x16x16_bf16 v[164:167], v[106:107], v[70:71], v[16:19]
  v_mfma_f32_16x16x16_bf16 v[152:155], v[122:123], v[68:69], 0
  v_mfma_f32_16x16x16_bf16 v[160:163], v[122:123], v[70:71], 0
  s_waitcnt vmcnt(5)
  v_cvt_pk_bf16_f32 v124, v40, v41
  v_cvt_pk_bf16_f32 v125, v42, v43
  v_mfma_f32_16x16x16_bf16 v[172:175], v[108:109], v[72:73], v[16:19]
  v_mfma_f32_16x16x16_bf16 v[180:183], v[108:109], v[74:75], v[16:19]
  v_mfma_f32_16x16x16_bf16 v[168:171], v[124:125], v[72:73], 0
  v_mfma_f32_16x16x16_bf16 v[176:179], v[124:125], v[74:75], 0
  s_waitcnt vmcnt(4)
  v_cvt_pk_bf16_f32 v126, v44, v45
  v_cvt_pk_bf16_f32 v127, v46, v47
  v_mfma_f32_16x16x16_bf16 v[188:191], v[110:111], v[76:77], v[16:19]
  v_mfma_f32_16x16x16_bf16 v[196:199], v[110:111], v[78:79], v[16:19]
  v_mfma_f32_16x16x16_bf16 v[184:187], v[126:127], v[76:77], 0
  v_mfma_f32_16x16x16_bf16 v[192:195], v[126:127], v[78:79], 0
  v_rcp_f32 v140, v140
  v_rcp_f32 v148, v148
  v_rcp_f32 v156, v156
  v_rcp_f32 v164, v164
  v_pk_mul_f32 v[136:137], v[136:137], v[140:141] op_sel_hi:[1,0]
  v_pk_mul_f32 v[138:139], v[138:139], v[140:141] op_sel_hi:[1,0]
  v_pk_mul_f32 v[144:145], v[144:145], v[148:149] op_sel_hi:[1,0]
  v_pk_mul_f32 v[146:147], v[146:147], v[148:149] op_sel_hi:[1,0]
  v_pk_mul_f32 v[152:153], v[152:153], v[156:157] op_sel_hi:[1,0]
  v_pk_mul_f32 v[154:155], v[154:155], v[156:157] op_sel_hi:[1,0]
  v_pk_mul_f32 v[160:161], v[160:161], v[164:165] op_sel_hi:[1,0]
  v_pk_mul_f32 v[162:163], v[162:163], v[164:165] op_sel_hi:[1,0]
  v_cvt_pk_bf16_f32 v200, v136, v137
  v_cvt_pk_bf16_f32 v201, v138, v139
  v_cvt_pk_bf16_f32 v202, v152, v153
  v_cvt_pk_bf16_f32 v203, v154, v155
  ds_write_b128 v9, v[200:203] offset:0
  v_cvt_pk_bf16_f32 v204, v144, v145
  v_cvt_pk_bf16_f32 v205, v146, v147
  v_cvt_pk_bf16_f32 v206, v160, v161
  v_cvt_pk_bf16_f32 v207, v162, v163
  ds_write_b128 v9, v[204:207] offset:16384
  s_waitcnt vmcnt(3)
  v_cvt_pk_bf16_f32 v128, v48, v49
  v_cvt_pk_bf16_f32 v129, v50, v51
  v_mfma_f32_16x16x16_bf16 v[140:143], v[112:113], v[80:81], v[16:19]
  v_mfma_f32_16x16x16_bf16 v[148:151], v[112:113], v[82:83], v[16:19]
  v_mfma_f32_16x16x16_bf16 v[136:139], v[128:129], v[80:81], 0
  v_mfma_f32_16x16x16_bf16 v[144:147], v[128:129], v[82:83], 0
  s_waitcnt vmcnt(2)
  v_cvt_pk_bf16_f32 v130, v52, v53
  v_cvt_pk_bf16_f32 v131, v54, v55
  v_mfma_f32_16x16x16_bf16 v[156:159], v[114:115], v[84:85], v[16:19]
  v_mfma_f32_16x16x16_bf16 v[164:167], v[114:115], v[86:87], v[16:19]
  v_mfma_f32_16x16x16_bf16 v[152:155], v[130:131], v[84:85], 0
  v_mfma_f32_16x16x16_bf16 v[160:163], v[130:131], v[86:87], 0
  v_rcp_f32 v172, v172
  v_rcp_f32 v180, v180
  v_rcp_f32 v188, v188
  v_rcp_f32 v196, v196
  v_pk_mul_f32 v[168:169], v[168:169], v[172:173] op_sel_hi:[1,0]
  v_pk_mul_f32 v[170:171], v[170:171], v[172:173] op_sel_hi:[1,0]
  v_pk_mul_f32 v[176:177], v[176:177], v[180:181] op_sel_hi:[1,0]
  v_pk_mul_f32 v[178:179], v[178:179], v[180:181] op_sel_hi:[1,0]
  v_pk_mul_f32 v[184:185], v[184:185], v[188:189] op_sel_hi:[1,0]
  v_pk_mul_f32 v[186:187], v[186:187], v[188:189] op_sel_hi:[1,0]
  v_pk_mul_f32 v[192:193], v[192:193], v[196:197] op_sel_hi:[1,0]
  v_pk_mul_f32 v[194:195], v[194:195], v[196:197] op_sel_hi:[1,0]
  v_cvt_pk_bf16_f32 v208, v168, v169
  v_cvt_pk_bf16_f32 v209, v170, v171
  v_cvt_pk_bf16_f32 v210, v184, v185
  v_cvt_pk_bf16_f32 v211, v186, v187
  ds_write_b128 v9, v[208:211] offset:1024
  v_cvt_pk_bf16_f32 v212, v176, v177
  v_cvt_pk_bf16_f32 v213, v178, v179
  v_cvt_pk_bf16_f32 v214, v192, v193
  v_cvt_pk_bf16_f32 v215, v194, v195
  ds_write_b128 v9, v[212:215] offset:17408
  s_waitcnt vmcnt(1)
  v_cvt_pk_bf16_f32 v132, v56, v57
  v_cvt_pk_bf16_f32 v133, v58, v59
  v_mfma_f32_16x16x16_bf16 v[172:175], v[116:117], v[88:89], v[16:19]
  v_mfma_f32_16x16x16_bf16 v[180:183], v[116:117], v[90:91], v[16:19]
  v_mfma_f32_16x16x16_bf16 v[168:171], v[132:133], v[88:89], 0
  v_mfma_f32_16x16x16_bf16 v[176:179], v[132:133], v[90:91], 0
  s_waitcnt vmcnt(0)
  v_cvt_pk_bf16_f32 v134, v60, v61
  v_cvt_pk_bf16_f32 v135, v62, v63
  v_mfma_f32_16x16x16_bf16 v[188:191], v[118:119], v[92:93], v[16:19]
  v_mfma_f32_16x16x16_bf16 v[196:199], v[118:119], v[94:95], v[16:19]
  v_mfma_f32_16x16x16_bf16 v[184:187], v[134:135], v[92:93], 0
  v_mfma_f32_16x16x16_bf16 v[192:195], v[134:135], v[94:95], 0
  v_rcp_f32 v140, v140
  v_rcp_f32 v148, v148
  v_rcp_f32 v156, v156
  v_rcp_f32 v164, v164
  v_pk_mul_f32 v[136:137], v[136:137], v[140:141] op_sel_hi:[1,0]
  v_pk_mul_f32 v[138:139], v[138:139], v[140:141] op_sel_hi:[1,0]
  v_pk_mul_f32 v[144:145], v[144:145], v[148:149] op_sel_hi:[1,0]
  v_pk_mul_f32 v[146:147], v[146:147], v[148:149] op_sel_hi:[1,0]
  v_pk_mul_f32 v[152:153], v[152:153], v[156:157] op_sel_hi:[1,0]
  v_pk_mul_f32 v[154:155], v[154:155], v[156:157] op_sel_hi:[1,0]
  v_pk_mul_f32 v[160:161], v[160:161], v[164:165] op_sel_hi:[1,0]
  v_pk_mul_f32 v[162:163], v[162:163], v[164:165] op_sel_hi:[1,0]
  v_cvt_pk_bf16_f32 v200, v136, v137
  v_cvt_pk_bf16_f32 v201, v138, v139
  v_cvt_pk_bf16_f32 v202, v152, v153
  v_cvt_pk_bf16_f32 v203, v154, v155
  ds_write_b128 v9, v[200:203] offset:2048
  v_cvt_pk_bf16_f32 v204, v144, v145
  v_cvt_pk_bf16_f32 v205, v146, v147
  v_cvt_pk_bf16_f32 v206, v160, v161
  v_cvt_pk_bf16_f32 v207, v162, v163
  ds_write_b128 v9, v[204:207] offset:18432
  v_rcp_f32 v172, v172
  v_rcp_f32 v180, v180
  v_rcp_f32 v188, v188
  v_rcp_f32 v196, v196
  v_pk_mul_f32 v[168:169], v[168:169], v[172:173] op_sel_hi:[1,0]
  v_pk_mul_f32 v[170:171], v[170:171], v[172:173] op_sel_hi:[1,0]
  v_pk_mul_f32 v[176:177], v[176:177], v[180:181] op_sel_hi:[1,0]
  v_pk_mul_f32 v[178:179], v[178:179], v[180:181] op_sel_hi:[1,0]
  v_pk_mul_f32 v[184:185], v[184:185], v[188:189] op_sel_hi:[1,0]
  v_pk_mul_f32 v[186:187], v[186:187], v[188:189] op_sel_hi:[1,0]
  v_pk_mul_f32 v[192:193], v[192:193], v[196:197] op_sel_hi:[1,0]
  v_pk_mul_f32 v[194:195], v[194:195], v[196:197] op_sel_hi:[1,0]
  v_cvt_pk_bf16_f32 v208, v168, v169
  v_cvt_pk_bf16_f32 v209, v170, v171
  v_cvt_pk_bf16_f32 v210, v184, v185
  v_cvt_pk_bf16_f32 v211, v186, v187
  ds_write_b128 v9, v[208:211] offset:3072
  v_cvt_pk_bf16_f32 v212, v176, v177
  v_cvt_pk_bf16_f32 v213, v178, v179
  v_cvt_pk_bf16_f32 v214, v192, v193
  v_cvt_pk_bf16_f32 v215, v194, v195
  ds_write_b128 v9, v[212:215] offset:19456
  s_waitcnt lgkmcnt(0)
  s_barrier
  ds_read_b128 v[32:35], v10 offset:0
  ds_read_b128 v[36:39], v10 offset:16384
  ds_read_b64_tr_b16 v[40:41], v12 offset:0
  ds_read_b64_tr_b16 v[42:43], v12 offset:4096
  ds_read_b64_tr_b16 v[44:45], v13 offset:0
  ds_read_b64_tr_b16 v[46:47], v13 offset:4096
  ds_read_b128 v[48:51], v10 offset:1024
  ds_read_b128 v[52:55], v10 offset:17408
  ds_read_b64_tr_b16 v[56:57], v12 offset:8192
  ds_read_b64_tr_b16 v[58:59], v12 offset:12288
  ds_read_b64_tr_b16 v[60:61], v13 offset:8192
  ds_read_b64_tr_b16 v[62:63], v13 offset:12288
  v_permlane16_swap_b32 v240, v242
  v_permlane16_swap_b32 v241, v243
  v_permlane16_swap_b32 v244, v246
  v_permlane16_swap_b32 v245, v247
  v_permlane32_swap_b32 v240, v242
  v_permlane32_swap_b32 v241, v243
  v_permlane32_swap_b32 v244, v246
  v_permlane32_swap_b32 v245, v247
  v_lshlrev_b32 v112, 16, v240
  v_and_b32 v113, 0xffff0000, v240
  v_lshlrev_b32 v114, 16, v241
  v_and_b32 v115, 0xffff0000, v241
  v_lshlrev_b32 v116, 16, v242
  v_and_b32 v117, 0xffff0000, v242
  v_lshlrev_b32 v118, 16, v243
  v_and_b32 v119, 0xffff0000, v243
  v_lshlrev_b32 v120, 16, v244
  v_and_b32 v121, 0xffff0000, v244
  v_lshlrev_b32 v122, 16, v245
  v_and_b32 v123, 0xffff0000, v245
  v_lshlrev_b32 v124, 16, v246
  v_and_b32 v125, 0xffff0000, v246
  v_lshlrev_b32 v126, 16, v247
  v_and_b32 v127, 0xffff0000, v247
  ds_read_b128 v[64:67], v10 offset:2048
  ds_read_b128 v[68:71], v10 offset:18432
  s_waitcnt lgkmcnt(8)
  v_mfma_f32_16x16x32_bf16 v[96:99], v[40:43], v[32:35], 0
  ds_read_b64_tr_b16 v[72:73], v12 offset:16384
  v_mfma_f32_16x16x32_bf16 v[104:107], v[40:43], v[36:39], 0
  ds_read_b64_tr_b16 v[74:75], v12 offset:20480
  ds_read_b64_tr_b16 v[76:77], v13 offset:16384
  v_mfma_f32_16x16x32_bf16 v[100:103], v[44:47], v[32:35], 0
  ds_read_b64_tr_b16 v[78:79], v13 offset:20480
  v_mfma_f32_16x16x32_bf16 v[108:111], v[44:47], v[36:39], 0
  ds_read_b128 v[32:35], v10 offset:3072
  ds_read_b128 v[36:39], v10 offset:19456
  s_waitcnt lgkmcnt(8)
  v_mfma_f32_16x16x32_bf16 v[96:99], v[56:59], v[48:51], v[96:99]
  ds_read_b64_tr_b16 v[40:41], v12 offset:24576
  v_mfma_f32_16x16x32_bf16 v[104:107], v[56:59], v[52:55], v[104:107]
  ds_read_b64_tr_b16 v[42:43], v12 offset:28672
  ds_read_b64_tr_b16 v[44:45], v13 offset:24576
  v_mfma_f32_16x16x32_bf16 v[100:103], v[60:63], v[48:51], v[100:103]
  ds_read_b64_tr_b16 v[46:47], v13 offset:28672
  v_mfma_f32_16x16x32_bf16 v[108:111], v[60:63], v[52:55], v[108:111]
  ds_read_b128 v[48:51], v10 offset:4096
  ds_read_b128 v[52:55], v10 offset:20480
  s_waitcnt lgkmcnt(8)
  v_mfma_f32_16x16x32_bf16 v[96:99], v[72:75], v[64:67], v[96:99]
  ds_read_b64_tr_b16 v[56:57], v12 offset:32768
  v_mfma_f32_16x16x32_bf16 v[104:107], v[72:75], v[68:71], v[104:107]
  ds_read_b64_tr_b16 v[58:59], v12 offset:36864
  ds_read_b64_tr_b16 v[60:61], v13 offset:32768
  v_mfma_f32_16x16x32_bf16 v[100:103], v[76:79], v[64:67], v[100:103]
  ds_read_b64_tr_b16 v[62:63], v13 offset:36864
  v_mfma_f32_16x16x32_bf16 v[108:111], v[76:79], v[68:71], v[108:111]
  ds_read_b128 v[64:67], v10 offset:5120
  ds_read_b128 v[68:71], v10 offset:21504
  s_waitcnt lgkmcnt(8)
  v_mfma_f32_16x16x32_bf16 v[96:99], v[40:43], v[32:35], v[96:99]
  ds_read_b64_tr_b16 v[72:73], v12 offset:40960
  v_mfma_f32_16x16x32_bf16 v[104:107], v[40:43], v[36:39], v[104:107]
  ds_read_b64_tr_b16 v[74:75], v12 offset:45056
  ds_read_b64_tr_b16 v[76:77], v13 offset:40960
  v_mfma_f32_16x16x32_bf16 v[100:103], v[44:47], v[32:35], v[100:103]
  ds_read_b64_tr_b16 v[78:79], v13 offset:45056
  v_mfma_f32_16x16x32_bf16 v[108:111], v[44:47], v[36:39], v[108:111]
  ds_read_b128 v[32:35], v10 offset:6144
  ds_read_b128 v[36:39], v10 offset:22528
  s_waitcnt lgkmcnt(8)
  v_mfma_f32_16x16x32_bf16 v[96:99], v[56:59], v[48:51], v[96:99]
  ds_read_b64_tr_b16 v[40:41], v12 offset:49152
  v_mfma_f32_16x16x32_bf16 v[104:107], v[56:59], v[52:55], v[104:107]
  ds_read_b64_tr_b16 v[42:43], v12 offset:53248
  ds_read_b64_tr_b16 v[44:45], v13 offset:49152
  v_mfma_f32_16x16x32_bf16 v[100:103], v[60:63], v[48:51], v[100:103]
  ds_read_b64_tr_b16 v[46:47], v13 offset:53248
  v_mfma_f32_16x16x32_bf16 v[108:111], v[60:63], v[52:55], v[108:111]
  ds_read_b128 v[48:51], v10 offset:7168
  ds_read_b128 v[52:55], v10 offset:23552
  s_waitcnt lgkmcnt(8)
  v_mfma_f32_16x16x32_bf16 v[96:99], v[72:75], v[64:67], v[96:99]
  ds_read_b64_tr_b16 v[56:57], v12 offset:57344
  v_mfma_f32_16x16x32_bf16 v[104:107], v[72:75], v[68:71], v[104:107]
  ds_read_b64_tr_b16 v[58:59], v12 offset:61440
  ds_read_b64_tr_b16 v[60:61], v13 offset:57344
  v_mfma_f32_16x16x32_bf16 v[100:103], v[76:79], v[64:67], v[100:103]
  ds_read_b64_tr_b16 v[62:63], v13 offset:61440
  v_mfma_f32_16x16x32_bf16 v[108:111], v[76:79], v[68:71], v[108:111]
  ds_read_b128 v[64:67], v10 offset:8192
  ds_read_b128 v[68:71], v10 offset:24576
  s_waitcnt lgkmcnt(8)
  v_mfma_f32_16x16x32_bf16 v[96:99], v[40:43], v[32:35], v[96:99]
  ds_read_b64_tr_b16 v[72:73], v14 offset:0
  v_mfma_f32_16x16x32_bf16 v[104:107], v[40:43], v[36:39], v[104:107]
  ds_read_b64_tr_b16 v[74:75], v14 offset:4096
  ds_read_b64_tr_b16 v[76:77], v15 offset:0
  v_mfma_f32_16x16x32_bf16 v[100:103], v[44:47], v[32:35], v[100:103]
  ds_read_b64_tr_b16 v[78:79], v15 offset:4096
  v_mfma_f32_16x16x32_bf16 v[108:111], v[44:47], v[36:39], v[108:111]
  ds_read_b128 v[32:35], v10 offset:9216
  ds_read_b128 v[36:39], v10 offset:25600
  s_waitcnt lgkmcnt(8)
  v_mfma_f32_16x16x32_bf16 v[96:99], v[56:59], v[48:51], v[96:99]
  ds_read_b64_tr_b16 v[40:41], v14 offset:8192
  v_mfma_f32_16x16x32_bf16 v[104:107], v[56:59], v[52:55], v[104:107]
  ds_read_b64_tr_b16 v[42:43], v14 offset:12288
  ds_read_b64_tr_b16 v[44:45], v15 offset:8192
  v_mfma_f32_16x16x32_bf16 v[100:103], v[60:63], v[48:51], v[100:103]
  ds_read_b64_tr_b16 v[46:47], v15 offset:12288
  v_mfma_f32_16x16x32_bf16 v[108:111], v[60:63], v[52:55], v[108:111]
  ds_read_b128 v[48:51], v10 offset:10240
  ds_read_b128 v[52:55], v10 offset:26624
  s_waitcnt lgkmcnt(8)
  v_mfma_f32_16x16x32_bf16 v[96:99], v[72:75], v[64:67], v[96:99]
  ds_read_b64_tr_b16 v[56:57], v14 offset:16384
  v_mfma_f32_16x16x32_bf16 v[104:107], v[72:75], v[68:71], v[104:107]
  ds_read_b64_tr_b16 v[58:59], v14 offset:20480
  ds_read_b64_tr_b16 v[60:61], v15 offset:16384
  v_mfma_f32_16x16x32_bf16 v[100:103], v[76:79], v[64:67], v[100:103]
  ds_read_b64_tr_b16 v[62:63], v15 offset:20480
  v_mfma_f32_16x16x32_bf16 v[108:111], v[76:79], v[68:71], v[108:111]
  ds_read_b128 v[64:67], v10 offset:11264
  ds_read_b128 v[68:71], v10 offset:27648
  s_waitcnt lgkmcnt(8)
  v_mfma_f32_16x16x32_bf16 v[96:99], v[40:43], v[32:35], v[96:99]
  ds_read_b64_tr_b16 v[72:73], v14 offset:24576
  v_mfma_f32_16x16x32_bf16 v[104:107], v[40:43], v[36:39], v[104:107]
  ds_read_b64_tr_b16 v[74:75], v14 offset:28672
  ds_read_b64_tr_b16 v[76:77], v15 offset:24576
  v_mfma_f32_16x16x32_bf16 v[100:103], v[44:47], v[32:35], v[100:103]
  ds_read_b64_tr_b16 v[78:79], v15 offset:28672
  v_mfma_f32_16x16x32_bf16 v[108:111], v[44:47], v[36:39], v[108:111]
  ds_read_b128 v[32:35], v10 offset:12288
  ds_read_b128 v[36:39], v10 offset:28672
  s_waitcnt lgkmcnt(8)
  v_mfma_f32_16x16x32_bf16 v[96:99], v[56:59], v[48:51], v[96:99]
  ds_read_b64_tr_b16 v[40:41], v14 offset:32768
  v_mfma_f32_16x16x32_bf16 v[104:107], v[56:59], v[52:55], v[104:107]
  ds_read_b64_tr_b16 v[42:43], v14 offset:36864
  ds_read_b64_tr_b16 v[44:45], v15 offset:32768
  v_mfma_f32_16x16x32_bf16 v[100:103], v[60:63], v[48:51], v[100:103]
  ds_read_b64_tr_b16 v[46:47], v15 offset:36864
  v_mfma_f32_16x16x32_bf16 v[108:111], v[60:63], v[52:55], v[108:111]
  ds_read_b128 v[48:51], v10 offset:13312
  ds_read_b128 v[52:55], v10 offset:29696
  s_waitcnt lgkmcnt(8)
  v_mfma_f32_16x16x32_bf16 v[96:99], v[72:75], v[64:67], v[96:99]
  ds_read_b64_tr_b16 v[56:57], v14 offset:40960
  v_mfma_f32_16x16x32_bf16 v[104:107], v[72:75], v[68:71], v[104:107]
  ds_read_b64_tr_b16 v[58:59], v14 offset:45056
  ds_read_b64_tr_b16 v[60:61], v15 offset:40960
  v_mfma_f32_16x16x32_bf16 v[100:103], v[76:79], v[64:67], v[100:103]
  ds_read_b64_tr_b16 v[62:63], v15 offset:45056
  v_mfma_f32_16x16x32_bf16 v[108:111], v[76:79], v[68:71], v[108:111]
  ds_read_b128 v[64:67], v10 offset:14336
  ds_read_b128 v[68:71], v10 offset:30720
  s_waitcnt lgkmcnt(8)
  v_mfma_f32_16x16x32_bf16 v[96:99], v[40:43], v[32:35], v[96:99]
  ds_read_b64_tr_b16 v[72:73], v14 offset:49152
  v_mfma_f32_16x16x32_bf16 v[104:107], v[40:43], v[36:39], v[104:107]
  ds_read_b64_tr_b16 v[74:75], v14 offset:53248
  ds_read_b64_tr_b16 v[76:77], v15 offset:49152
  v_mfma_f32_16x16x32_bf16 v[100:103], v[44:47], v[32:35], v[100:103]
  ds_read_b64_tr_b16 v[78:79], v15 offset:53248
  v_mfma_f32_16x16x32_bf16 v[108:111], v[44:47], v[36:39], v[108:111]
  ds_read_b128 v[32:35], v10 offset:15360
  ds_read_b128 v[36:39], v10 offset:31744
  s_waitcnt lgkmcnt(8)
  v_mfma_f32_16x16x32_bf16 v[96:99], v[56:59], v[48:51], v[96:99]
  ds_read_b64_tr_b16 v[40:41], v14 offset:57344
  v_mfma_f32_16x16x32_bf16 v[104:107], v[56:59], v[52:55], v[104:107]
  ds_read_b64_tr_b16 v[42:43], v14 offset:61440
  ds_read_b64_tr_b16 v[44:45], v15 offset:57344
  v_mfma_f32_16x16x32_bf16 v[100:103], v[60:63], v[48:51], v[100:103]
  ds_read_b64_tr_b16 v[46:47], v15 offset:61440
  v_mfma_f32_16x16x32_bf16 v[108:111], v[60:63], v[52:55], v[108:111]
  s_waitcnt lgkmcnt(0)
  s_barrier
  v_mfma_f32_16x16x32_bf16 v[96:99], v[72:75], v[64:67], v[96:99]
  v_mfma_f32_16x16x32_bf16 v[104:107], v[72:75], v[68:71], v[104:107]
  v_mfma_f32_16x16x32_bf16 v[100:103], v[76:79], v[64:67], v[100:103]
  v_mfma_f32_16x16x32_bf16 v[108:111], v[76:79], v[68:71], v[108:111]
  v_mfma_f32_16x16x32_bf16 v[96:99], v[40:43], v[32:35], v[96:99]
  v_mfma_f32_16x16x32_bf16 v[104:107], v[40:43], v[36:39], v[104:107]
  v_mfma_f32_16x16x32_bf16 v[100:103], v[44:47], v[32:35], v[100:103]
  v_mfma_f32_16x16x32_bf16 v[108:111], v[44:47], v[36:39], v[108:111]
  s_lshl_b32 s50, s48, 15
  s_lshl_b32 s6, s49, 2
  s_add_u32 s6, s6, s3
  s_lshl_b32 s6, s6, 10
  s_add_u32 s50, s50, s6
  s_add_u32 s50, s50, 0x200000
  s_add_u32 s51, s50, 0x4000
  s_lshl_b32 s52, s48, 8
  s_add_u32 s52, s52, 0xb10000
  s_lshl_b32 s54, s48, 2
  s_add_u32 s54, s54, s49
  v_pk_add_f32 v[112:113], v[112:113], v[96:97]
  v_pk_add_f32 v[114:115], v[114:115], v[98:99]
  v_pk_add_f32 v[116:117], v[116:117], v[100:101]
  v_pk_add_f32 v[118:119], v[118:119], v[102:103]
  v_cvt_pk_bf16_f32 v128, v112, v113
  v_cvt_pk_bf16_f32 v129, v114, v115
  v_cvt_pk_bf16_f32 v130, v116, v117
  v_cvt_pk_bf16_f32 v131, v118, v119
  buffer_store_dwordx4 v[128:131], v1, s[36:39], s50 offen sc1
  v_pk_add_f32 v[120:121], v[120:121], v[104:105]
  v_pk_add_f32 v[122:123], v[122:123], v[106:107]
  v_pk_add_f32 v[124:125], v[124:125], v[108:109]
  v_pk_add_f32 v[126:127], v[126:127], v[110:111]
  v_cvt_pk_bf16_f32 v132, v120, v121
  v_cvt_pk_bf16_f32 v133, v122, v123
  v_cvt_pk_bf16_f32 v134, v124, v125
  v_cvt_pk_bf16_f32 v135, v126, v127
  buffer_store_dwordx4 v[132:135], v1, s[36:39], s51 offen sc1
  v_pk_add_f32 v[136:137], v[112:113], v[114:115]
  v_pk_mul_f32 v[140:141], v[112:113], v[112:113]
  v_pk_add_f32 v[138:139], v[120:121], v[122:123]
  v_pk_mul_f32 v[142:143], v[120:121], v[120:121]
  v_pk_fma_f32 v[140:141], v[114:115], v[114:115], v[140:141]
  v_pk_fma_f32 v[142:143], v[122:123], v[122:123], v[142:143]
  v_pk_add_f32 v[136:137], v[136:137], v[116:117]
  v_pk_fma_f32 v[140:141], v[116:117], v[116:117], v[140:141]
  v_pk_add_f32 v[138:139], v[138:139], v[124:125]
  v_pk_fma_f32 v[142:143], v[124:125], v[124:125], v[142:143]
  v_pk_add_f32 v[136:137], v[136:137], v[118:119]
  v_pk_fma_f32 v[140:141], v[118:119], v[118:119], v[140:141]
  v_pk_add_f32 v[138:139], v[138:139], v[126:127]
  v_pk_fma_f32 v[142:143], v[126:127], v[126:127], v[142:143]
  v_add_f32 v136, v136, v137
  v_add_f32 v140, v140, v141
  v_add_f32 v138, v138, v139
  v_add_f32 v142, v142, v143
  v_permlane32_swap_b32 v136, v140
  s_nop 0
  v_permlane32_swap_b32 v138, v142
  v_add_f32 v136, v136, v140
  v_add_f32 v138, v138, v142
  v_mov_b32 v140, v136
  v_mov_b32 v142, v138
  s_nop 0
  v_permlane16_swap_b32 v136, v140
  v_permlane16_swap_b32 v138, v142
  v_add_f32 v136, v136, v140
  v_add_f32 v138, v138, v142
  s_mov_b32 exec_lo, 0xffff
  s_mov_b32 exec_hi, 0xffff
  buffer_atomic_add_f32 v136, v11, s[36:39], s52 offen offset:0
  buffer_atomic_add_f32 v138, v11, s[36:39], s52 offen offset:128
  s_mov_b64 exec, -1
  s_lshl_b32 s54, s54, 7
  s_add_u32 s54, s54, 0xb1c000
  v_mov_b32 v4, 1
  v_mov_b32 v5, 0
  s_waitcnt vmcnt(0)
  s_barrier
  s_cmp_eq_u32 s3, 0
  s_cbranch_scc0 L_skip9
  s_mov_b64 exec, 1
  buffer_store_dword v4, v5, s[36:39], s54 offen sc1
  s_mov_b64 exec, -1
L_skip9:
  s_lshr_b32 s48, s4, 1
  s_lshl_b32 s48, s48, 2
  s_and_b32 s6, s5, 3
  s_add_u32 s48, s48, s6
  s_and_b32 s49, s4, 1
  s_lshl_b32 s49, s49, 3
  s_lshr_b32 s6, s5, 2
  s_add_u32 s49, s49, s6
  s_lshl_b32 s50, s48, 3
  s_lshl_b32 s6, s3, 1
  s_add_u32 s50, s50, s6
  s_lshl_b32 s52, s50, 14
  s_add_u32 s52, s52, 0x200000
  s_add_u32 s53, s52, 0x4000
  s_lshl_b32 s57, s48, 11
  s_add_u32 s57, s57, 0xb1c000
  s_bfe_u32 s62, s49, 0x10001
  s_and_b32 s63, s49, 1
  s_cmp_eq_u32 s62, s63
  s_cbranch_scc0 L_p3_v3
  v_bfe_u32 v4, v0, 3, 2
  v_and_b32 v5, 3, v0
  v_lshlrev_b32 v5, 3, v5
  v_lshrrev_b32 v13, 2, v0
  v_lshl_add_u32 v5, v13, 7, v5
  v_add_u32 v13, 0x10000, v5
  s_bfe_u32 s69, s49, 0x20001
  s_lshl_b32 s68, s69, 2
  s_lshr_b32 s80, 0x1020, s68
  s_and_b32 s80, s80, 15
  s_lshr_b32 s81, 0x2131, s68
  s_and_b32 s81, s81, 15
  s_lshr_b32 s82, 0x3212, s68
  s_and_b32 s82, s82, 15
  v_xor_b32 v6, 0, v4
  v_lshl_add_u32 v6, v6, 5, v5
  v_xor_b32 v7, 1, v4
  v_lshl_add_u32 v7, v7, 5, v5
  v_xor_b32 v8, 2, v4
  v_lshl_add_u32 v8, v8, 5, v5
  v_xor_b32 v9, 3, v4
  v_lshl_add_u32 v9, v9, 5, v5
  v_xor_b32 v10, s80, v4
  v_lshl_add_u32 v10, v10, 5, v13
  v_xor_b32 v11, s81, v4
  v_lshl_add_u32 v11, v11, 5, v13
  v_xor_b32 v12, s82, v4
  v_lshl_add_u32 v12, v12, 5, v13
  s_lshr_b32 s6, s49, 1
  s_lshl_b32 s66, s6, 6
  s_lshr_b32 s7, s50, 1
  s_add_u32 s66, s66, s7
  s_mul_i32 s66, s66, 7168
  s_add_u32 s66, s66, 0x780000
  s_lshr_b32 s7, 0x0054, s68
  s_and_b32 s7, s7, 15
  s_lshl_b32 s7, s7, 10
  s_add_u32 s83, s66, s7
  s_lshr_b32 s7, 0x1165, s68
  s_and_b32 s7, s7, 15
  s_lshl_b32 s7, s7, 10
  s_add_u32 s84, s66, s7
  s_lshr_b32 s7, 0x2606, s68
  s_and_b32 s7, s7, 15
  s_lshl_b32 s7, s7, 10
  s_add_u32 s85, s66, s7
  s_lshl_b32 s7, s69, 10
  s_add_u32 s66, s66, s7
  s_lshl_b32 s60, s50, 3
  s_add_u32 s60, s60, s6
  s_mul_i32 s60, s60, 3584
  s_add_u32 s60, s60, 0x400000
  s_add_u32 s61, s60, 28672
  s_lshr_b32 s7, s69, 1
  s_xor_b32 s7, s7, 1
  s_lshl_b32 s7, s7, 11
  s_add_u32 s54, s60, s7
  s_add_u32 s55, s61, s7
  s_lshl_b32 s58, s48, 14
  s_lshl_b32 s6, s3, 8
  s_add_u32 s58, s58, s6
  s_add_u32 s58, s58, 0xb44000
  s_lshl_b32 s6, s49, 10
  s_add_u32 s59, s58, s6
  s_add_u32 s67, s58, 4096
  v_lshrrev_b32 v4, 3, v3
  v_lshlrev_b32 v190, 7, v4
  v_lshl_add_u32 v190, v2, 5, v190
  v_and_b32 v4, 6, v3
  v_lshl_add_u32 v190, v4, 2, v190
  v_and_b32 v4, 31, v0
  v_lshlrev_b32 v191, 3, v4
  s_lshl_b32 s6, s3, 8
  s_add_u32 s6, s6, 147456
  v_lshl_add_u32 v192, v4, 2, s6
  v_lshl_add_u32 v193, v2, 4, s6
  v_lshrrev_b32 v4, 5, v0
  v_lshl_add_u32 v191, v4, 13, v191
  v_and_b32 v4, 2, v3
  v_cmp_eq_u32 s[64:65], 2, v4
  s_lshl_b32 s6, s3, 7
  s_add_u32 s6, s6, 148480
  v_lshl_add_u32 v194, v2, 4, s6
  v_lshl_add_u32 v195, v3, 2, s6
  v_lshlrev_b32 v196, 2, v3
  v_add_u32 v196, 150528, v196
  v_lshlrev_b32 v197, 4, v2
  v_add_u32 v197, 150528, v197
  s_lshl_b32 s6, s3, 9
  s_add_u32 s57, s57, s6
  v_lshlrev_b32 v5, 7, v0
  s_mov_b64 exec, 0xf
  s_mov_b32 s6, 131072
L_pollS24:
  buffer_load_dword v4, v5, s[36:39], s57 offen sc1
  s_sub_u32 s6, s6, 1
  s_cbranch_scc1 L_pollxS24
  s_waitcnt vmcnt(0)
  v_cmp_eq_u32 vcc, 0, v4
  s_nop 4
  s_cbranch_vccnz L_pollS24
L_pollxS24:
  s_mov_b64 exec, -1
  buffer_load_dwordx4 v[14:17], v1, s[36:39], s52 offen offset:0 sc1
  buffer_load_dwordx4 v[18:21], v1, s[36:39], s53 offen offset:0 sc1
  buffer_load_dwordx4 v[22:25], v1, s[36:39], s52 offen offset:1024 sc1
  buffer_load_dwordx4 v[26:29], v1, s[36:39], s53 offen offset:1024 sc1
  buffer_load_dwordx4 v[30:33], v1, s[36:39], s52 offen offset:2048 sc1
  buffer_load_dwordx4 v[34:37], v1, s[36:39], s53 offen offset:2048 sc1
  buffer_load_dwordx4 v[38:41], v1, s[36:39], s52 offen offset:3072 sc1
  buffer_load_dwordx4 v[42:45], v1, s[36:39], s53 offen offset:3072 sc1
  s_add_u32 s52, s52, 4096
  buffer_load_dwordx4 v[46:49], v1, s[36:39], s52 offen offset:0 sc1
  s_add_u32 s53, s53, 4096
  buffer_load_dwordx4 v[50:53], v1, s[36:39], s53 offen offset:0 sc1
  buffer_load_dwordx4 v[54:57], v1, s[36:39], s52 offen offset:1024 sc1
  buffer_load_dwordx4 v[58:61], v1, s[36:39], s53 offen offset:1024 sc1
  ds_read_b64_tr_b16 v[142:143], v6 offset:0
  ds_read_b64_tr_b16 v[144:145], v6 offset:2048
  ds_read_b64_tr_b16 v[146:147], v7 offset:0
  ds_read_b64_tr_b16 v[148:149], v7 offset:2048
  ds_read_b64_tr_b16 v[150:151], v8 offset:0
  ds_read_b64_tr_b16 v[152:153], v8 offset:2048
  ds_read_b64_tr_b16 v[154:155], v9 offset:0
  ds_read_b64_tr_b16 v[156:157], v9 offset:2048
  ds_read_b64_tr_b16 v[158:159], v6 offset:4096
  buffer_load_dwordx4 v[62:65], v1, s[36:39], s52 offen offset:2048 sc1
  s_waitcnt vmcnt(11) lgkmcnt(5)
  v_mfma_f32_16x16x32_bf16 v[198:201], v[14:17], v[142:145], 0
  ds_read_b64_tr_b16 v[160:161], v6 offset:6144
  v_mfma_f32_16x16x32_bf16 v[226:229], v[18:21], v[142:145], 0
  ds_read_b64_tr_b16 v[162:163], v7 offset:4096
  v_mfma_f32_16x16x32_bf16 v[202:205], v[14:17], v[146:149], 0
  ds_read_b64_tr_b16 v[164:165], v7 offset:6144
  v_mfma_f32_16x16x32_bf16 v[230:233], v[18:21], v[146:149], 0
  ds_read_b64_tr_b16 v[166:167], v8 offset:4096
  buffer_load_dwordx4 v[66:69], v1, s[36:39], s53 offen offset:2048 sc1
  s_waitcnt lgkmcnt(5)
  v_mfma_f32_16x16x32_bf16 v[206:209], v[14:17], v[150:153], 0
  ds_read_b64_tr_b16 v[168:169], v8 offset:6144
  v_mfma_f32_16x16x32_bf16 v[234:237], v[18:21], v[150:153], 0
  ds_read_b64_tr_b16 v[170:171], v9 offset:4096
  v_mfma_f32_16x16x32_bf16 v[210:213], v[14:17], v[154:157], 0
  ds_read_b64_tr_b16 v[172:173], v9 offset:6144
  v_mfma_f32_16x16x32_bf16 v[238:241], v[18:21], v[154:157], 0
  ds_read_b64_tr_b16 v[142:143], v6 offset:8192
  buffer_load_dwordx4 v[70:73], v1, s[36:39], s52 offen offset:3072 sc1
  s_waitcnt vmcnt(11) lgkmcnt(5)
  v_mfma_f32_16x16x32_bf16 v[198:201], v[22:25], v[158:161], v[198:201]
  ds_read_b64_tr_b16 v[144:145], v6 offset:10240
  v_mfma_f32_16x16x32_bf16 v[226:229], v[26:29], v[158:161], v[226:229]
  ds_read_b64_tr_b16 v[146:147], v7 offset:8192
  v_mfma_f32_16x16x32_bf16 v[202:205], v[22:25], v[162:165], v[202:205]
  ds_read_b64_tr_b16 v[148:149], v7 offset:10240
  v_mfma_f32_16x16x32_bf16 v[230:233], v[26:29], v[162:165], v[230:233]
  ds_read_b64_tr_b16 v[150:151], v8 offset:8192
  buffer_load_dwordx4 v[74:77], v1, s[36:39], s53 offen offset:3072 sc1
  s_waitcnt lgkmcnt(5)
  v_mfma_f32_16x16x32_bf16 v[206:209], v[22:25], v[166:169], v[206:209]
  ds_read_b64_tr_b16 v[152:153], v8 offset:10240
  v_mfma_f32_16x16x32_bf16 v[234:237], v[26:29], v[166:169], v[234:237]
  ds_read_b64_tr_b16 v[154:155], v9 offset:8192
  v_mfma_f32_16x16x32_bf16 v[210:213], v[22:25], v[170:173], v[210:213]
  ds_read_b64_tr_b16 v[156:157], v9 offset:10240
  v_mfma_f32_16x16x32_bf16 v[238:241], v[26:29], v[170:173], v[238:241]
  ds_read_b64_tr_b16 v[158:159], v6 offset:12288
  s_add_u32 s52, s52, 4096
  buffer_load_dwordx4 v[78:81], v1, s[36:39], s52 offen offset:0 sc1
  s_waitcnt vmcnt(11) lgkmcnt(5)
  v_mfma_f32_16x16x32_bf16 v[198:201], v[30:33], v[142:145], v[198:201]
  ds_read_b64_tr_b16 v[160:161], v6 offset:14336
  v_mfma_f32_16x16x32_bf16 v[226:229], v[34:37], v[142:145], v[226:229]
  ds_read_b64_tr_b16 v[162:163], v7 offset:12288
  v_mfma_f32_16x16x32_bf16 v[202:205], v[30:33], v[146:149], v[202:205]
  ds_read_b64_tr_b16 v[164:165], v7 offset:14336
  v_mfma_f32_16x16x32_bf16 v[230:233], v[34:37], v[146:149], v[230:233]
  ds_read_b64_tr_b16 v[166:167], v8 offset:12288
  s_add_u32 s53, s53, 4096
  buffer_load_dwordx4 v[82:85], v1, s[36:39], s53 offen offset:0 sc1
  s_waitcnt lgkmcnt(5)
  v_mfma_f32_16x16x32_bf16 v[206:209], v[30:33], v[150:153], v[206:209]
  ds_read_b64_tr_b16 v[168:169], v8 offset:14336
  v_mfma_f32_16x16x32_bf16 v[234:237], v[34:37], v[150:153], v[234:237]
  ds_read_b64_tr_b16 v[170:171], v9 offset:12288
  v_mfma_f32_16x16x32_bf16 v[210:213], v[30:33], v[154:157], v[210:213]
  ds_read_b64_tr_b16 v[172:173], v9 offset:14336
  v_mfma_f32_16x16x32_bf16 v[238:241], v[34:37], v[154:157], v[238:241]
  s_barrier
  ds_read_b64_tr_b16 v[142:143], v6 offset:16384
  buffer_load_dwordx4 v[86:89], v1, s[36:39], s52 offen offset:1024 sc1
  s_waitcnt vmcnt(11) lgkmcnt(5)
  v_mfma_f32_16x16x32_bf16 v[198:201], v[38:41], v[158:161], v[198:201]
  ds_read_b64_tr_b16 v[144:145], v6 offset:18432
  v_mfma_f32_16x16x32_bf16 v[226:229], v[42:45], v[158:161], v[226:229]
  ds_read_b64_tr_b16 v[146:147], v7 offset:16384
  v_mfma_f32_16x16x32_bf16 v[202:205], v[38:41], v[162:165], v[202:205]
  ds_read_b64_tr_b16 v[148:149], v7 offset:18432
  v_mfma_f32_16x16x32_bf16 v[230:233], v[42:45], v[162:165], v[230:233]
  ds_read_b64_tr_b16 v[150:151], v8 offset:16384
  buffer_load_dwordx4 v[90:93], v1, s[36:39], s53 offen offset:1024 sc1
  s_waitcnt lgkmcnt(5)
  v_mfma_f32_16x16x32_bf16 v[206:209], v[38:41], v[166:169], v[206:209]
  ds_read_b64_tr_b16 v[152:153], v8 offset:18432
  v_mfma_f32_16x16x32_bf16 v[234:237], v[42:45], v[166:169], v[234:237]
  ds_read_b64_tr_b16 v[154:155], v9 offset:16384
  v_mfma_f32_16x16x32_bf16 v[210:213], v[38:41], v[170:173], v[210:213]
  ds_read_b64_tr_b16 v[156:157], v9 offset:18432
  v_mfma_f32_16x16x32_bf16 v[238:241], v[42:45], v[170:173], v[238:241]
  ds_read_b64_tr_b16 v[158:159], v6 offset:20480
  buffer_load_dwordx4 v[94:97], v1, s[36:39], s52 offen offset:2048 sc1
  s_waitcnt vmcnt(11) lgkmcnt(5)
  v_mfma_f32_16x16x32_bf16 v[198:201], v[46:49], v[142:145], v[198:201]
  ds_read_b64_tr_b16 v[160:161], v6 offset:22528
  v_mfma_f32_16x16x32_bf16 v[226:229], v[50:53], v[142:145], v[226:229]
  ds_read_b64_tr_b16 v[162:163], v7 offset:20480
  v_mfma_f32_16x16x32_bf16 v[202:205], v[46:49], v[146:149], v[202:205]
  ds_read_b64_tr_b16 v[164:165], v7 offset:22528
  v_mfma_f32_16x16x32_bf16 v[230:233], v[50:53], v[146:149], v[230:233]
  ds_read_b64_tr_b16 v[166:167], v8 offset:20480
  buffer_load_dwordx4 v[98:101], v1, s[36:39], s53 offen offset:2048 sc1
  s_waitcnt lgkmcnt(5)
  v_mfma_f32_16x16x32_bf16 v[206:209], v[46:49], v[150:153], v[206:209]
  ds_read_b64_tr_b16 v[168:169], v8 offset:22528
  v_mfma_f32_16x16x32_bf16 v[234:237], v[50:53], v[150:153], v[234:237]
  ds_read_b64_tr_b16 v[170:171], v9 offset:20480
  v_mfma_f32_16x16x32_bf16 v[210:213], v[46:49], v[154:157], v[210:213]
  ds_read_b64_tr_b16 v[172:173], v9 offset:22528
  v_mfma_f32_16x16x32_bf16 v[238:241], v[50:53], v[154:157], v[238:241]
  ds_read_b64_tr_b16 v[142:143], v6 offset:24576
  buffer_load_dwordx4 v[102:105], v1, s[36:39], s52 offen offset:3072 sc1
  s_waitcnt vmcnt(11) lgkmcnt(5)
  v_mfma_f32_16x16x32_bf16 v[198:201], v[54:57], v[158:161], v[198:201]
  ds_read_b64_tr_b16 v[144:145], v6 offset:26624
  v_mfma_f32_16x16x32_bf16 v[226:229], v[58:61], v[158:161], v[226:229]
  ds_read_b64_tr_b16 v[146:147], v7 offset:24576
  v_mfma_f32_16x16x32_bf16 v[202:205], v[54:57], v[162:165], v[202:205]
  ds_read_b64_tr_b16 v[148:149], v7 offset:26624
  v_mfma_f32_16x16x32_bf16 v[230:233], v[58:61], v[162:165], v[230:233]
  ds_read_b64_tr_b16 v[150:151], v8 offset:24576
  buffer_load_dwordx4 v[106:109], v1, s[36:39], s53 offen offset:3072 sc1
  s_waitcnt lgkmcnt(5)
  v_mfma_f32_16x16x32_bf16 v[206:209], v[54:57], v[166:169], v[206:209]
  ds_read_b64_tr_b16 v[152:153], v8 offset:26624
  v_mfma_f32_16x16x32_bf16 v[234:237], v[58:61], v[166:169], v[234:237]
  ds_read_b64_tr_b16 v[154:155], v9 offset:24576
  v_mfma_f32_16x16x32_bf16 v[210:213], v[54:57], v[170:173], v[210:213]
  ds_read_b64_tr_b16 v[156:157], v9 offset:26624
  v_mfma_f32_16x16x32_bf16 v[238:241], v[58:61], v[170:173], v[238:241]
  ds_read_b64_tr_b16 v[158:159], v6 offset:28672
  s_add_u32 s52, s52, 4096
  buffer_load_dwordx4 v[110:113], v1, s[36:39], s52 offen offset:0 sc1
  s_waitcnt vmcnt(11) lgkmcnt(5)
  v_mfma_f32_16x16x32_bf16 v[198:201], v[62:65], v[142:145], v[198:201]
  ds_read_b64_tr_b16 v[160:161], v6 offset:30720
  v_mfma_f32_16x16x32_bf16 v[226:229], v[66:69], v[142:145], v[226:229]
  ds_read_b64_tr_b16 v[162:163], v7 offset:28672
  v_mfma_f32_16x16x32_bf16 v[202:205], v[62:65], v[146:149], v[202:205]
  ds_read_b64_tr_b16 v[164:165], v7 offset:30720
  v_mfma_f32_16x16x32_bf16 v[230:233], v[66:69], v[146:149], v[230:233]
  ds_read_b64_tr_b16 v[166:167], v8 offset:28672
  s_add_u32 s53, s53, 4096
  buffer_load_dwordx4 v[114:117], v1, s[36:39], s53 offen offset:0 sc1
  s_waitcnt lgkmcnt(5)
  v_mfma_f32_16x16x32_bf16 v[206:209], v[62:65], v[150:153], v[206:209]
  ds_read_b64_tr_b16 v[168:169], v8 offset:30720
  v_mfma_f32_16x16x32_bf16 v[234:237], v[66:69], v[150:153], v[234:237]
  ds_read_b64_tr_b16 v[170:171], v9 offset:28672
  v_mfma_f32_16x16x32_bf16 v[210:213], v[62:65], v[154:157], v[210:213]
  ds_read_b64_tr_b16 v[172:173], v9 offset:30720
  v_mfma_f32_16x16x32_bf16 v[238:241], v[66:69], v[154:157], v[238:241]
  ds_read_b64_tr_b16 v[142:143], v6 offset:32768
  buffer_load_dwordx4 v[118:121], v1, s[36:39], s52 offen offset:1024 sc1
  s_waitcnt vmcnt(11) lgkmcnt(5)
  v_mfma_f32_16x16x32_bf16 v[198:201], v[70:73], v[158:161], v[198:201]
  ds_read_b64_tr_b16 v[144:145], v6 offset:34816
  v_mfma_f32_16x16x32_bf16 v[226:229], v[74:77], v[158:161], v[226:229]
  ds_read_b64_tr_b16 v[146:147], v7 offset:32768
  v_mfma_f32_16x16x32_bf16 v[202:205], v[70:73], v[162:165], v[202:205]
  ds_read_b64_tr_b16 v[148:149], v7 offset:34816
  v_mfma_f32_16x16x32_bf16 v[230:233], v[74:77], v[162:165], v[230:233]
  ds_read_b64_tr_b16 v[150:151], v8 offset:32768
  buffer_load_dwordx4 v[122:125], v1, s[36:39], s53 offen offset:1024 sc1
  s_waitcnt lgkmcnt(5)
  v_mfma_f32_16x16x32_bf16 v[206:209], v[70:73], v[166:169], v[206:209]
  ds_read_b64_tr_b16 v[152:153], v8 offset:34816
  v_mfma_f32_16x16x32_bf16 v[234:237], v[74:77], v[166:169], v[234:237]
  ds_read_b64_tr_b16 v[154:155], v9 offset:32768
  v_mfma_f32_16x16x32_bf16 v[210:213], v[70:73], v[170:173], v[210:213]
  ds_read_b64_tr_b16 v[156:157], v9 offset:34816
  v_mfma_f32_16x16x32_bf16 v[238:241], v[74:77], v[170:173], v[238:241]
  ds_read_b64_tr_b16 v[158:159], v6 offset:36864
  buffer_load_dwordx4 v[126:129], v1, s[36:39], s52 offen offset:2048 sc1
  s_waitcnt vmcnt(11) lgkmcnt(5)
  v_mfma_f32_16x16x32_bf16 v[198:201], v[78:81], v[142:145], v[198:201]
  ds_read_b64_tr_b16 v[160:161], v6 offset:38912
  v_mfma_f32_16x16x32_bf16 v[226:229], v[82:85], v[142:145], v[226:229]
  ds_read_b64_tr_b16 v[162:163], v7 offset:36864
  v_mfma_f32_16x16x32_bf16 v[202:205], v[78:81], v[146:149], v[202:205]
  ds_read_b64_tr_b16 v[164:165], v7 offset:38912
  v_mfma_f32_16x16x32_bf16 v[230:233], v[82:85], v[146:149], v[230:233]
  ds_read_b64_tr_b16 v[166:167], v8 offset:36864
  buffer_load_dwordx4 v[130:133], v1, s[36:39], s53 offen offset:2048 sc1
  s_waitcnt lgkmcnt(5)
  v_mfma_f32_16x16x32_bf16 v[206:209], v[78:81], v[150:153], v[206:209]
  ds_read_b64_tr_b16 v[168:169], v8 offset:38912
  v_mfma_f32_16x16x32_bf16 v[234:237], v[82:85], v[150:153], v[234:237]
  ds_read_b64_tr_b16 v[170:171], v9 offset:36864
  v_mfma_f32_16x16x32_bf16 v[210:213], v[78:81], v[154:157], v[210:213]
  ds_read_b64_tr_b16 v[172:173], v9 offset:38912
  v_mfma_f32_16x16x32_bf16 v[238:241], v[82:85], v[154:157], v[238:241]
  ds_read_b64_tr_b16 v[142:143], v6 offset:40960
  buffer_load_dwordx4 v[134:137], v1, s[36:39], s52 offen offset:3072 sc1
  s_waitcnt vmcnt(11) lgkmcnt(5)
  v_mfma_f32_16x16x32_bf16 v[198:201], v[86:89], v[158:161], v[198:201]
  ds_read_b64_tr_b16 v[144:145], v6 offset:43008
  v_mfma_f32_16x16x32_bf16 v[226:229], v[90:93], v[158:161], v[226:229]
  ds_read_b64_tr_b16 v[146:147], v7 offset:40960
  v_mfma_f32_16x16x32_bf16 v[202:205], v[86:89], v[162:165], v[202:205]
  ds_read_b64_tr_b16 v[148:149], v7 offset:43008
  v_mfma_f32_16x16x32_bf16 v[230:233], v[90:93], v[162:165], v[230:233]
  ds_read_b64_tr_b16 v[150:151], v8 offset:40960
  buffer_load_dwordx4 v[138:141], v1, s[36:39], s53 offen offset:3072 sc1
  s_waitcnt lgkmcnt(5)
  v_mfma_f32_16x16x32_bf16 v[206:209], v[86:89], v[166:169], v[206:209]
  ds_read_b64_tr_b16 v[152:153], v8 offset:43008
  v_mfma_f32_16x16x32_bf16 v[234:237], v[90:93], v[166:169], v[234:237]
  ds_read_b64_tr_b16 v[154:155], v9 offset:40960
  v_mfma_f32_16x16x32_bf16 v[210:213], v[86:89], v[170:173], v[210:213]
  ds_read_b64_tr_b16 v[156:157], v9 offset:43008
  v_mfma_f32_16x16x32_bf16 v[238:241], v[90:93], v[170:173], v[238:241]
  ds_read_b64_tr_b16 v[158:159], v6 offset:45056
  s_waitcnt vmcnt(10) lgkmcnt(5)
  v_mfma_f32_16x16x32_bf16 v[198:201], v[94:97], v[142:145], v[198:201]
  ds_read_b64_tr_b16 v[160:161], v6 offset:47104
  v_mfma_f32_16x16x32_bf16 v[226:229], v[98:101], v[142:145], v[226:229]
  ds_read_b64_tr_b16 v[162:163], v7 offset:45056
  v_mfma_f32_16x16x32_bf16 v[202:205], v[94:97], v[146:149], v[202:205]
  ds_read_b64_tr_b16 v[164:165], v7 offset:47104
  v_mfma_f32_16x16x32_bf16 v[230:233], v[98:101], v[146:149], v[230:233]
  ds_read_b64_tr_b16 v[166:167], v8 offset:45056
  s_waitcnt lgkmcnt(5)
  v_mfma_f32_16x16x32_bf16 v[206:209], v[94:97], v[150:153], v[206:209]
  ds_read_b64_tr_b16 v[168:169], v8 offset:47104
  v_mfma_f32_16x16x32_bf16 v[234:237], v[98:101], v[150:153], v[234:237]
  ds_read_b64_tr_b16 v[170:171], v9 offset:45056
  v_mfma_f32_16x16x32_bf16 v[210:213], v[94:97], v[154:157], v[210:213]
  ds_read_b64_tr_b16 v[172:173], v9 offset:47104
  v_mfma_f32_16x16x32_bf16 v[238:241], v[98:101], v[154:157], v[238:241]
  s_barrier
  ds_read_b64_tr_b16 v[142:143], v6 offset:49152
  s_waitcnt vmcnt(8) lgkmcnt(5)
  v_mfma_f32_16x16x32_bf16 v[198:201], v[102:105], v[158:161], v[198:201]
  ds_read_b64_tr_b16 v[144:145], v6 offset:51200
  v_mfma_f32_16x16x32_bf16 v[226:229], v[106:109], v[158:161], v[226:229]
  ds_read_b64_tr_b16 v[146:147], v7 offset:49152
  v_mfma_f32_16x16x32_bf16 v[202:205], v[102:105], v[162:165], v[202:205]
  ds_read_b64_tr_b16 v[148:149], v7 offset:51200
  v_mfma_f32_16x16x32_bf16 v[230:233], v[106:109], v[162:165], v[230:233]
  ds_read_b64_tr_b16 v[150:151], v8 offset:49152
  s_waitcnt lgkmcnt(5)
  v_mfma_f32_16x16x32_bf16 v[206:209], v[102:105], v[166:169], v[206:209]
  ds_read_b64_tr_b16 v[152:153], v8 offset:51200
  v_mfma_f32_16x16x32_bf16 v[234:237], v[106:109], v[166:169], v[234:237]
  ds_read_b64_tr_b16 v[154:155], v9 offset:49152
  v_mfma_f32_16x16x32_bf16 v[210:213], v[102:105], v[170:173], v[210:213]
  ds_read_b64_tr_b16 v[156:157], v9 offset:51200
  v_mfma_f32_16x16x32_bf16 v[238:241], v[106:109], v[170:173], v[238:241]
  ds_read_b64_tr_b16 v[158:159], v6 offset:53248
  ds_read_b128 v[174:177], v194 offset:1536
  s_waitcnt vmcnt(6) lgkmcnt(6)
  v_mfma_f32_16x16x32_bf16 v[198:201], v[110:113], v[142:145], v[198:201]
  ds_read_b64_tr_b16 v[160:161], v6 offset:55296
  ds_read_b128 v[178:181], v194 offset:1600
  v_mfma_f32_16x16x32_bf16 v[226:229], v[114:117], v[142:145], v[226:229]
  ds_read_b64_tr_b16 v[162:163], v7 offset:53248
  ds_read_b32 v182, v196 offset:0
  v_mfma_f32_16x16x32_bf16 v[202:205], v[110:113], v[146:149], v[202:205]
  ds_read_b64_tr_b16 v[164:165], v7 offset:55296
  v_mfma_f32_16x16x32_bf16 v[230:233], v[114:117], v[146:149], v[230:233]
  ds_read_b64_tr_b16 v[166:167], v8 offset:53248
  ds_read_b32 v183, v196 offset:64
  s_waitcnt lgkmcnt(9)
  v_mfma_f32_16x16x32_bf16 v[206:209], v[110:113], v[150:153], v[206:209]
  ds_read_b64_tr_b16 v[168:169], v8 offset:55296
  ds_read_b32 v184, v196 offset:128
  v_mfma_f32_16x16x32_bf16 v[234:237], v[114:117], v[150:153], v[234:237]
  ds_read_b64_tr_b16 v[170:171], v9 offset:53248
  ds_read_b32 v185, v196 offset:192
  v_mfma_f32_16x16x32_bf16 v[210:213], v[110:113], v[154:157], v[210:213]
  ds_read_b64_tr_b16 v[172:173], v9 offset:55296
  v_mfma_f32_16x16x32_bf16 v[238:241], v[114:117], v[154:157], v[238:241]
  ds_read_b64_tr_b16 v[142:143], v6 offset:57344
  s_waitcnt vmcnt(4) lgkmcnt(8)
  v_mfma_f32_16x16x32_bf16 v[198:201], v[118:121], v[158:161], v[198:201]
  ds_read_b64_tr_b16 v[144:145], v6 offset:59392
  v_mfma_f32_16x16x32_bf16 v[226:229], v[122:125], v[158:161], v[226:229]
  ds_read_b64_tr_b16 v[146:147], v7 offset:57344
  v_mfma_f32_16x16x32_bf16 v[202:205], v[118:121], v[162:165], v[202:205]
  ds_read_b64_tr_b16 v[148:149], v7 offset:59392
  v_mfma_f32_16x16x32_bf16 v[230:233], v[122:125], v[162:165], v[230:233]
  ds_read_b64_tr_b16 v[150:151], v8 offset:57344
  s_waitcnt lgkmcnt(5)
  v_mfma_f32_16x16x32_bf16 v[206:209], v[118:121], v[166:169], v[206:209]
  ds_read_b64_tr_b16 v[152:153], v8 offset:59392
  v_mfma_f32_16x16x32_bf16 v[234:237], v[122:125], v[166:169], v[234:237]
  ds_read_b64_tr_b16 v[154:155], v9 offset:57344
  v_mfma_f32_16x16x32_bf16 v[210:213], v[118:121], v[170:173], v[210:213]
  ds_read_b64_tr_b16 v[156:157], v9 offset:59392
  v_mfma_f32_16x16x32_bf16 v[238:241], v[122:125], v[170:173], v[238:241]
  ds_read_b64_tr_b16 v[158:159], v6 offset:61440
  s_waitcnt vmcnt(2) lgkmcnt(5)
  v_mfma_f32_16x16x32_bf16 v[198:201], v[126:129], v[142:145], v[198:201]
  ds_read_b64_tr_b16 v[160:161], v6 offset:63488
  v_mfma_f32_16x16x32_bf16 v[226:229], v[130:133], v[142:145], v[226:229]
  ds_read_b64_tr_b16 v[162:163], v7 offset:61440
  v_mfma_f32_16x16x32_bf16 v[202:205], v[126:129], v[146:149], v[202:205]
  ds_read_b64_tr_b16 v[164:165], v7 offset:63488
  v_mfma_f32_16x16x32_bf16 v[230:233], v[130:133], v[146:149], v[230:233]
  ds_read_b64_tr_b16 v[166:167], v8 offset:61440
  s_waitcnt lgkmcnt(5)
  v_mfma_f32_16x16x32_bf16 v[206:209], v[126:129], v[150:153], v[206:209]
  ds_read_b64_tr_b16 v[168:169], v8 offset:63488
  v_mfma_f32_16x16x32_bf16 v[234:237], v[130:133], v[150:153], v[234:237]
  ds_read_b64_tr_b16 v[170:171], v9 offset:61440
  v_mfma_f32_16x16x32_bf16 v[210:213], v[126:129], v[154:157], v[210:213]
  ds_read_b64_tr_b16 v[172:173], v9 offset:63488
  v_mfma_f32_16x16x32_bf16 v[238:241], v[130:133], v[154:157], v[238:241]
  s_waitcnt lgkmcnt(0)
  s_barrier
  s_waitcnt vmcnt(0)
  v_mfma_f32_16x16x32_bf16 v[198:201], v[134:137], v[158:161], v[198:201]
  v_mfma_f32_16x16x32_bf16 v[226:229], v[138:141], v[158:161], v[226:229]
  v_mfma_f32_16x16x32_bf16 v[202:205], v[134:137], v[162:165], v[202:205]
  v_mfma_f32_16x16x32_bf16 v[230:233], v[138:141], v[162:165], v[230:233]
  v_mfma_f32_16x16x32_bf16 v[206:209], v[134:137], v[166:169], v[206:209]
  v_mfma_f32_16x16x32_bf16 v[234:237], v[138:141], v[166:169], v[234:237]
  v_mfma_f32_16x16x32_bf16 v[210:213], v[134:137], v[170:173], v[210:213]
  v_mfma_f32_16x16x32_bf16 v[238:241], v[138:141], v[170:173], v[238:241]
  ds_read_b128 v[142:145], v194 offset:0
  ds_read_b128 v[146:149], v194 offset:64
  ds_read_b128 v[150:153], v194 offset:512
  ds_read_b128 v[154:157], v194 offset:576
  ds_read_b128 v[158:161], v194 offset:1024
  ds_read_b128 v[162:165], v194 offset:1088
  v_pk_fma_f32 v[198:199], v[174:175], v[182:183], v[198:199] op_sel_hi:[1,0,1]
  v_pk_fma_f32 v[200:201], v[176:177], v[182:183], v[200:201] op_sel_hi:[1,0,1]
  v_pk_fma_f32 v[226:227], v[178:179], v[182:183], v[226:227] op_sel_hi:[1,0,1]
  v_pk_fma_f32 v[228:229], v[180:181], v[182:183], v[228:229] op_sel_hi:[1,0,1]
  v_pk_fma_f32 v[202:203], v[174:175], v[182:183], v[202:203] op_sel:[0,1,0] op_sel_hi:[1,1,1]
  v_pk_fma_f32 v[204:205], v[176:177], v[182:183], v[204:205] op_sel:[0,1,0] op_sel_hi:[1,1,1]
  v_pk_fma_f32 v[230:231], v[178:179], v[182:183], v[230:231] op_sel:[0,1,0] op_sel_hi:[1,1,1]
  v_pk_fma_f32 v[232:233], v[180:181], v[182:183], v[232:233] op_sel:[0,1,0] op_sel_hi:[1,1,1]
  v_pk_fma_f32 v[206:207], v[174:175], v[184:185], v[206:207] op_sel_hi:[1,0,1]
  v_pk_fma_f32 v[208:209], v[176:177], v[184:185], v[208:209] op_sel_hi:[1,0,1]
  v_pk_fma_f32 v[234:235], v[178:179], v[184:185], v[234:235] op_sel_hi:[1,0,1]
  v_pk_fma_f32 v[236:237], v[180:181], v[184:185], v[236:237] op_sel_hi:[1,0,1]
  v_pk_fma_f32 v[210:211], v[174:175], v[184:185], v[210:211] op_sel:[0,1,0] op_sel_hi:[1,1,1]
  v_pk_fma_f32 v[212:213], v[176:177], v[184:185], v[212:213] op_sel:[0,1,0] op_sel_hi:[1,1,1]
  v_pk_fma_f32 v[238:239], v[178:179], v[184:185], v[238:239] op_sel:[0,1,0] op_sel_hi:[1,1,1]
  v_pk_fma_f32 v[240:241], v[180:181], v[184:185], v[240:241] op_sel:[0,1,0] op_sel_hi:[1,1,1]
  s_waitcnt lgkmcnt(0)
  v_pk_mul_f32 v[166:167], v[198:199], v[198:199]
  v_pk_mul_f32 v[168:169], v[200:201], v[200:201]
  v_pk_mul_f32 v[170:171], v[226:227], v[226:227]
  v_pk_mul_f32 v[172:173], v[228:229], v[228:229]
  v_pk_fma_f32 v[166:167], v[166:167], v[150:151], v[142:143]
  v_pk_fma_f32 v[168:169], v[168:169], v[152:153], v[144:145]
  v_pk_fma_f32 v[170:171], v[170:171], v[154:155], v[146:147]
  v_pk_fma_f32 v[172:173], v[172:173], v[156:157], v[148:149]
  v_pk_mul_f32 v[166:167], v[166:167], v[198:199]
  v_pk_mul_f32 v[168:169], v[168:169], v[200:201]
  v_pk_mul_f32 v[170:171], v[170:171], v[226:227]
  v_pk_mul_f32 v[172:173], v[172:173], v[228:229]
  v_exp_f32 v166, v166
  v_exp_f32 v167, v167
  v_exp_f32 v168, v168
  v_exp_f32 v169, v169
  v_exp_f32 v170, v170
  v_exp_f32 v171, v171
  v_exp_f32 v172, v172
  v_exp_f32 v173, v173
  v_pk_fma_f32 v[166:167], v[166:167], v[158:159], v[158:159]
  v_pk_fma_f32 v[168:169], v[168:169], v[160:161], v[160:161]
  v_pk_fma_f32 v[170:171], v[170:171], v[162:163], v[162:163]
  v_pk_fma_f32 v[172:173], v[172:173], v[164:165], v[164:165]
  v_rcp_f32 v166, v166
  v_rcp_f32 v167, v167
  v_rcp_f32 v168, v168
  v_rcp_f32 v169, v169
  v_rcp_f32 v170, v170
  v_rcp_f32 v171, v171
  v_rcp_f32 v172, v172
  v_rcp_f32 v173, v173
  v_pk_mul_f32 v[198:199], v[198:199], v[166:167]
  v_pk_mul_f32 v[200:201], v[200:201], v[168:169]
  v_pk_mul_f32 v[226:227], v[226:227], v[170:171]
  v_pk_mul_f32 v[228:229], v[228:229], v[172:173]
  v_pk_mul_f32 v[182:183], v[198:199], v[198:199]
  v_pk_mul_f32 v[184:185], v[200:201], v[200:201]
  v_pk_mul_f32 v[186:187], v[226:227], v[226:227]
  v_pk_mul_f32 v[188:189], v[228:229], v[228:229]
  v_pk_mul_f32 v[166:167], v[202:203], v[202:203]
  v_pk_mul_f32 v[168:169], v[204:205], v[204:205]
  v_pk_mul_f32 v[170:171], v[230:231], v[230:231]
  v_pk_mul_f32 v[172:173], v[232:233], v[232:233]
  v_pk_fma_f32 v[166:167], v[166:167], v[150:151], v[142:143]
  v_pk_fma_f32 v[168:169], v[168:169], v[152:153], v[144:145]
  v_pk_fma_f32 v[170:171], v[170:171], v[154:155], v[146:147]
  v_pk_fma_f32 v[172:173], v[172:173], v[156:157], v[148:149]
  v_pk_mul_f32 v[166:167], v[166:167], v[202:203]
  v_pk_mul_f32 v[168:169], v[168:169], v[204:205]
  v_pk_mul_f32 v[170:171], v[170:171], v[230:231]
  v_pk_mul_f32 v[172:173], v[172:173], v[232:233]
  v_exp_f32 v166, v166
  v_exp_f32 v167, v167
  v_exp_f32 v168, v168
  v_exp_f32 v169, v169
  v_exp_f32 v170, v170
  v_exp_f32 v171, v171
  v_exp_f32 v172, v172
  v_exp_f32 v173, v173
  v_pk_fma_f32 v[166:167], v[166:167], v[158:159], v[158:159]
  v_pk_fma_f32 v[168:169], v[168:169], v[160:161], v[160:161]
  v_pk_fma_f32 v[170:171], v[170:171], v[162:163], v[162:163]
  v_pk_fma_f32 v[172:173], v[172:173], v[164:165], v[164:165]
  v_rcp_f32 v166, v166
  v_rcp_f32 v167, v167
  v_rcp_f32 v168, v168
  v_rcp_f32 v169, v169
  v_rcp_f32 v170, v170
  v_rcp_f32 v171, v171
  v_rcp_f32 v172, v172
  v_rcp_f32 v173, v173
  v_pk_mul_f32 v[202:203], v[202:203], v[166:167]
  v_pk_mul_f32 v[204:205], v[204:205], v[168:169]
  v_pk_mul_f32 v[230:231], v[230:231], v[170:171]
  v_pk_mul_f32 v[232:233], v[232:233], v[172:173]
  v_pk_fma_f32 v[182:183], v[202:203], v[202:203], v[182:183]
  v_pk_add_f32 v[174:175], v[202:203], v[198:199]
  v_pk_fma_f32 v[184:185], v[204:205], v[204:205], v[184:185]
  v_pk_add_f32 v[176:177], v[204:205], v[200:201]
  v_pk_fma_f32 v[186:187], v[230:231], v[230:231], v[186:187]
  v_pk_add_f32 v[178:179], v[230:231], v[226:227]
  v_pk_fma_f32 v[188:189], v[232:233], v[232:233], v[188:189]
  v_pk_add_f32 v[180:181], v[232:233], v[228:229]
  v_pk_mul_f32 v[166:167], v[206:207], v[206:207]
  v_pk_mul_f32 v[168:169], v[208:209], v[208:209]
  v_pk_mul_f32 v[170:171], v[234:235], v[234:235]
  v_pk_mul_f32 v[172:173], v[236:237], v[236:237]
  v_pk_fma_f32 v[166:167], v[166:167], v[150:151], v[142:143]
  v_pk_fma_f32 v[168:169], v[168:169], v[152:153], v[144:145]
  v_pk_fma_f32 v[170:171], v[170:171], v[154:155], v[146:147]
  v_pk_fma_f32 v[172:173], v[172:173], v[156:157], v[148:149]
  v_pk_mul_f32 v[166:167], v[166:167], v[206:207]
  v_pk_mul_f32 v[168:169], v[168:169], v[208:209]
  v_pk_mul_f32 v[170:171], v[170:171], v[234:235]
  v_pk_mul_f32 v[172:173], v[172:173], v[236:237]
  v_exp_f32 v166, v166
  v_exp_f32 v167, v167
  v_exp_f32 v168, v168
  v_exp_f32 v169, v169
  v_exp_f32 v170, v170
  v_exp_f32 v171, v171
  v_exp_f32 v172, v172
  v_exp_f32 v173, v173
  v_pk_fma_f32 v[166:167], v[166:167], v[158:159], v[158:159]
  v_pk_fma_f32 v[168:169], v[168:169], v[160:161], v[160:161]
  v_pk_fma_f32 v[170:171], v[170:171], v[162:163], v[162:163]
  v_pk_fma_f32 v[172:173], v[172:173], v[164:165], v[164:165]
  v_rcp_f32 v166, v166
  v_rcp_f32 v167, v167
  v_rcp_f32 v168, v168
  v_rcp_f32 v169, v169
  v_rcp_f32 v170, v170
  v_rcp_f32 v171, v171
  v_rcp_f32 v172, v172
  v_rcp_f32 v173, v173
  v_pk_mul_f32 v[206:207], v[206:207], v[166:167]
  v_pk_mul_f32 v[208:209], v[208:209], v[168:169]
  v_pk_mul_f32 v[234:235], v[234:235], v[170:171]
  v_pk_mul_f32 v[236:237], v[236:237], v[172:173]
  v_pk_fma_f32 v[182:183], v[206:207], v[206:207], v[182:183]
  v_pk_add_f32 v[174:175], v[206:207], v[174:175]
  v_pk_fma_f32 v[184:185], v[208:209], v[208:209], v[184:185]
  v_pk_add_f32 v[176:177], v[208:209], v[176:177]
  v_pk_fma_f32 v[186:187], v[234:235], v[234:235], v[186:187]
  v_pk_add_f32 v[178:179], v[234:235], v[178:179]
  v_pk_fma_f32 v[188:189], v[236:237], v[236:237], v[188:189]
  v_pk_add_f32 v[180:181], v[236:237], v[180:181]
  v_pk_mul_f32 v[166:167], v[210:211], v[210:211]
  v_pk_mul_f32 v[168:169], v[212:213], v[212:213]
  v_pk_mul_f32 v[170:171], v[238:239], v[238:239]
  v_pk_mul_f32 v[172:173], v[240:241], v[240:241]
  v_pk_fma_f32 v[166:167], v[166:167], v[150:151], v[142:143]
  v_pk_fma_f32 v[168:169], v[168:169], v[152:153], v[144:145]
  v_pk_fma_f32 v[170:171], v[170:171], v[154:155], v[146:147]
  v_pk_fma_f32 v[172:173], v[172:173], v[156:157], v[148:149]
  v_pk_mul_f32 v[166:167], v[166:167], v[210:211]
  v_pk_mul_f32 v[168:169], v[168:169], v[212:213]
  v_pk_mul_f32 v[170:171], v[170:171], v[238:239]
  v_pk_mul_f32 v[172:173], v[172:173], v[240:241]
  v_exp_f32 v166, v166
  v_exp_f32 v167, v167
  v_exp_f32 v168, v168
  v_exp_f32 v169, v169
  v_exp_f32 v170, v170
  v_exp_f32 v171, v171
  v_exp_f32 v172, v172
  v_exp_f32 v173, v173
  v_pk_fma_f32 v[166:167], v[166:167], v[158:159], v[158:159]
  v_pk_fma_f32 v[168:169], v[168:169], v[160:161], v[160:161]
  v_pk_fma_f32 v[170:171], v[170:171], v[162:163], v[162:163]
  v_pk_fma_f32 v[172:173], v[172:173], v[164:165], v[164:165]
  v_rcp_f32 v166, v166
  v_rcp_f32 v167, v167
  v_rcp_f32 v168, v168
  v_rcp_f32 v169, v169
  v_rcp_f32 v170, v170
  v_rcp_f32 v171, v171
  v_rcp_f32 v172, v172
  v_rcp_f32 v173, v173
  v_pk_mul_f32 v[210:211], v[210:211], v[166:167]
  v_pk_mul_f32 v[212:213], v[212:213], v[168:169]
  v_pk_mul_f32 v[238:239], v[238:239], v[170:171]
  v_pk_mul_f32 v[240:241], v[240:241], v[172:173]
  v_pk_fma_f32 v[182:183], v[210:211], v[210:211], v[182:183]
  v_pk_add_f32 v[174:175], v[210:211], v[174:175]
  v_pk_fma_f32 v[184:185], v[212:213], v[212:213], v[184:185]
  v_pk_add_f32 v[176:177], v[212:213], v[176:177]
  v_pk_fma_f32 v[186:187], v[238:239], v[238:239], v[186:187]
  v_pk_add_f32 v[178:179], v[238:239], v[178:179]
  v_pk_fma_f32 v[188:189], v[240:241], v[240:241], v[188:189]
  v_pk_add_f32 v[180:181], v[240:241], v[180:181]
  v_lshl_add_u32 v150, s80, 6, v197
  ds_read_b128 v[150:153], v150 offset:256
  v_lshl_add_u32 v154, s81, 6, v197
  ds_read_b128 v[154:157], v154 offset:256
  v_lshl_add_u32 v158, s82, 6, v197
  ds_read_b128 v[158:161], v158 offset:256
  ds_read_b32 v6, v195 offset:1536
  ds_read_b32 v7, v195 offset:1600
  v_add_f32_dpp v142, v174, v174 row_ror:8 row_mask:0xf bank_mask:0x3
  v_add_f32_dpp v143, v175, v175 row_ror:8 row_mask:0xf bank_mask:0x3
  v_add_f32_dpp v144, v176, v176 row_ror:8 row_mask:0xf bank_mask:0x3
  v_add_f32_dpp v145, v177, v177 row_ror:8 row_mask:0xf bank_mask:0x3
  v_add_f32_dpp v146, v182, v182 row_ror:8 row_mask:0xf bank_mask:0x3
  v_add_f32_dpp v147, v183, v183 row_ror:8 row_mask:0xf bank_mask:0x3
  v_add_f32_dpp v148, v184, v184 row_ror:8 row_mask:0xf bank_mask:0x3
  v_add_f32_dpp v149, v185, v185 row_ror:8 row_mask:0xf bank_mask:0x3
  v_add_f32_dpp v142, v178, v178 row_ror:8 row_mask:0xf bank_mask:0xc
  v_add_f32_dpp v143, v179, v179 row_ror:8 row_mask:0xf bank_mask:0xc
  v_add_f32_dpp v144, v180, v180 row_ror:8 row_mask:0xf bank_mask:0xc
  v_add_f32_dpp v145, v181, v181 row_ror:8 row_mask:0xf bank_mask:0xc
  v_add_f32_dpp v146, v186, v186 row_ror:8 row_mask:0xf bank_mask:0xc
  v_add_f32_dpp v147, v187, v187 row_ror:8 row_mask:0xf bank_mask:0xc
  v_add_f32_dpp v148, v188, v188 row_ror:8 row_mask:0xf bank_mask:0xc
  v_add_f32_dpp v149, v189, v189 row_ror:8 row_mask:0xf bank_mask:0xc
  v_add_f32_dpp v166, v142, v142 row_half_mirror row_mask:0xf bank_mask:0x5
  v_add_f32_dpp v167, v143, v143 row_half_mirror row_mask:0xf bank_mask:0x5
  v_add_f32_dpp v168, v146, v146 row_half_mirror row_mask:0xf bank_mask:0x5
  v_add_f32_dpp v169, v147, v147 row_half_mirror row_mask:0xf bank_mask:0x5
  v_add_f32_dpp v166, v144, v144 row_half_mirror row_mask:0xf bank_mask:0xa
  v_add_f32_dpp v167, v145, v145 row_half_mirror row_mask:0xf bank_mask:0xa
  v_add_f32_dpp v168, v148, v148 row_half_mirror row_mask:0xf bank_mask:0xa
  v_add_f32_dpp v169, v149, v149 row_half_mirror row_mask:0xf bank_mask:0xa
  v_add_f32_dpp v166, v166, v166 quad_perm:[2,3,0,1] row_mask:0xf bank_mask:0xf
  v_add_f32_dpp v167, v167, v167 quad_perm:[2,3,0,1] row_mask:0xf bank_mask:0xf
  v_add_f32_dpp v168, v168, v168 quad_perm:[2,3,0,1] row_mask:0xf bank_mask:0xf
  v_add_f32_dpp v169, v169, v169 quad_perm:[2,3,0,1] row_mask:0xf bank_mask:0xf
  v_add_f32_dpp v166, v166, v166 quad_perm:[1,0,3,2] row_mask:0xf bank_mask:0xf
  v_add_f32_dpp v167, v167, v167 quad_perm:[1,0,3,2] row_mask:0xf bank_mask:0xf
  v_add_f32_dpp v168, v168, v168 quad_perm:[1,0,3,2] row_mask:0xf bank_mask:0xf
  v_add_f32_dpp v169, v169, v169 quad_perm:[1,0,3,2] row_mask:0xf bank_mask:0xf
  v_cndmask_b32 v170, v166, v167, s[64:65]
  v_cndmask_b32 v171, v168, v169, s[64:65]
  v_or_b32 v171, 1, v171
  s_mov_b32 exec_lo, 0x55555555
  s_mov_b32 exec_hi, 0x55555555
  buffer_store_dwordx2 v[170:171], v190, s[36:39], s59 offen sc1
  s_mov_b64 exec, -1
  s_waitcnt lgkmcnt(0)
  v_pk_mul_f32 v[214:215], v[150:151], v[6:7] op_sel_hi:[1,0]
  v_pk_mul_f32 v[216:217], v[152:153], v[6:7] op_sel_hi:[1,0]
  v_pk_mul_f32 v[242:243], v[150:151], v[6:7] op_sel:[0,1] op_sel_hi:[1,1]
  v_pk_mul_f32 v[244:245], v[152:153], v[6:7] op_sel:[0,1] op_sel_hi:[1,1]
  v_pk_mul_f32 v[218:219], v[154:155], v[6:7] op_sel_hi:[1,0]
  v_pk_mul_f32 v[220:221], v[156:157], v[6:7] op_sel_hi:[1,0]
  v_pk_mul_f32 v[246:247], v[154:155], v[6:7] op_sel:[0,1] op_sel_hi:[1,1]
  v_pk_mul_f32 v[248:249], v[156:157], v[6:7] op_sel:[0,1] op_sel_hi:[1,1]
  v_pk_mul_f32 v[222:223], v[158:159], v[6:7] op_sel_hi:[1,0]
  v_pk_mul_f32 v[224:225], v[160:161], v[6:7] op_sel_hi:[1,0]
  v_pk_mul_f32 v[250:251], v[158:159], v[6:7] op_sel:[0,1] op_sel_hi:[1,1]
  v_pk_mul_f32 v[252:253], v[160:161], v[6:7] op_sel:[0,1] op_sel_hi:[1,1]
  ds_read_b64_tr_b16 v[142:143], v10 offset:0
  ds_read_b64_tr_b16 v[144:145], v10 offset:2048
  ds_read_b64_tr_b16 v[146:147], v11 offset:0
  ds_read_b64_tr_b16 v[148:149], v11 offset:2048
  ds_read_b64_tr_b16 v[150:151], v12 offset:0
  ds_read_b64_tr_b16 v[152:153], v12 offset:2048
  ds_read_b64_tr_b16 v[158:159], v10 offset:4096
  s_waitcnt lgkmcnt(3)
  v_mfma_f32_16x16x32_bf16 v[214:217], v[142:145], v[14:17], v[214:217]
  ds_read_b64_tr_b16 v[160:161], v10 offset:6144
  v_mfma_f32_16x16x32_bf16 v[242:245], v[142:145], v[18:21], v[242:245]
  ds_read_b64_tr_b16 v[162:163], v11 offset:4096
  v_mfma_f32_16x16x32_bf16 v[218:221], v[146:149], v[14:17], v[218:221]
  ds_read_b64_tr_b16 v[164:165], v11 offset:6144
  v_mfma_f32_16x16x32_bf16 v[246:249], v[146:149], v[18:21], v[246:249]
  ds_read_b64_tr_b16 v[166:167], v12 offset:4096
  s_waitcnt lgkmcnt(5)
  v_mfma_f32_16x16x32_bf16 v[222:225], v[150:153], v[14:17], v[222:225]
  ds_read_b64_tr_b16 v[168:169], v12 offset:6144
  v_mfma_f32_16x16x32_bf16 v[250:253], v[150:153], v[18:21], v[250:253]
  ds_read_b64_tr_b16 v[142:143], v10 offset:8192
  s_waitcnt lgkmcnt(3)
  v_mfma_f32_16x16x32_bf16 v[214:217], v[158:161], v[22:25], v[214:217]
  ds_read_b64_tr_b16 v[144:145], v10 offset:10240
  v_mfma_f32_16x16x32_bf16 v[242:245], v[158:161], v[26:29], v[242:245]
  ds_read_b64_tr_b16 v[146:147], v11 offset:8192
  v_mfma_f32_16x16x32_bf16 v[218:221], v[162:165], v[22:25], v[218:221]
  ds_read_b64_tr_b16 v[148:149], v11 offset:10240
  v_mfma_f32_16x16x32_bf16 v[246:249], v[162:165], v[26:29], v[246:249]
  ds_read_b64_tr_b16 v[150:151], v12 offset:8192
  s_waitcnt lgkmcnt(5)
  v_mfma_f32_16x16x32_bf16 v[222:225], v[166:169], v[22:25], v[222:225]
  ds_read_b64_tr_b16 v[152:153], v12 offset:10240
  v_mfma_f32_16x16x32_bf16 v[250:253], v[166:169], v[26:29], v[250:253]
  v_mov_b32 v13, v195
  ds_read_b64_tr_b16 v[158:159], v10 offset:12288
  ds_read_b32 v194, v13 offset:0
  s_waitcnt lgkmcnt(4)
  v_mfma_f32_16x16x32_bf16 v[214:217], v[142:145], v[30:33], v[214:217]
  ds_read_b64_tr_b16 v[160:161], v10 offset:14336
  ds_read_b32 v195, v13 offset:64
  v_mfma_f32_16x16x32_bf16 v[242:245], v[142:145], v[34:37], v[242:245]
  ds_read_b64_tr_b16 v[162:163], v11 offset:12288
  ds_read_b32 v196, v13 offset:512
  v_mfma_f32_16x16x32_bf16 v[218:221], v[146:149], v[30:33], v[218:221]
  ds_read_b64_tr_b16 v[164:165], v11 offset:14336
  ds_read_b32 v197, v13 offset:576
  v_mfma_f32_16x16x32_bf16 v[246:249], v[146:149], v[34:37], v[246:249]
  ds_read_b64_tr_b16 v[166:167], v12 offset:12288
  ds_read_b32 v6, v13 offset:1024
  s_waitcnt lgkmcnt(10)
  v_mfma_f32_16x16x32_bf16 v[222:225], v[150:153], v[30:33], v[222:225]
  ds_read_b64_tr_b16 v[168:169], v12 offset:14336
  ds_read_b32 v7, v13 offset:1088
  v_mfma_f32_16x16x32_bf16 v[250:253], v[150:153], v[34:37], v[250:253]
  ds_read_b64_tr_b16 v[142:143], v10 offset:16384
  s_waitcnt lgkmcnt(6)
  v_mfma_f32_16x16x32_bf16 v[214:217], v[158:161], v[38:41], v[214:217]
  ds_read_b64_tr_b16 v[144:145], v10 offset:18432
  v_mfma_f32_16x16x32_bf16 v[242:245], v[158:161], v[42:45], v[242:245]
  ds_read_b64_tr_b16 v[146:147], v11 offset:16384
  v_mfma_f32_16x16x32_bf16 v[218:221], v[162:165], v[38:41], v[218:221]
  ds_read_b64_tr_b16 v[148:149], v11 offset:18432
  v_mfma_f32_16x16x32_bf16 v[246:249], v[162:165], v[42:45], v[246:249]
  ds_read_b64_tr_b16 v[150:151], v12 offset:16384
  s_waitcnt lgkmcnt(6)
  v_mfma_f32_16x16x32_bf16 v[222:225], v[166:169], v[38:41], v[222:225]
  ds_read_b64_tr_b16 v[152:153], v12 offset:18432
  v_mfma_f32_16x16x32_bf16 v[250:253], v[166:169], v[42:45], v[250:253]
  ds_read_b64_tr_b16 v[158:159], v10 offset:20480
  s_waitcnt lgkmcnt(3)
  v_mfma_f32_16x16x32_bf16 v[214:217], v[142:145], v[46:49], v[214:217]
  ds_read_b64_tr_b16 v[160:161], v10 offset:22528
  v_mfma_f32_16x16x32_bf16 v[242:245], v[142:145], v[50:53], v[242:245]
  ds_read_b64_tr_b16 v[162:163], v11 offset:20480
  v_mfma_f32_16x16x32_bf16 v[218:221], v[146:149], v[46:49], v[218:221]
  ds_read_b64_tr_b16 v[164:165], v11 offset:22528
  v_mfma_f32_16x16x32_bf16 v[246:249], v[146:149], v[50:53], v[246:249]
  ds_read_b64_tr_b16 v[166:167], v12 offset:20480
  s_waitcnt lgkmcnt(5)
  v_mfma_f32_16x16x32_bf16 v[222:225], v[150:153], v[46:49], v[222:225]
  ds_read_b64_tr_b16 v[168:169], v12 offset:22528
  v_mfma_f32_16x16x32_bf16 v[250:253], v[150:153], v[50:53], v[250:253]
  ds_read_b64_tr_b16 v[142:143], v10 offset:24576
  s_waitcnt lgkmcnt(3)
  v_mfma_f32_16x16x32_bf16 v[214:217], v[158:161], v[54:57], v[214:217]
  ds_read_b64_tr_b16 v[144:145], v10 offset:26624
  v_mfma_f32_16x16x32_bf16 v[242:245], v[158:161], v[58:61], v[242:245]
  ds_read_b64_tr_b16 v[146:147], v11 offset:24576
  v_mfma_f32_16x16x32_bf16 v[218:221], v[162:165], v[54:57], v[218:221]
  ds_read_b64_tr_b16 v[148:149], v11 offset:26624
  v_mfma_f32_16x16x32_bf16 v[246:249], v[162:165], v[58:61], v[246:249]
  ds_read_b64_tr_b16 v[150:151], v12 offset:24576
  s_waitcnt lgkmcnt(5)
  v_mfma_f32_16x16x32_bf16 v[222:225], v[166:169], v[54:57], v[222:225]
  ds_read_b64_tr_b16 v[152:153], v12 offset:26624
  v_mfma_f32_16x16x32_bf16 v[250:253], v[166:169], v[58:61], v[250:253]
  ds_read_b64_tr_b16 v[158:159], v10 offset:28672
  s_waitcnt lgkmcnt(3)
  v_mfma_f32_16x16x32_bf16 v[214:217], v[142:145], v[62:65], v[214:217]
  ds_read_b64_tr_b16 v[160:161], v10 offset:30720
  v_mfma_f32_16x16x32_bf16 v[242:245], v[142:145], v[66:69], v[242:245]
  ds_read_b64_tr_b16 v[162:163], v11 offset:28672
  v_mfma_f32_16x16x32_bf16 v[218:221], v[146:149], v[62:65], v[218:221]
  ds_read_b64_tr_b16 v[164:165], v11 offset:30720
  v_mfma_f32_16x16x32_bf16 v[246:249], v[146:149], v[66:69], v[246:249]
  ds_read_b64_tr_b16 v[166:167], v12 offset:28672
  s_waitcnt lgkmcnt(5)
  v_mfma_f32_16x16x32_bf16 v[222:225], v[150:153], v[62:65], v[222:225]
  ds_read_b64_tr_b16 v[168:169], v12 offset:30720
  v_mfma_f32_16x16x32_bf16 v[250:253], v[150:153], v[66:69], v[250:253]
  ds_read_b64_tr_b16 v[142:143], v10 offset:32768
  s_waitcnt lgkmcnt(3)
  v_mfma_f32_16x16x32_bf16 v[214:217], v[158:161], v[70:73], v[214:217]
  ds_read_b64_tr_b16 v[144:145], v10 offset:34816
  v_mfma_f32_16x16x32_bf16 v[242:245], v[158:161], v[74:77], v[242:245]
  ds_read_b64_tr_b16 v[146:147], v11 offset:32768
  v_mfma_f32_16x16x32_bf16 v[218:221], v[162:165], v[70:73], v[218:221]
  ds_read_b64_tr_b16 v[148:149], v11 offset:34816
  v_mfma_f32_16x16x32_bf16 v[246:249], v[162:165], v[74:77], v[246:249]
  ds_read_b64_tr_b16 v[150:151], v12 offset:32768
  s_waitcnt lgkmcnt(5)
  v_mfma_f32_16x16x32_bf16 v[222:225], v[166:169], v[70:73], v[222:225]
  ds_read_b64_tr_b16 v[152:153], v12 offset:34816
  v_mfma_f32_16x16x32_bf16 v[250:253], v[166:169], v[74:77], v[250:253]
  ds_read_b64_tr_b16 v[158:159], v10 offset:36864
  s_waitcnt lgkmcnt(3)
  v_mfma_f32_16x16x32_bf16 v[214:217], v[142:145], v[78:81], v[214:217]
  ds_read_b64_tr_b16 v[160:161], v10 offset:38912
  v_mfma_f32_16x16x32_bf16 v[242:245], v[142:145], v[82:85], v[242:245]
  ds_read_b64_tr_b16 v[162:163], v11 offset:36864
  v_mfma_f32_16x16x32_bf16 v[218:221], v[146:149], v[78:81], v[218:221]
  ds_read_b64_tr_b16 v[164:165], v11 offset:38912
  v_mfma_f32_16x16x32_bf16 v[246:249], v[146:149], v[82:85], v[246:249]
  ds_read_b64_tr_b16 v[166:167], v12 offset:36864
  s_waitcnt lgkmcnt(5)
  v_mfma_f32_16x16x32_bf16 v[222:225], v[150:153], v[78:81], v[222:225]
  ds_read_b64_tr_b16 v[168:169], v12 offset:38912
  v_mfma_f32_16x16x32_bf16 v[250:253], v[150:153], v[82:85], v[250:253]
  ds_read_b64_tr_b16 v[142:143], v10 offset:40960
  buffer_load_dwordx2 v[174:175], v191, s[36:39], s58 offen offset:0 sc1
  buffer_load_dwordx2 v[176:177], v191, s[36:39], s58 offen offset:1024 sc1
  s_waitcnt lgkmcnt(3)
  v_mfma_f32_16x16x32_bf16 v[214:217], v[158:161], v[86:89], v[214:217]
  ds_read_b64_tr_b16 v[144:145], v10 offset:43008
  buffer_load_dwordx2 v[178:179], v191, s[36:39], s58 offen offset:2048 sc1
  v_mfma_f32_16x16x32_bf16 v[242:245], v[158:161], v[90:93], v[242:245]
  ds_read_b64_tr_b16 v[146:147], v11 offset:40960
  buffer_load_dwordx2 v[180:181], v191, s[36:39], s58 offen offset:3072 sc1
  v_mfma_f32_16x16x32_bf16 v[218:221], v[162:165], v[86:89], v[218:221]
  ds_read_b64_tr_b16 v[148:149], v11 offset:43008
  buffer_load_dwordx2 v[182:183], v191, s[36:39], s67 offen offset:0 sc1
  buffer_load_dwordx2 v[184:185], v191, s[36:39], s67 offen offset:1024 sc1
  v_mfma_f32_16x16x32_bf16 v[246:249], v[162:165], v[90:93], v[246:249]
  ds_read_b64_tr_b16 v[150:151], v12 offset:40960
  buffer_load_dwordx2 v[186:187], v191, s[36:39], s67 offen offset:2048 sc1
  s_waitcnt lgkmcnt(5)
  v_mfma_f32_16x16x32_bf16 v[222:225], v[166:169], v[86:89], v[222:225]
  ds_read_b64_tr_b16 v[152:153], v12 offset:43008
  buffer_load_dwordx2 v[188:189], v191, s[36:39], s67 offen offset:3072 sc1
  v_mfma_f32_16x16x32_bf16 v[250:253], v[166:169], v[90:93], v[250:253]
  ds_read_b64_tr_b16 v[158:159], v10 offset:45056
  s_waitcnt lgkmcnt(3)
  v_mfma_f32_16x16x32_bf16 v[214:217], v[142:145], v[94:97], v[214:217]
  ds_read_b64_tr_b16 v[160:161], v10 offset:47104
  v_mfma_f32_16x16x32_bf16 v[242:245], v[142:145], v[98:101], v[242:245]
  ds_read_b64_tr_b16 v[162:163], v11 offset:45056
  v_mfma_f32_16x16x32_bf16 v[218:221], v[146:149], v[94:97], v[218:221]
  ds_read_b64_tr_b16 v[164:165], v11 offset:47104
  v_mfma_f32_16x16x32_bf16 v[246:249], v[146:149], v[98:101], v[246:249]
  ds_read_b64_tr_b16 v[166:167], v12 offset:45056
  s_waitcnt lgkmcnt(5)
  v_mfma_f32_16x16x32_bf16 v[222:225], v[150:153], v[94:97], v[222:225]
  ds_read_b64_tr_b16 v[168:169], v12 offset:47104
  v_mfma_f32_16x16x32_bf16 v[250:253], v[150:153], v[98:101], v[250:253]
  ds_read_b64_tr_b16 v[142:143], v10 offset:49152
  s_waitcnt lgkmcnt(3)
  v_mfma_f32_16x16x32_bf16 v[214:217], v[158:161], v[102:105], v[214:217]
  ds_read_b64_tr_b16 v[144:145], v10 offset:51200
  v_mfma_f32_16x16x32_bf16 v[242:245], v[158:161], v[106:109], v[242:245]
  ds_read_b64_tr_b16 v[146:147], v11 offset:49152
  v_mfma_f32_16x16x32_bf16 v[218:221], v[162:165], v[102:105], v[218:221]
  ds_read_b64_tr_b16 v[148:149], v11 offset:51200
  v_mfma_f32_16x16x32_bf16 v[246:249], v[162:165], v[106:109], v[246:249]
  ds_read_b64_tr_b16 v[150:151], v12 offset:49152
  s_waitcnt lgkmcnt(5)
  v_mfma_f32_16x16x32_bf16 v[222:225], v[166:169], v[102:105], v[222:225]
  ds_read_b64_tr_b16 v[152:153], v12 offset:51200
  v_mfma_f32_16x16x32_bf16 v[250:253], v[166:169], v[106:109], v[250:253]
  s_mov_b32 s6, 131072
  s_waitcnt vmcnt(0)
L_p3_poll4:
  v_min3_u32 v4, v175, v177, v179
  v_min3_u32 v4, v4, v181, v183
  v_min3_u32 v4, v4, v185, v187
  v_min_u32 v4, v4, v189
  v_cmp_eq_u32 vcc, 0, v4
  s_sub_u32 s6, s6, 1
  s_cbranch_scc1 L_p3_pollx4
  s_nop 2
  s_cbranch_vccz L_p3_pollx4
  buffer_load_dwordx2 v[174:175], v191, s[36:39], s58 offen offset:0 sc1
  buffer_load_dwordx2 v[176:177], v191, s[36:39], s58 offen offset:1024 sc1
  buffer_load_dwordx2 v[178:179], v191, s[36:39], s58 offen offset:2048 sc1
  buffer_load_dwordx2 v[180:181], v191, s[36:39], s58 offen offset:3072 sc1
  buffer_load_dwordx2 v[182:183], v191, s[36:39], s67 offen offset:0 sc1
  buffer_load_dwordx2 v[184:185], v191, s[36:39], s67 offen offset:1024 sc1
  buffer_load_dwordx2 v[186:187], v191, s[36:39], s67 offen offset:2048 sc1
  buffer_load_dwordx2 v[188:189], v191, s[36:39], s67 offen offset:3072 sc1
  s_waitcnt vmcnt(0)
  s_branch L_p3_poll4
L_p3_pollx4:
  v_pk_add_f32 v[174:175], v[174:175], v[176:177]
  v_pk_add_f32 v[178:179], v[178:179], v[180:181]
  v_pk_add_f32 v[182:183], v[182:183], v[184:185]
  v_pk_add_f32 v[186:187], v[186:187], v[188:189]
  v_pk_add_f32 v[174:175], v[174:175], v[178:179]
  v_pk_add_f32 v[182:183], v[182:183], v[186:187]
  v_pk_add_f32 v[174:175], v[174:175], v[182:183]
  v_mov_b32 v176, v174
  v_mov_b32 v177, v175
  s_nop 0
  v_permlane32_swap_b32 v174, v176
  v_permlane32_swap_b32 v175, v177
  v_pk_add_f32 v[174:175], v[174:175], v[176:177]
  v_mul_f32 v174, 0xba924925, v174
  v_mul_f32 v175, 0x3a924925, v175
  v_fma_f32 v175, -v174, v174, v175
  v_max_f32 v175, 0, v175
  v_add_f32 v175, 0x3727c5ac, v175
  v_rsq_f32 v175, v175
  s_nop 0
  v_mul_f32 v174, v174, v175
  ds_write_b32 v192, v175
  ds_write_b32 v192, v174 offset:128
  ds_read_b128 v[174:177], v193 offset:0
  ds_read_b128 v[182:185], v193 offset:128
  ds_read_b128 v[178:181], v193 offset:64
  ds_read_b128 v[186:189], v193 offset:192
  ds_read_b64_tr_b16 v[158:159], v10 offset:53248
  s_waitcnt lgkmcnt(9)
  v_mfma_f32_16x16x32_bf16 v[214:217], v[142:145], v[110:113], v[214:217]
  ds_read_b64_tr_b16 v[160:161], v10 offset:55296
  v_mfma_f32_16x16x32_bf16 v[242:245], v[142:145], v[114:117], v[242:245]
  ds_read_b64_tr_b16 v[162:163], v11 offset:53248
  v_mfma_f32_16x16x32_bf16 v[218:221], v[146:149], v[110:113], v[218:221]
  ds_read_b64_tr_b16 v[164:165], v11 offset:55296
  v_mfma_f32_16x16x32_bf16 v[246:249], v[146:149], v[114:117], v[246:249]
  ds_read_b64_tr_b16 v[166:167], v12 offset:53248
  s_waitcnt lgkmcnt(11)
  v_mfma_f32_16x16x32_bf16 v[222:225], v[150:153], v[110:113], v[222:225]
  ds_read_b64_tr_b16 v[168:169], v12 offset:55296
  v_mfma_f32_16x16x32_bf16 v[250:253], v[150:153], v[114:117], v[250:253]
  s_waitcnt lgkmcnt(6)
  v_pk_fma_f32 v[198:199], v[198:199], v[174:175], v[182:183]
  v_pk_fma_f32 v[200:201], v[200:201], v[176:177], v[184:185]
  v_pk_fma_f32 v[226:227], v[226:227], v[178:179], v[186:187]
  v_pk_fma_f32 v[228:229], v[228:229], v[180:181], v[188:189]
  v_cvt_pk_bf16_f32 v198, v198, v199
  v_cvt_pk_bf16_f32 v199, v200, v201
  v_cvt_pk_bf16_f32 v200, v226, v227
  v_cvt_pk_bf16_f32 v201, v228, v229
  s_nop 0
  v_permlane32_swap_b32 v198, v200
  v_permlane32_swap_b32 v199, v201
  v_pk_fma_f32 v[202:203], v[202:203], v[174:175], v[182:183]
  v_pk_fma_f32 v[204:205], v[204:205], v[176:177], v[184:185]
  v_pk_fma_f32 v[230:231], v[230:231], v[178:179], v[186:187]
  v_pk_fma_f32 v[232:233], v[232:233], v[180:181], v[188:189]
  v_cvt_pk_bf16_f32 v202, v202, v203
  v_cvt_pk_bf16_f32 v203, v204, v205
  v_cvt_pk_bf16_f32 v204, v230, v231
  v_cvt_pk_bf16_f32 v205, v232, v233
  v_permlane16_swap_b32 v198, v200
  v_permlane16_swap_b32 v199, v201
  buffer_store_dwordx4 v[198:201], v1, s[36:39], s66 offen offset:0 sc1
  v_permlane32_swap_b32 v202, v204
  v_permlane32_swap_b32 v203, v205
  v_pk_fma_f32 v[206:207], v[206:207], v[174:175], v[182:183]
  v_pk_fma_f32 v[208:209], v[208:209], v[176:177], v[184:185]
  v_pk_fma_f32 v[234:235], v[234:235], v[178:179], v[186:187]
  v_pk_fma_f32 v[236:237], v[236:237], v[180:181], v[188:189]
  v_cvt_pk_bf16_f32 v206, v206, v207
  v_cvt_pk_bf16_f32 v207, v208, v209
  v_cvt_pk_bf16_f32 v208, v234, v235
  v_cvt_pk_bf16_f32 v209, v236, v237
  v_permlane16_swap_b32 v202, v204
  v_permlane16_swap_b32 v203, v205
  buffer_store_dwordx4 v[202:205], v1, s[36:39], s66 offen offset:1024 sc1
  v_permlane32_swap_b32 v206, v208
  v_permlane32_swap_b32 v207, v209
  v_pk_fma_f32 v[210:211], v[210:211], v[174:175], v[182:183]
  v_pk_fma_f32 v[212:213], v[212:213], v[176:177], v[184:185]
  v_pk_fma_f32 v[238:239], v[238:239], v[178:179], v[186:187]
  v_pk_fma_f32 v[240:241], v[240:241], v[180:181], v[188:189]
  v_cvt_pk_bf16_f32 v210, v210, v211
  v_cvt_pk_bf16_f32 v211, v212, v213
  v_cvt_pk_bf16_f32 v212, v238, v239
  v_cvt_pk_bf16_f32 v213, v240, v241
  v_permlane16_swap_b32 v206, v208
  v_permlane16_swap_b32 v207, v209
  buffer_store_dwordx4 v[206:209], v1, s[36:39], s66 offen offset:2048 sc1
  v_permlane32_swap_b32 v210, v212
  v_permlane32_swap_b32 v211, v213
  s_nop 0
  v_permlane16_swap_b32 v210, v212
  v_permlane16_swap_b32 v211, v213
  buffer_store_dwordx4 v[210:213], v1, s[36:39], s66 offen offset:3072 sc1
  ds_read_b64_tr_b16 v[142:143], v10 offset:57344
  s_waitcnt lgkmcnt(3)
  v_mfma_f32_16x16x32_bf16 v[214:217], v[158:161], v[118:121], v[214:217]
  ds_read_b64_tr_b16 v[144:145], v10 offset:59392
  v_mfma_f32_16x16x32_bf16 v[242:245], v[158:161], v[122:125], v[242:245]
  ds_read_b64_tr_b16 v[146:147], v11 offset:57344
  v_mfma_f32_16x16x32_bf16 v[218:221], v[162:165], v[118:121], v[218:221]
  ds_read_b64_tr_b16 v[148:149], v11 offset:59392
  v_mfma_f32_16x16x32_bf16 v[246:249], v[162:165], v[122:125], v[246:249]
  ds_read_b64_tr_b16 v[150:151], v12 offset:57344
  s_waitcnt lgkmcnt(5)
  v_mfma_f32_16x16x32_bf16 v[222:225], v[166:169], v[118:121], v[222:225]
  ds_read_b64_tr_b16 v[152:153], v12 offset:59392
  v_mfma_f32_16x16x32_bf16 v[250:253], v[166:169], v[122:125], v[250:253]
  ds_read_b64_tr_b16 v[158:159], v10 offset:61440
  s_waitcnt lgkmcnt(3)
  v_mfma_f32_16x16x32_bf16 v[214:217], v[142:145], v[126:129], v[214:217]
  ds_read_b64_tr_b16 v[160:161], v10 offset:63488
  v_mfma_f32_16x16x32_bf16 v[242:245], v[142:145], v[130:133], v[242:245]
  ds_read_b64_tr_b16 v[162:163], v11 offset:61440
  v_mfma_f32_16x16x32_bf16 v[218:221], v[146:149], v[126:129], v[218:221]
  ds_read_b64_tr_b16 v[164:165], v11 offset:63488
  v_mfma_f32_16x16x32_bf16 v[246:249], v[146:149], v[130:133], v[246:249]
  ds_read_b64_tr_b16 v[166:167], v12 offset:61440
  s_waitcnt lgkmcnt(5)
  v_mfma_f32_16x16x32_bf16 v[222:225], v[150:153], v[126:129], v[222:225]
  ds_read_b64_tr_b16 v[168:169], v12 offset:63488
  v_mfma_f32_16x16x32_bf16 v[250:253], v[150:153], v[130:133], v[250:253]
  s_waitcnt lgkmcnt(0)
  v_mfma_f32_16x16x32_bf16 v[214:217], v[158:161], v[134:137], v[214:217]
  v_mfma_f32_16x16x32_bf16 v[242:245], v[158:161], v[138:141], v[242:245]
  v_mfma_f32_16x16x32_bf16 v[218:221], v[162:165], v[134:137], v[218:221]
  v_mfma_f32_16x16x32_bf16 v[246:249], v[162:165], v[138:141], v[246:249]
  v_mfma_f32_16x16x32_bf16 v[222:225], v[166:169], v[134:137], v[222:225]
  v_mfma_f32_16x16x32_bf16 v[250:253], v[166:169], v[138:141], v[250:253]
  s_lshl_b32 s56, s48, 4
  s_add_u32 s56, s56, s49
  s_lshl_b32 s56, s56, 7
  s_add_u32 s56, s56, 0xb3c000
  v_mov_b32 v8, 1
  v_mov_b32 v9, 0
  s_waitcnt vmcnt(0)
  s_barrier
  s_cmp_eq_u32 s3, 0
  s_cbranch_scc0 L_skip10
  s_mov_b64 exec, 1
  buffer_store_dword v8, v9, s[36:39], s56 offen sc1
  s_mov_b64 exec, -1
L_skip10:
  s_barrier
  v_pk_mul_f32 v[14:15], v[214:215], v[214:215]
  v_pk_mul_f32 v[16:17], v[216:217], v[216:217]
  v_pk_mul_f32 v[18:19], v[218:219], v[218:219]
  v_pk_mul_f32 v[20:21], v[220:221], v[220:221]
  v_pk_fma_f32 v[14:15], v[14:15], v[196:197], v[194:195] op_sel_hi:[1,0,0]
  v_pk_fma_f32 v[16:17], v[16:17], v[196:197], v[194:195] op_sel_hi:[1,0,0]
  v_pk_fma_f32 v[18:19], v[18:19], v[196:197], v[194:195] op_sel_hi:[1,0,0]
  v_pk_fma_f32 v[20:21], v[20:21], v[196:197], v[194:195] op_sel_hi:[1,0,0]
  v_pk_mul_f32 v[14:15], v[14:15], v[214:215]
  v_pk_mul_f32 v[16:17], v[16:17], v[216:217]
  v_pk_mul_f32 v[18:19], v[18:19], v[218:219]
  v_pk_mul_f32 v[20:21], v[20:21], v[220:221]
  v_exp_f32 v14, v14
  v_exp_f32 v15, v15
  v_exp_f32 v16, v16
  v_exp_f32 v17, v17
  v_exp_f32 v18, v18
  v_exp_f32 v19, v19
  v_exp_f32 v20, v20
  v_exp_f32 v21, v21
  v_pk_fma_f32 v[14:15], v[14:15], v[6:7], v[6:7] op_sel_hi:[1,0,0]
  v_pk_fma_f32 v[16:17], v[16:17], v[6:7], v[6:7] op_sel_hi:[1,0,0]
  v_pk_fma_f32 v[18:19], v[18:19], v[6:7], v[6:7] op_sel_hi:[1,0,0]
  v_pk_fma_f32 v[20:21], v[20:21], v[6:7], v[6:7] op_sel_hi:[1,0,0]
  v_rcp_f32 v14, v14
  v_rcp_f32 v15, v15
  v_rcp_f32 v16, v16
  v_rcp_f32 v17, v17
  v_rcp_f32 v18, v18
  v_rcp_f32 v19, v19
  v_rcp_f32 v20, v20
  v_rcp_f32 v21, v21
  v_pk_mul_f32 v[214:215], v[214:215], v[14:15]
  v_pk_mul_f32 v[216:217], v[216:217], v[16:17]
  v_pk_mul_f32 v[218:219], v[218:219], v[18:19]
  v_pk_mul_f32 v[220:221], v[220:221], v[20:21]
  v_cvt_pk_bf16_f32 v104, v214, v215
  v_cvt_pk_bf16_f32 v105, v216, v217
  v_cvt_pk_bf16_f32 v106, v218, v219
  v_cvt_pk_bf16_f32 v107, v220, v221
  v_pk_mul_f32 v[14:15], v[242:243], v[242:243]
  v_pk_mul_f32 v[16:17], v[244:245], v[244:245]
  v_pk_mul_f32 v[18:19], v[246:247], v[246:247]
  v_pk_mul_f32 v[20:21], v[248:249], v[248:249]
  v_pk_fma_f32 v[14:15], v[14:15], v[196:197], v[194:195] op_sel:[0,1,1] op_sel_hi:[1,1,1]
  v_pk_fma_f32 v[16:17], v[16:17], v[196:197], v[194:195] op_sel:[0,1,1] op_sel_hi:[1,1,1]
  v_pk_fma_f32 v[18:19], v[18:19], v[196:197], v[194:195] op_sel:[0,1,1] op_sel_hi:[1,1,1]
  v_pk_fma_f32 v[20:21], v[20:21], v[196:197], v[194:195] op_sel:[0,1,1] op_sel_hi:[1,1,1]
  v_pk_mul_f32 v[14:15], v[14:15], v[242:243]
  v_pk_mul_f32 v[16:17], v[16:17], v[244:245]
  v_pk_mul_f32 v[18:19], v[18:19], v[246:247]
  v_pk_mul_f32 v[20:21], v[20:21], v[248:249]
  v_exp_f32 v14, v14
  v_exp_f32 v15, v15
  v_exp_f32 v16, v16
  v_exp_f32 v17, v17
  v_exp_f32 v18, v18
  v_exp_f32 v19, v19
  v_exp_f32 v20, v20
  v_exp_f32 v21, v21
  v_pk_fma_f32 v[14:15], v[14:15], v[6:7], v[6:7] op_sel:[0,1,1] op_sel_hi:[1,1,1]
  v_pk_fma_f32 v[16:17], v[16:17], v[6:7], v[6:7] op_sel:[0,1,1] op_sel_hi:[1,1,1]
  v_pk_fma_f32 v[18:19], v[18:19], v[6:7], v[6:7] op_sel:[0,1,1] op_sel_hi:[1,1,1]
  v_pk_fma_f32 v[20:21], v[20:21], v[6:7], v[6:7] op_sel:[0,1,1] op_sel_hi:[1,1,1]
  v_rcp_f32 v14, v14
  v_rcp_f32 v15, v15
  v_rcp_f32 v16, v16
  v_rcp_f32 v17, v17
  v_rcp_f32 v18, v18
  v_rcp_f32 v19, v19
  v_rcp_f32 v20, v20
  v_rcp_f32 v21, v21
  v_pk_mul_f32 v[242:243], v[242:243], v[14:15]
  v_pk_mul_f32 v[244:245], v[244:245], v[16:17]
  v_pk_mul_f32 v[246:247], v[246:247], v[18:19]
  v_pk_mul_f32 v[248:249], v[248:249], v[20:21]
  v_cvt_pk_bf16_f32 v108, v242, v243
  v_cvt_pk_bf16_f32 v109, v244, v245
  v_cvt_pk_bf16_f32 v110, v246, v247
  v_cvt_pk_bf16_f32 v111, v248, v249
  v_pk_mul_f32 v[14:15], v[222:223], v[222:223]
  v_pk_mul_f32 v[16:17], v[224:225], v[224:225]
  v_pk_fma_f32 v[14:15], v[14:15], v[196:197], v[194:195] op_sel_hi:[1,0,0]
  v_pk_fma_f32 v[16:17], v[16:17], v[196:197], v[194:195] op_sel_hi:[1,0,0]
  v_pk_mul_f32 v[14:15], v[14:15], v[222:223]
  v_pk_mul_f32 v[16:17], v[16:17], v[224:225]
  v_exp_f32 v14, v14
  v_exp_f32 v15, v15
  v_exp_f32 v16, v16
  v_exp_f32 v17, v17
  v_pk_fma_f32 v[14:15], v[14:15], v[6:7], v[6:7] op_sel_hi:[1,0,0]
  v_pk_fma_f32 v[16:17], v[16:17], v[6:7], v[6:7] op_sel_hi:[1,0,0]
  v_rcp_f32 v14, v14
  v_rcp_f32 v15, v15
  v_rcp_f32 v16, v16
  v_rcp_f32 v17, v17
  v_pk_mul_f32 v[222:223], v[222:223], v[14:15]
  v_pk_mul_f32 v[224:225], v[224:225], v[16:17]
  v_cvt_pk_bf16_f32 v112, v222, v223
  v_cvt_pk_bf16_f32 v113, v224, v225
  v_pk_mul_f32 v[14:15], v[250:251], v[250:251]
  v_pk_mul_f32 v[16:17], v[252:253], v[252:253]
  v_pk_fma_f32 v[14:15], v[14:15], v[196:197], v[194:195] op_sel:[0,1,1] op_sel_hi:[1,1,1]
  v_pk_fma_f32 v[16:17], v[16:17], v[196:197], v[194:195] op_sel:[0,1,1] op_sel_hi:[1,1,1]
  v_pk_mul_f32 v[14:15], v[14:15], v[250:251]
  v_pk_mul_f32 v[16:17], v[16:17], v[252:253]
  v_exp_f32 v14, v14
  v_exp_f32 v15, v15
  v_exp_f32 v16, v16
  v_exp_f32 v17, v17
  v_pk_fma_f32 v[14:15], v[14:15], v[6:7], v[6:7] op_sel:[0,1,1] op_sel_hi:[1,1,1]
  v_pk_fma_f32 v[16:17], v[16:17], v[6:7], v[6:7] op_sel:[0,1,1] op_sel_hi:[1,1,1]
  v_rcp_f32 v14, v14
  v_rcp_f32 v15, v15
  v_rcp_f32 v16, v16
  v_rcp_f32 v17, v17
  v_pk_mul_f32 v[250:251], v[250:251], v[14:15]
  v_pk_mul_f32 v[252:253], v[252:253], v[16:17]
  v_cvt_pk_bf16_f32 v116, v250, v251
  v_cvt_pk_bf16_f32 v117, v252, v253
  s_branch L_p3_done
L_p3_v3:
  v_bfe_u32 v4, v0, 3, 2
  v_and_b32 v5, 3, v0
  v_lshlrev_b32 v5, 3, v5
  v_lshrrev_b32 v13, 2, v0
  v_lshl_add_u32 v5, v13, 7, v5
  v_add_u32 v13, 0x10000, v5
  s_bfe_u32 s69, s49, 0x20001
  s_lshl_b32 s68, s69, 2
  s_lshr_b32 s80, 0x1020, s68
  s_and_b32 s80, s80, 15
  s_lshr_b32 s81, 0x2131, s68
  s_and_b32 s81, s81, 15
  s_lshr_b32 s82, 0x3212, s68
  s_and_b32 s82, s82, 15
  v_xor_b32 v6, s80, v4
  v_lshl_add_u32 v6, v6, 5, v5
  v_xor_b32 v7, s81, v4
  v_lshl_add_u32 v7, v7, 5, v5
  v_xor_b32 v8, s82, v4
  v_lshl_add_u32 v8, v8, 5, v5
  v_xor_b32 v9, 0, v4
  v_lshl_add_u32 v9, v9, 5, v13
  v_xor_b32 v10, 1, v4
  v_lshl_add_u32 v10, v10, 5, v13
  v_xor_b32 v11, 2, v4
  v_lshl_add_u32 v11, v11, 5, v13
  v_xor_b32 v12, 3, v4
  v_lshl_add_u32 v12, v12, 5, v13
  s_lshr_b32 s6, s49, 1
  s_lshl_b32 s66, s6, 6
  s_lshr_b32 s7, s50, 1
  s_add_u32 s66, s66, s7
  s_mul_i32 s66, s66, 7168
  s_add_u32 s66, s66, 0x780000
  s_lshr_b32 s7, 0x0054, s68
  s_and_b32 s7, s7, 15
  s_lshl_b32 s7, s7, 10
  s_add_u32 s83, s66, s7
  s_lshr_b32 s7, 0x1165, s68
  s_and_b32 s7, s7, 15
  s_lshl_b32 s7, s7, 10
  s_add_u32 s84, s66, s7
  s_lshr_b32 s7, 0x2606, s68
  s_and_b32 s7, s7, 15
  s_lshl_b32 s7, s7, 10
  s_add_u32 s85, s66, s7
  s_lshl_b32 s7, s69, 10
  s_add_u32 s66, s66, s7
  s_lshl_b32 s60, s50, 3
  s_add_u32 s60, s60, s6
  s_mul_i32 s60, s60, 3584
  s_add_u32 s60, s60, 0x400000
  s_add_u32 s61, s60, 28672
  s_lshr_b32 s7, s69, 1
  s_xor_b32 s7, s7, 0
  s_lshl_b32 s7, s7, 10
  s_add_u32 s54, s60, s7
  s_add_u32 s55, s61, s7
  s_lshl_b32 s58, s48, 14
  s_lshl_b32 s6, s3, 8
  s_add_u32 s58, s58, s6
  s_add_u32 s58, s58, 0xb44000
  s_lshl_b32 s6, s49, 10
  s_add_u32 s59, s58, s6
  s_add_u32 s67, s58, 4096
  v_lshrrev_b32 v4, 3, v3
  v_lshlrev_b32 v190, 7, v4
  v_lshl_add_u32 v190, v2, 5, v190
  v_and_b32 v4, 6, v3
  v_lshl_add_u32 v190, v4, 2, v190
  v_and_b32 v4, 31, v0
  v_lshlrev_b32 v191, 3, v4
  s_lshl_b32 s6, s3, 8
  s_add_u32 s6, s6, 147456
  v_lshl_add_u32 v192, v4, 2, s6
  v_lshl_add_u32 v193, v2, 4, s6
  v_lshrrev_b32 v4, 5, v0
  v_lshl_add_u32 v191, v4, 13, v191
  v_and_b32 v4, 2, v3
  v_cmp_eq_u32 s[64:65], 2, v4
  s_lshl_b32 s6, s3, 7
  s_add_u32 s6, s6, 148480
  v_lshl_add_u32 v194, v2, 4, s6
  v_lshl_add_u32 v195, v3, 2, s6
  v_lshlrev_b32 v196, 2, v3
  v_add_u32 v196, 150528, v196
  v_lshlrev_b32 v197, 4, v2
  v_add_u32 v197, 150528, v197
  s_lshl_b32 s6, s3, 9
  s_add_u32 s57, s57, s6
  v_lshlrev_b32 v5, 7, v0
  s_mov_b64 exec, 0xf
  s_mov_b32 s6, 131072
L_pollS23:
  buffer_load_dword v4, v5, s[36:39], s57 offen sc1
  s_sub_u32 s6, s6, 1
  s_cbranch_scc1 L_pollxS23
  s_waitcnt vmcnt(0)
  v_cmp_eq_u32 vcc, 0, v4
  s_nop 4
  s_cbranch_vccnz L_pollS23
L_pollxS23:
  s_mov_b64 exec, -1
  buffer_load_dwordx4 v[14:17], v1, s[36:39], s52 offen offset:0 sc1
  buffer_load_dwordx4 v[18:21], v1, s[36:39], s53 offen offset:0 sc1
  buffer_load_dwordx4 v[22:25], v1, s[36:39], s52 offen offset:1024 sc1
  buffer_load_dwordx4 v[26:29], v1, s[36:39], s53 offen offset:1024 sc1
  buffer_load_dwordx4 v[30:33], v1, s[36:39], s52 offen offset:2048 sc1
  buffer_load_dwordx4 v[34:37], v1, s[36:39], s53 offen offset:2048 sc1
  buffer_load_dwordx4 v[38:41], v1, s[36:39], s52 offen offset:3072 sc1
  buffer_load_dwordx4 v[42:45], v1, s[36:39], s53 offen offset:3072 sc1
  s_add_u32 s52, s52, 4096
  buffer_load_dwordx4 v[46:49], v1, s[36:39], s52 offen offset:0 sc1
  s_add_u32 s53, s53, 4096
  buffer_load_dwordx4 v[50:53], v1, s[36:39], s53 offen offset:0 sc1
  buffer_load_dwordx4 v[54:57], v1, s[36:39], s52 offen offset:1024 sc1
  buffer_load_dwordx4 v[58:61], v1, s[36:39], s53 offen offset:1024 sc1
  ds_read_b64_tr_b16 v[142:143], v6 offset:0
  ds_read_b64_tr_b16 v[144:145], v6 offset:2048
  ds_read_b64_tr_b16 v[146:147], v7 offset:0
  ds_read_b64_tr_b16 v[148:149], v7 offset:2048
  ds_read_b64_tr_b16 v[150:151], v8 offset:0
  ds_read_b64_tr_b16 v[152:153], v8 offset:2048
  ds_read_b64_tr_b16 v[158:159], v6 offset:4096
  buffer_load_dwordx4 v[62:65], v1, s[36:39], s52 offen offset:2048 sc1
  s_waitcnt vmcnt(11) lgkmcnt(3)
  v_mfma_f32_16x16x32_bf16 v[198:201], v[14:17], v[142:145], 0
  ds_read_b64_tr_b16 v[160:161], v6 offset:6144
  v_mfma_f32_16x16x32_bf16 v[226:229], v[18:21], v[142:145], 0
  ds_read_b64_tr_b16 v[162:163], v7 offset:4096
  v_mfma_f32_16x16x32_bf16 v[202:205], v[14:17], v[146:149], 0
  ds_read_b64_tr_b16 v[164:165], v7 offset:6144
  buffer_load_dwordx4 v[66:69], v1, s[36:39], s53 offen offset:2048 sc1
  v_mfma_f32_16x16x32_bf16 v[230:233], v[18:21], v[146:149], 0
  ds_read_b64_tr_b16 v[166:167], v8 offset:4096
  s_waitcnt lgkmcnt(5)
  v_mfma_f32_16x16x32_bf16 v[206:209], v[14:17], v[150:153], 0
  ds_read_b64_tr_b16 v[168:169], v8 offset:6144
  v_mfma_f32_16x16x32_bf16 v[234:237], v[18:21], v[150:153], 0
  ds_read_b64_tr_b16 v[142:143], v6 offset:8192
  buffer_load_dwordx4 v[70:73], v1, s[36:39], s52 offen offset:3072 sc1
  s_waitcnt vmcnt(11) lgkmcnt(3)
  v_mfma_f32_16x16x32_bf16 v[198:201], v[22:25], v[158:161], v[198:201]
  ds_read_b64_tr_b16 v[144:145], v6 offset:10240
  v_mfma_f32_16x16x32_bf16 v[226:229], v[26:29], v[158:161], v[226:229]
  ds_read_b64_tr_b16 v[146:147], v7 offset:8192
  v_mfma_f32_16x16x32_bf16 v[202:205], v[22:25], v[162:165], v[202:205]
  ds_read_b64_tr_b16 v[148:149], v7 offset:10240
  buffer_load_dwordx4 v[74:77], v1, s[36:39], s53 offen offset:3072 sc1
  v_mfma_f32_16x16x32_bf16 v[230:233], v[26:29], v[162:165], v[230:233]
  ds_read_b64_tr_b16 v[150:151], v8 offset:8192
  s_waitcnt lgkmcnt(5)
  v_mfma_f32_16x16x32_bf16 v[206:209], v[22:25], v[166:169], v[206:209]
  ds_read_b64_tr_b16 v[152:153], v8 offset:10240
  v_mfma_f32_16x16x32_bf16 v[234:237], v[26:29], v[166:169], v[234:237]
  ds_read_b64_tr_b16 v[158:159], v6 offset:12288
  s_add_u32 s52, s52, 4096
  buffer_load_dwordx4 v[78:81], v1, s[36:39], s52 offen offset:0 sc1
  s_waitcnt vmcnt(11) lgkmcnt(3)
  v_mfma_f32_16x16x32_bf16 v[198:201], v[30:33], v[142:145], v[198:201]
  ds_read_b64_tr_b16 v[160:161], v6 offset:14336
  v_mfma_f32_16x16x32_bf16 v[226:229], v[34:37], v[142:145], v[226:229]
  ds_read_b64_tr_b16 v[162:163], v7 offset:12288
  v_mfma_f32_16x16x32_bf16 v[202:205], v[30:33], v[146:149], v[202:205]
  ds_read_b64_tr_b16 v[164:165], v7 offset:14336
  s_add_u32 s53, s53, 4096
  buffer_load_dwordx4 v[82:85], v1, s[36:39], s53 offen offset:0 sc1
  v_mfma_f32_16x16x32_bf16 v[230:233], v[34:37], v[146:149], v[230:233]
  ds_read_b64_tr_b16 v[166:167], v8 offset:12288
  s_waitcnt lgkmcnt(5)
  v_mfma_f32_16x16x32_bf16 v[206:209], v[30:33], v[150:153], v[206:209]
  ds_read_b64_tr_b16 v[168:169], v8 offset:14336
  v_mfma_f32_16x16x32_bf16 v[234:237], v[34:37], v[150:153], v[234:237]
  s_barrier
  ds_read_b64_tr_b16 v[142:143], v6 offset:16384
  buffer_load_dwordx4 v[86:89], v1, s[36:39], s52 offen offset:1024 sc1
  s_waitcnt vmcnt(11) lgkmcnt(3)
  v_mfma_f32_16x16x32_bf16 v[198:201], v[38:41], v[158:161], v[198:201]
  ds_read_b64_tr_b16 v[144:145], v6 offset:18432
  v_mfma_f32_16x16x32_bf16 v[226:229], v[42:45], v[158:161], v[226:229]
  ds_read_b64_tr_b16 v[146:147], v7 offset:16384
  v_mfma_f32_16x16x32_bf16 v[202:205], v[38:41], v[162:165], v[202:205]
  ds_read_b64_tr_b16 v[148:149], v7 offset:18432
  buffer_load_dwordx4 v[90:93], v1, s[36:39], s53 offen offset:1024 sc1
  v_mfma_f32_16x16x32_bf16 v[230:233], v[42:45], v[162:165], v[230:233]
  ds_read_b64_tr_b16 v[150:151], v8 offset:16384
  s_waitcnt lgkmcnt(5)
  v_mfma_f32_16x16x32_bf16 v[206:209], v[38:41], v[166:169], v[206:209]
  ds_read_b64_tr_b16 v[152:153], v8 offset:18432
  v_mfma_f32_16x16x32_bf16 v[234:237], v[42:45], v[166:169], v[234:237]
  ds_read_b64_tr_b16 v[158:159], v6 offset:20480
  buffer_load_dwordx4 v[94:97], v1, s[36:39], s52 offen offset:2048 sc1
  s_waitcnt vmcnt(11) lgkmcnt(3)
  v_mfma_f32_16x16x32_bf16 v[198:201], v[46:49], v[142:145], v[198:201]
  ds_read_b64_tr_b16 v[160:161], v6 offset:22528
  v_mfma_f32_16x16x32_bf16 v[226:229], v[50:53], v[142:145], v[226:229]
  ds_read_b64_tr_b16 v[162:163], v7 offset:20480
  v_mfma_f32_16x16x32_bf16 v[202:205], v[46:49], v[146:149], v[202:205]
  ds_read_b64_tr_b16 v[164:165], v7 offset:22528
  buffer_load_dwordx4 v[98:101], v1, s[36:39], s53 offen offset:2048 sc1
  v_mfma_f32_16x16x32_bf16 v[230:233], v[50:53], v[146:149], v[230:233]
  ds_read_b64_tr_b16 v[166:167], v8 offset:20480
  s_waitcnt lgkmcnt(5)
  v_mfma_f32_16x16x32_bf16 v[206:209], v[46:49], v[150:153], v[206:209]
  ds_read_b64_tr_b16 v[168:169], v8 offset:22528
  v_mfma_f32_16x16x32_bf16 v[234:237], v[50:53], v[150:153], v[234:237]
  ds_read_b64_tr_b16 v[142:143], v6 offset:24576
  buffer_load_dwordx4 v[102:105], v1, s[36:39], s52 offen offset:3072 sc1
  s_waitcnt vmcnt(11) lgkmcnt(3)
  v_mfma_f32_16x16x32_bf16 v[198:201], v[54:57], v[158:161], v[198:201]
  ds_read_b64_tr_b16 v[144:145], v6 offset:26624
  v_mfma_f32_16x16x32_bf16 v[226:229], v[58:61], v[158:161], v[226:229]
  ds_read_b64_tr_b16 v[146:147], v7 offset:24576
  v_mfma_f32_16x16x32_bf16 v[202:205], v[54:57], v[162:165], v[202:205]
  ds_read_b64_tr_b16 v[148:149], v7 offset:26624
  buffer_load_dwordx4 v[106:109], v1, s[36:39], s53 offen offset:3072 sc1
  v_mfma_f32_16x16x32_bf16 v[230:233], v[58:61], v[162:165], v[230:233]
  ds_read_b64_tr_b16 v[150:151], v8 offset:24576
  s_waitcnt lgkmcnt(5)
  v_mfma_f32_16x16x32_bf16 v[206:209], v[54:57], v[166:169], v[206:209]
  ds_read_b64_tr_b16 v[152:153], v8 offset:26624
  v_mfma_f32_16x16x32_bf16 v[234:237], v[58:61], v[166:169], v[234:237]
  ds_read_b64_tr_b16 v[158:159], v6 offset:28672
  s_add_u32 s52, s52, 4096
  buffer_load_dwordx4 v[110:113], v1, s[36:39], s52 offen offset:0 sc1
  s_waitcnt vmcnt(11) lgkmcnt(3)
  v_mfma_f32_16x16x32_bf16 v[198:201], v[62:65], v[142:145], v[198:201]
  ds_read_b64_tr_b16 v[160:161], v6 offset:30720
  v_mfma_f32_16x16x32_bf16 v[226:229], v[66:69], v[142:145], v[226:229]
  ds_read_b64_tr_b16 v[162:163], v7 offset:28672
  v_mfma_f32_16x16x32_bf16 v[202:205], v[62:65], v[146:149], v[202:205]
  ds_read_b64_tr_b16 v[164:165], v7 offset:30720
  s_add_u32 s53, s53, 4096
  buffer_load_dwordx4 v[114:117], v1, s[36:39], s53 offen offset:0 sc1
  v_mfma_f32_16x16x32_bf16 v[230:233], v[66:69], v[146:149], v[230:233]
  ds_read_b64_tr_b16 v[166:167], v8 offset:28672
  s_waitcnt lgkmcnt(5)
  v_mfma_f32_16x16x32_bf16 v[206:209], v[62:65], v[150:153], v[206:209]
  ds_read_b64_tr_b16 v[168:169], v8 offset:30720
  v_mfma_f32_16x16x32_bf16 v[234:237], v[66:69], v[150:153], v[234:237]
  ds_read_b64_tr_b16 v[142:143], v6 offset:32768
  buffer_load_dwordx4 v[118:121], v1, s[36:39], s52 offen offset:1024 sc1
  s_waitcnt vmcnt(11) lgkmcnt(3)
  v_mfma_f32_16x16x32_bf16 v[198:201], v[70:73], v[158:161], v[198:201]
  ds_read_b64_tr_b16 v[144:145], v6 offset:34816
  v_mfma_f32_16x16x32_bf16 v[226:229], v[74:77], v[158:161], v[226:229]
  ds_read_b64_tr_b16 v[146:147], v7 offset:32768
  v_mfma_f32_16x16x32_bf16 v[202:205], v[70:73], v[162:165], v[202:205]
  ds_read_b64_tr_b16 v[148:149], v7 offset:34816
  buffer_load_dwordx4 v[122:125], v1, s[36:39], s53 offen offset:1024 sc1
  v_mfma_f32_16x16x32_bf16 v[230:233], v[74:77], v[162:165], v[230:233]
  ds_read_b64_tr_b16 v[150:151], v8 offset:32768
  s_waitcnt lgkmcnt(5)
  v_mfma_f32_16x16x32_bf16 v[206:209], v[70:73], v[166:169], v[206:209]
  ds_read_b64_tr_b16 v[152:153], v8 offset:34816
  v_mfma_f32_16x16x32_bf16 v[234:237], v[74:77], v[166:169], v[234:237]
  ds_read_b64_tr_b16 v[158:159], v6 offset:36864
  buffer_load_dwordx4 v[126:129], v1, s[36:39], s52 offen offset:2048 sc1
  s_waitcnt vmcnt(11) lgkmcnt(3)
  v_mfma_f32_16x16x32_bf16 v[198:201], v[78:81], v[142:145], v[198:201]
  ds_read_b64_tr_b16 v[160:161], v6 offset:38912
  v_mfma_f32_16x16x32_bf16 v[226:229], v[82:85], v[142:145], v[226:229]
  ds_read_b64_tr_b16 v[162:163], v7 offset:36864
  v_mfma_f32_16x16x32_bf16 v[202:205], v[78:81], v[146:149], v[202:205]
  ds_read_b64_tr_b16 v[164:165], v7 offset:38912
  buffer_load_dwordx4 v[130:133], v1, s[36:39], s53 offen offset:2048 sc1
  v_mfma_f32_16x16x32_bf16 v[230:233], v[82:85], v[146:149], v[230:233]
  ds_read_b64_tr_b16 v[166:167], v8 offset:36864
  s_waitcnt lgkmcnt(5)
  v_mfma_f32_16x16x32_bf16 v[206:209], v[78:81], v[150:153], v[206:209]
  ds_read_b64_tr_b16 v[168:169], v8 offset:38912
  v_mfma_f32_16x16x32_bf16 v[234:237], v[82:85], v[150:153], v[234:237]
  ds_read_b64_tr_b16 v[142:143], v6 offset:40960
  buffer_load_dwordx4 v[134:137], v1, s[36:39], s52 offen offset:3072 sc1
  s_waitcnt vmcnt(11) lgkmcnt(3)
  v_mfma_f32_16x16x32_bf16 v[198:201], v[86:89], v[158:161], v[198:201]
  ds_read_b64_tr_b16 v[144:145], v6 offset:43008
  v_mfma_f32_16x16x32_bf16 v[226:229], v[90:93], v[158:161], v[226:229]
  ds_read_b64_tr_b16 v[146:147], v7 offset:40960
  v_mfma_f32_16x16x32_bf16 v[202:205], v[86:89], v[162:165], v[202:205]
  ds_read_b64_tr_b16 v[148:149], v7 offset:43008
  buffer_load_dwordx4 v[138:141], v1, s[36:39], s53 offen offset:3072 sc1
  v_mfma_f32_16x16x32_bf16 v[230:233], v[90:93], v[162:165], v[230:233]
  ds_read_b64_tr_b16 v[150:151], v8 offset:40960
  s_waitcnt lgkmcnt(5)
  v_mfma_f32_16x16x32_bf16 v[206:209], v[86:89], v[166:169], v[206:209]
  ds_read_b64_tr_b16 v[152:153], v8 offset:43008
  v_mfma_f32_16x16x32_bf16 v[234:237], v[90:93], v[166:169], v[234:237]
  ds_read_b64_tr_b16 v[158:159], v6 offset:45056
  s_waitcnt vmcnt(10) lgkmcnt(3)
  v_mfma_f32_16x16x32_bf16 v[198:201], v[94:97], v[142:145], v[198:201]
  ds_read_b64_tr_b16 v[160:161], v6 offset:47104
  v_mfma_f32_16x16x32_bf16 v[226:229], v[98:101], v[142:145], v[226:229]
  ds_read_b64_tr_b16 v[162:163], v7 offset:45056
  v_mfma_f32_16x16x32_bf16 v[202:205], v[94:97], v[146:149], v[202:205]
  ds_read_b64_tr_b16 v[164:165], v7 offset:47104
  v_mfma_f32_16x16x32_bf16 v[230:233], v[98:101], v[146:149], v[230:233]
  ds_read_b64_tr_b16 v[166:167], v8 offset:45056
  s_waitcnt lgkmcnt(5)
  v_mfma_f32_16x16x32_bf16 v[206:209], v[94:97], v[150:153], v[206:209]
  ds_read_b64_tr_b16 v[168:169], v8 offset:47104
  v_mfma_f32_16x16x32_bf16 v[234:237], v[98:101], v[150:153], v[234:237]
  s_barrier
  ds_read_b64_tr_b16 v[142:143], v6 offset:49152
  s_waitcnt vmcnt(8) lgkmcnt(3)
  v_mfma_f32_16x16x32_bf16 v[198:201], v[102:105], v[158:161], v[198:201]
  ds_read_b64_tr_b16 v[144:145], v6 offset:51200
  v_mfma_f32_16x16x32_bf16 v[226:229], v[106:109], v[158:161], v[226:229]
  ds_read_b64_tr_b16 v[146:147], v7 offset:49152
  v_mfma_f32_16x16x32_bf16 v[202:205], v[102:105], v[162:165], v[202:205]
  ds_read_b64_tr_b16 v[148:149], v7 offset:51200
  v_mfma_f32_16x16x32_bf16 v[230:233], v[106:109], v[162:165], v[230:233]
  ds_read_b64_tr_b16 v[150:151], v8 offset:49152
  s_waitcnt lgkmcnt(5)
  v_mfma_f32_16x16x32_bf16 v[206:209], v[102:105], v[166:169], v[206:209]
  ds_read_b64_tr_b16 v[152:153], v8 offset:51200
  v_mfma_f32_16x16x32_bf16 v[234:237], v[106:109], v[166:169], v[234:237]
  ds_read_b64_tr_b16 v[158:159], v6 offset:53248
  ds_read_b128 v[174:177], v194 offset:1536
  s_waitcnt vmcnt(6) lgkmcnt(4)
  v_mfma_f32_16x16x32_bf16 v[198:201], v[110:113], v[142:145], v[198:201]
  ds_read_b64_tr_b16 v[160:161], v6 offset:55296
  ds_read_b128 v[178:181], v194 offset:1600
  v_mfma_f32_16x16x32_bf16 v[226:229], v[114:117], v[142:145], v[226:229]
  ds_read_b64_tr_b16 v[162:163], v7 offset:53248
  v_lshl_add_u32 v182, s80, 6, v196
  ds_read_b32 v182, v182
  v_mfma_f32_16x16x32_bf16 v[202:205], v[110:113], v[146:149], v[202:205]
  ds_read_b64_tr_b16 v[164:165], v7 offset:55296
  v_lshl_add_u32 v183, s81, 6, v196
  ds_read_b32 v183, v183
  v_mfma_f32_16x16x32_bf16 v[230:233], v[114:117], v[146:149], v[230:233]
  ds_read_b64_tr_b16 v[166:167], v8 offset:53248
  v_lshl_add_u32 v184, s82, 6, v196
  ds_read_b32 v184, v184
  s_waitcnt lgkmcnt(10)
  v_mfma_f32_16x16x32_bf16 v[206:209], v[110:113], v[150:153], v[206:209]
  ds_read_b64_tr_b16 v[168:169], v8 offset:55296
  v_mfma_f32_16x16x32_bf16 v[234:237], v[114:117], v[150:153], v[234:237]
  ds_read_b64_tr_b16 v[142:143], v6 offset:57344
  s_waitcnt vmcnt(4) lgkmcnt(5)
  v_mfma_f32_16x16x32_bf16 v[198:201], v[118:121], v[158:161], v[198:201]
  ds_read_b64_tr_b16 v[144:145], v6 offset:59392
  v_mfma_f32_16x16x32_bf16 v[226:229], v[122:125], v[158:161], v[226:229]
  ds_read_b64_tr_b16 v[146:147], v7 offset:57344
  v_mfma_f32_16x16x32_bf16 v[202:205], v[118:121], v[162:165], v[202:205]
  ds_read_b64_tr_b16 v[148:149], v7 offset:59392
  v_mfma_f32_16x16x32_bf16 v[230:233], v[122:125], v[162:165], v[230:233]
  ds_read_b64_tr_b16 v[150:151], v8 offset:57344
  s_waitcnt lgkmcnt(5)
  v_mfma_f32_16x16x32_bf16 v[206:209], v[118:121], v[166:169], v[206:209]
  ds_read_b64_tr_b16 v[152:153], v8 offset:59392
  v_mfma_f32_16x16x32_bf16 v[234:237], v[122:125], v[166:169], v[234:237]
  ds_read_b64_tr_b16 v[158:159], v6 offset:61440
  s_waitcnt vmcnt(2) lgkmcnt(3)
  v_mfma_f32_16x16x32_bf16 v[198:201], v[126:129], v[142:145], v[198:201]
  ds_read_b64_tr_b16 v[160:161], v6 offset:63488
  v_mfma_f32_16x16x32_bf16 v[226:229], v[130:133], v[142:145], v[226:229]
  ds_read_b64_tr_b16 v[162:163], v7 offset:61440
  v_mfma_f32_16x16x32_bf16 v[202:205], v[126:129], v[146:149], v[202:205]
  ds_read_b64_tr_b16 v[164:165], v7 offset:63488
  v_mfma_f32_16x16x32_bf16 v[230:233], v[130:133], v[146:149], v[230:233]
  ds_read_b64_tr_b16 v[166:167], v8 offset:61440
  s_waitcnt lgkmcnt(5)
  v_mfma_f32_16x16x32_bf16 v[206:209], v[126:129], v[150:153], v[206:209]
  ds_read_b64_tr_b16 v[168:169], v8 offset:63488
  v_mfma_f32_16x16x32_bf16 v[234:237], v[130:133], v[150:153], v[234:237]
  s_waitcnt lgkmcnt(0)
  s_barrier
  s_waitcnt vmcnt(0)
  v_mfma_f32_16x16x32_bf16 v[198:201], v[134:137], v[158:161], v[198:201]
  v_mfma_f32_16x16x32_bf16 v[226:229], v[138:141], v[158:161], v[226:229]
  v_mfma_f32_16x16x32_bf16 v[202:205], v[134:137], v[162:165], v[202:205]
  v_mfma_f32_16x16x32_bf16 v[230:233], v[138:141], v[162:165], v[230:233]
  v_mfma_f32_16x16x32_bf16 v[206:209], v[134:137], v[166:169], v[206:209]
  v_mfma_f32_16x16x32_bf16 v[234:237], v[138:141], v[166:169], v[234:237]
  ds_read_b128 v[142:145], v194 offset:0
  ds_read_b128 v[146:149], v194 offset:64
  ds_read_b128 v[150:153], v194 offset:512
  ds_read_b128 v[154:157], v194 offset:576
  ds_read_b128 v[158:161], v194 offset:1024
  ds_read_b128 v[162:165], v194 offset:1088
  v_pk_fma_f32 v[198:199], v[174:175], v[182:183], v[198:199] op_sel_hi:[1,0,1]
  v_pk_fma_f32 v[200:201], v[176:177], v[182:183], v[200:201] op_sel_hi:[1,0,1]
  v_pk_fma_f32 v[226:227], v[178:179], v[182:183], v[226:227] op_sel_hi:[1,0,1]
  v_pk_fma_f32 v[228:229], v[180:181], v[182:183], v[228:229] op_sel_hi:[1,0,1]
  v_pk_fma_f32 v[202:203], v[174:175], v[182:183], v[202:203] op_sel:[0,1,0] op_sel_hi:[1,1,1]
  v_pk_fma_f32 v[204:205], v[176:177], v[182:183], v[204:205] op_sel:[0,1,0] op_sel_hi:[1,1,1]
  v_pk_fma_f32 v[230:231], v[178:179], v[182:183], v[230:231] op_sel:[0,1,0] op_sel_hi:[1,1,1]
  v_pk_fma_f32 v[232:233], v[180:181], v[182:183], v[232:233] op_sel:[0,1,0] op_sel_hi:[1,1,1]
  v_pk_fma_f32 v[206:207], v[174:175], v[184:185], v[206:207] op_sel_hi:[1,0,1]
  v_pk_fma_f32 v[208:209], v[176:177], v[184:185], v[208:209] op_sel_hi:[1,0,1]
  v_pk_fma_f32 v[234:235], v[178:179], v[184:185], v[234:235] op_sel_hi:[1,0,1]
  v_pk_fma_f32 v[236:237], v[180:181], v[184:185], v[236:237] op_sel_hi:[1,0,1]
  s_waitcnt lgkmcnt(0)
  v_pk_mul_f32 v[166:167], v[198:199], v[198:199]
  v_pk_mul_f32 v[168:169], v[200:201], v[200:201]
  v_pk_mul_f32 v[170:171], v[226:227], v[226:227]
  v_pk_mul_f32 v[172:173], v[228:229], v[228:229]
  v_pk_fma_f32 v[166:167], v[166:167], v[150:151], v[142:143]
  v_pk_fma_f32 v[168:169], v[168:169], v[152:153], v[144:145]
  v_pk_fma_f32 v[170:171], v[170:171], v[154:155], v[146:147]
  v_pk_fma_f32 v[172:173], v[172:173], v[156:157], v[148:149]
  v_pk_mul_f32 v[166:167], v[166:167], v[198:199]
  v_pk_mul_f32 v[168:169], v[168:169], v[200:201]
  v_pk_mul_f32 v[170:171], v[170:171], v[226:227]
  v_pk_mul_f32 v[172:173], v[172:173], v[228:229]
  v_exp_f32 v166, v166
  v_exp_f32 v167, v167
  v_exp_f32 v168, v168
  v_exp_f32 v169, v169
  v_exp_f32 v170, v170
  v_exp_f32 v171, v171
  v_exp_f32 v172, v172
  v_exp_f32 v173, v173
  v_pk_fma_f32 v[166:167], v[166:167], v[158:159], v[158:159]
  v_pk_fma_f32 v[168:169], v[168:169], v[160:161], v[160:161]
  v_pk_fma_f32 v[170:171], v[170:171], v[162:163], v[162:163]
  v_pk_fma_f32 v[172:173], v[172:173], v[164:165], v[164:165]
  v_rcp_f32 v166, v166
  v_rcp_f32 v167, v167
  v_rcp_f32 v168, v168
  v_rcp_f32 v169, v169
  v_rcp_f32 v170, v170
  v_rcp_f32 v171, v171
  v_rcp_f32 v172, v172
  v_rcp_f32 v173, v173
  v_pk_mul_f32 v[198:199], v[198:199], v[166:167]
  v_pk_mul_f32 v[200:201], v[200:201], v[168:169]
  v_pk_mul_f32 v[226:227], v[226:227], v[170:171]
  v_pk_mul_f32 v[228:229], v[228:229], v[172:173]
  v_pk_mul_f32 v[182:183], v[198:199], v[198:199]
  v_pk_mul_f32 v[184:185], v[200:201], v[200:201]
  v_pk_mul_f32 v[186:187], v[226:227], v[226:227]
  v_pk_mul_f32 v[188:189], v[228:229], v[228:229]
  v_pk_mul_f32 v[166:167], v[202:203], v[202:203]
  v_pk_mul_f32 v[168:169], v[204:205], v[204:205]
  v_pk_mul_f32 v[170:171], v[230:231], v[230:231]
  v_pk_mul_f32 v[172:173], v[232:233], v[232:233]
  v_pk_fma_f32 v[166:167], v[166:167], v[150:151], v[142:143]
  v_pk_fma_f32 v[168:169], v[168:169], v[152:153], v[144:145]
  v_pk_fma_f32 v[170:171], v[170:171], v[154:155], v[146:147]
  v_pk_fma_f32 v[172:173], v[172:173], v[156:157], v[148:149]
  v_pk_mul_f32 v[166:167], v[166:167], v[202:203]
  v_pk_mul_f32 v[168:169], v[168:169], v[204:205]
  v_pk_mul_f32 v[170:171], v[170:171], v[230:231]
  v_pk_mul_f32 v[172:173], v[172:173], v[232:233]
  v_exp_f32 v166, v166
  v_exp_f32 v167, v167
  v_exp_f32 v168, v168
  v_exp_f32 v169, v169
  v_exp_f32 v170, v170
  v_exp_f32 v171, v171
  v_exp_f32 v172, v172
  v_exp_f32 v173, v173
  v_pk_fma_f32 v[166:167], v[166:167], v[158:159], v[158:159]
  v_pk_fma_f32 v[168:169], v[168:169], v[160:161], v[160:161]
  v_pk_fma_f32 v[170:171], v[170:171], v[162:163], v[162:163]
  v_pk_fma_f32 v[172:173], v[172:173], v[164:165], v[164:165]
  v_rcp_f32 v166, v166
  v_rcp_f32 v167, v167
  v_rcp_f32 v168, v168
  v_rcp_f32 v169, v169
  v_rcp_f32 v170, v170
  v_rcp_f32 v171, v171
  v_rcp_f32 v172, v172
  v_rcp_f32 v173, v173
  v_pk_mul_f32 v[202:203], v[202:203], v[166:167]
  v_pk_mul_f32 v[204:205], v[204:205], v[168:169]
  v_pk_mul_f32 v[230:231], v[230:231], v[170:171]
  v_pk_mul_f32 v[232:233], v[232:233], v[172:173]
  v_pk_fma_f32 v[182:183], v[202:203], v[202:203], v[182:183]
  v_pk_add_f32 v[174:175], v[202:203], v[198:199]
  v_pk_fma_f32 v[184:185], v[204:205], v[204:205], v[184:185]
  v_pk_add_f32 v[176:177], v[204:205], v[200:201]
  v_pk_fma_f32 v[186:187], v[230:231], v[230:231], v[186:187]
  v_pk_add_f32 v[178:179], v[230:231], v[226:227]
  v_pk_fma_f32 v[188:189], v[232:233], v[232:233], v[188:189]
  v_pk_add_f32 v[180:181], v[232:233], v[228:229]
  v_pk_mul_f32 v[166:167], v[206:207], v[206:207]
  v_pk_mul_f32 v[168:169], v[208:209], v[208:209]
  v_pk_mul_f32 v[170:171], v[234:235], v[234:235]
  v_pk_mul_f32 v[172:173], v[236:237], v[236:237]
  v_pk_fma_f32 v[166:167], v[166:167], v[150:151], v[142:143]
  v_pk_fma_f32 v[168:169], v[168:169], v[152:153], v[144:145]
  v_pk_fma_f32 v[170:171], v[170:171], v[154:155], v[146:147]
  v_pk_fma_f32 v[172:173], v[172:173], v[156:157], v[148:149]
  v_pk_mul_f32 v[166:167], v[166:167], v[206:207]
  v_pk_mul_f32 v[168:169], v[168:169], v[208:209]
  v_pk_mul_f32 v[170:171], v[170:171], v[234:235]
  v_pk_mul_f32 v[172:173], v[172:173], v[236:237]
  v_exp_f32 v166, v166
  v_exp_f32 v167, v167
  v_exp_f32 v168, v168
  v_exp_f32 v169, v169
  v_exp_f32 v170, v170
  v_exp_f32 v171, v171
  v_exp_f32 v172, v172
  v_exp_f32 v173, v173
  v_pk_fma_f32 v[166:167], v[166:167], v[158:159], v[158:159]
  v_pk_fma_f32 v[168:169], v[168:169], v[160:161], v[160:161]
  v_pk_fma_f32 v[170:171], v[170:171], v[162:163], v[162:163]
  v_pk_fma_f32 v[172:173], v[172:173], v[164:165], v[164:165]
  v_rcp_f32 v166, v166
  v_rcp_f32 v167, v167
  v_rcp_f32 v168, v168
  v_rcp_f32 v169, v169
  v_rcp_f32 v170, v170
  v_rcp_f32 v171, v171
  v_rcp_f32 v172, v172
  v_rcp_f32 v173, v173
  v_pk_mul_f32 v[206:207], v[206:207], v[166:167]
  v_pk_mul_f32 v[208:209], v[208:209], v[168:169]
  v_pk_mul_f32 v[234:235], v[234:235], v[170:171]
  v_pk_mul_f32 v[236:237], v[236:237], v[172:173]
  v_pk_fma_f32 v[182:183], v[206:207], v[206:207], v[182:183]
  v_pk_add_f32 v[174:175], v[206:207], v[174:175]
  v_pk_fma_f32 v[184:185], v[208:209], v[208:209], v[184:185]
  v_pk_add_f32 v[176:177], v[208:209], v[176:177]
  v_pk_fma_f32 v[186:187], v[234:235], v[234:235], v[186:187]
  v_pk_add_f32 v[178:179], v[234:235], v[178:179]
  v_pk_fma_f32 v[188:189], v[236:237], v[236:237], v[188:189]
  v_pk_add_f32 v[180:181], v[236:237], v[180:181]
  ds_read_b128 v[150:153], v197 offset:256
  ds_read_b128 v[154:157], v197 offset:320
  ds_read_b128 v[158:161], v197 offset:384
  ds_read_b128 v[162:165], v197 offset:448
  ds_read_b32 v6, v195 offset:1536
  ds_read_b32 v7, v195 offset:1600
  v_add_f32_dpp v142, v174, v174 row_ror:8 row_mask:0xf bank_mask:0x3
  v_add_f32_dpp v143, v175, v175 row_ror:8 row_mask:0xf bank_mask:0x3
  v_add_f32_dpp v144, v176, v176 row_ror:8 row_mask:0xf bank_mask:0x3
  v_add_f32_dpp v145, v177, v177 row_ror:8 row_mask:0xf bank_mask:0x3
  v_add_f32_dpp v146, v182, v182 row_ror:8 row_mask:0xf bank_mask:0x3
  v_add_f32_dpp v147, v183, v183 row_ror:8 row_mask:0xf bank_mask:0x3
  v_add_f32_dpp v148, v184, v184 row_ror:8 row_mask:0xf bank_mask:0x3
  v_add_f32_dpp v149, v185, v185 row_ror:8 row_mask:0xf bank_mask:0x3
  v_add_f32_dpp v142, v178, v178 row_ror:8 row_mask:0xf bank_mask:0xc
  v_add_f32_dpp v143, v179, v179 row_ror:8 row_mask:0xf bank_mask:0xc
  v_add_f32_dpp v144, v180, v180 row_ror:8 row_mask:0xf bank_mask:0xc
  v_add_f32_dpp v145, v181, v181 row_ror:8 row_mask:0xf bank_mask:0xc
  v_add_f32_dpp v146, v186, v186 row_ror:8 row_mask:0xf bank_mask:0xc
  v_add_f32_dpp v147, v187, v187 row_ror:8 row_mask:0xf bank_mask:0xc
  v_add_f32_dpp v148, v188, v188 row_ror:8 row_mask:0xf bank_mask:0xc
  v_add_f32_dpp v149, v189, v189 row_ror:8 row_mask:0xf bank_mask:0xc
  v_add_f32_dpp v166, v142, v142 row_half_mirror row_mask:0xf bank_mask:0x5
  v_add_f32_dpp v167, v143, v143 row_half_mirror row_mask:0xf bank_mask:0x5
  v_add_f32_dpp v168, v146, v146 row_half_mirror row_mask:0xf bank_mask:0x5
  v_add_f32_dpp v169, v147, v147 row_half_mirror row_mask:0xf bank_mask:0x5
  v_add_f32_dpp v166, v144, v144 row_half_mirror row_mask:0xf bank_mask:0xa
  v_add_f32_dpp v167, v145, v145 row_half_mirror row_mask:0xf bank_mask:0xa
  v_add_f32_dpp v168, v148, v148 row_half_mirror row_mask:0xf bank_mask:0xa
  v_add_f32_dpp v169, v149, v149 row_half_mirror row_mask:0xf bank_mask:0xa
  v_add_f32_dpp v166, v166, v166 quad_perm:[2,3,0,1] row_mask:0xf bank_mask:0xf
  v_add_f32_dpp v167, v167, v167 quad_perm:[2,3,0,1] row_mask:0xf bank_mask:0xf
  v_add_f32_dpp v168, v168, v168 quad_perm:[2,3,0,1] row_mask:0xf bank_mask:0xf
  v_add_f32_dpp v169, v169, v169 quad_perm:[2,3,0,1] row_mask:0xf bank_mask:0xf
  v_add_f32_dpp v166, v166, v166 quad_perm:[1,0,3,2] row_mask:0xf bank_mask:0xf
  v_add_f32_dpp v167, v167, v167 quad_perm:[1,0,3,2] row_mask:0xf bank_mask:0xf
  v_add_f32_dpp v168, v168, v168 quad_perm:[1,0,3,2] row_mask:0xf bank_mask:0xf
  v_add_f32_dpp v169, v169, v169 quad_perm:[1,0,3,2] row_mask:0xf bank_mask:0xf
  v_cndmask_b32 v170, v166, v167, s[64:65]
  v_cndmask_b32 v171, v168, v169, s[64:65]
  v_or_b32 v171, 1, v171
  s_mov_b32 exec_lo, 0x55555555
  s_mov_b32 exec_hi, 0x55555555
  buffer_store_dwordx2 v[170:171], v190, s[36:39], s59 offen sc1
  s_mov_b64 exec, -1
  s_waitcnt lgkmcnt(0)
  v_pk_mul_f32 v[210:211], v[150:151], v[6:7] op_sel_hi:[1,0]
  v_pk_mul_f32 v[212:213], v[152:153], v[6:7] op_sel_hi:[1,0]
  v_pk_mul_f32 v[238:239], v[150:151], v[6:7] op_sel:[0,1] op_sel_hi:[1,1]
  v_pk_mul_f32 v[240:241], v[152:153], v[6:7] op_sel:[0,1] op_sel_hi:[1,1]
  v_pk_mul_f32 v[214:215], v[154:155], v[6:7] op_sel_hi:[1,0]
  v_pk_mul_f32 v[216:217], v[156:157], v[6:7] op_sel_hi:[1,0]
  v_pk_mul_f32 v[242:243], v[154:155], v[6:7] op_sel:[0,1] op_sel_hi:[1,1]
  v_pk_mul_f32 v[244:245], v[156:157], v[6:7] op_sel:[0,1] op_sel_hi:[1,1]
  v_pk_mul_f32 v[218:219], v[158:159], v[6:7] op_sel_hi:[1,0]
  v_pk_mul_f32 v[220:221], v[160:161], v[6:7] op_sel_hi:[1,0]
  v_pk_mul_f32 v[246:247], v[158:159], v[6:7] op_sel:[0,1] op_sel_hi:[1,1]
  v_pk_mul_f32 v[248:249], v[160:161], v[6:7] op_sel:[0,1] op_sel_hi:[1,1]
  v_pk_mul_f32 v[222:223], v[162:163], v[6:7] op_sel_hi:[1,0]
  v_pk_mul_f32 v[224:225], v[164:165], v[6:7] op_sel_hi:[1,0]
  v_pk_mul_f32 v[250:251], v[162:163], v[6:7] op_sel:[0,1] op_sel_hi:[1,1]
  v_pk_mul_f32 v[252:253], v[164:165], v[6:7] op_sel:[0,1] op_sel_hi:[1,1]
  ds_read_b64_tr_b16 v[142:143], v9 offset:0
  ds_read_b64_tr_b16 v[144:145], v9 offset:2048
  ds_read_b64_tr_b16 v[146:147], v10 offset:0
  ds_read_b64_tr_b16 v[148:149], v10 offset:2048
  ds_read_b64_tr_b16 v[150:151], v11 offset:0
  ds_read_b64_tr_b16 v[152:153], v11 offset:2048
  ds_read_b64_tr_b16 v[154:155], v12 offset:0
  ds_read_b64_tr_b16 v[156:157], v12 offset:2048
  ds_read_b64_tr_b16 v[158:159], v9 offset:4096
  s_waitcnt lgkmcnt(5)
  v_mfma_f32_16x16x32_bf16 v[210:213], v[142:145], v[14:17], v[210:213]
  ds_read_b64_tr_b16 v[160:161], v9 offset:6144
  v_mfma_f32_16x16x32_bf16 v[238:241], v[142:145], v[18:21], v[238:241]
  ds_read_b64_tr_b16 v[162:163], v10 offset:4096
  v_mfma_f32_16x16x32_bf16 v[214:217], v[146:149], v[14:17], v[214:217]
  ds_read_b64_tr_b16 v[164:165], v10 offset:6144
  v_mfma_f32_16x16x32_bf16 v[242:245], v[146:149], v[18:21], v[242:245]
  ds_read_b64_tr_b16 v[166:167], v11 offset:4096
  s_waitcnt lgkmcnt(5)
  v_mfma_f32_16x16x32_bf16 v[218:221], v[150:153], v[14:17], v[218:221]
  ds_read_b64_tr_b16 v[168:169], v11 offset:6144
  v_mfma_f32_16x16x32_bf16 v[246:249], v[150:153], v[18:21], v[246:249]
  ds_read_b64_tr_b16 v[170:171], v12 offset:4096
  v_mfma_f32_16x16x32_bf16 v[222:225], v[154:157], v[14:17], v[222:225]
  ds_read_b64_tr_b16 v[172:173], v12 offset:6144
  v_mfma_f32_16x16x32_bf16 v[250:253], v[154:157], v[18:21], v[250:253]
  ds_read_b64_tr_b16 v[142:143], v9 offset:8192
  s_waitcnt lgkmcnt(5)
  v_mfma_f32_16x16x32_bf16 v[210:213], v[158:161], v[22:25], v[210:213]
  ds_read_b64_tr_b16 v[144:145], v9 offset:10240
  v_mfma_f32_16x16x32_bf16 v[238:241], v[158:161], v[26:29], v[238:241]
  ds_read_b64_tr_b16 v[146:147], v10 offset:8192
  v_mfma_f32_16x16x32_bf16 v[214:217], v[162:165], v[22:25], v[214:217]
  ds_read_b64_tr_b16 v[148:149], v10 offset:10240
  v_mfma_f32_16x16x32_bf16 v[242:245], v[162:165], v[26:29], v[242:245]
  ds_read_b64_tr_b16 v[150:151], v11 offset:8192
  s_waitcnt lgkmcnt(5)
  v_mfma_f32_16x16x32_bf16 v[218:221], v[166:169], v[22:25], v[218:221]
  ds_read_b64_tr_b16 v[152:153], v11 offset:10240
  v_mfma_f32_16x16x32_bf16 v[246:249], v[166:169], v[26:29], v[246:249]
  ds_read_b64_tr_b16 v[154:155], v12 offset:8192
  v_mfma_f32_16x16x32_bf16 v[222:225], v[170:173], v[22:25], v[222:225]
  ds_read_b64_tr_b16 v[156:157], v12 offset:10240
  v_mfma_f32_16x16x32_bf16 v[250:253], v[170:173], v[26:29], v[250:253]
  v_mov_b32 v13, v195
  ds_read_b64_tr_b16 v[158:159], v9 offset:12288
  ds_read_b32 v194, v13 offset:0
  s_waitcnt lgkmcnt(6)
  v_mfma_f32_16x16x32_bf16 v[210:213], v[142:145], v[30:33], v[210:213]
  ds_read_b64_tr_b16 v[160:161], v9 offset:14336
  ds_read_b32 v195, v13 offset:64
  v_mfma_f32_16x16x32_bf16 v[238:241], v[142:145], v[34:37], v[238:241]
  ds_read_b64_tr_b16 v[162:163], v10 offset:12288
  ds_read_b32 v196, v13 offset:512
  v_mfma_f32_16x16x32_bf16 v[214:217], v[146:149], v[30:33], v[214:217]
  ds_read_b64_tr_b16 v[164:165], v10 offset:14336
  v_mfma_f32_16x16x32_bf16 v[242:245], v[146:149], v[34:37], v[242:245]
  ds_read_b64_tr_b16 v[166:167], v11 offset:12288
  ds_read_b32 v197, v13 offset:576
  s_waitcnt lgkmcnt(9)
  v_mfma_f32_16x16x32_bf16 v[218:221], v[150:153], v[30:33], v[218:221]
  ds_read_b64_tr_b16 v[168:169], v11 offset:14336
  ds_read_b32 v6, v13 offset:1024
  v_mfma_f32_16x16x32_bf16 v[246:249], v[150:153], v[34:37], v[246:249]
  ds_read_b64_tr_b16 v[170:171], v12 offset:12288
  ds_read_b32 v7, v13 offset:1088
  v_mfma_f32_16x16x32_bf16 v[222:225], v[154:157], v[30:33], v[222:225]
  ds_read_b64_tr_b16 v[172:173], v12 offset:14336
  v_mfma_f32_16x16x32_bf16 v[250:253], v[154:157], v[34:37], v[250:253]
  ds_read_b64_tr_b16 v[142:143], v9 offset:16384
  s_waitcnt lgkmcnt(8)
  v_mfma_f32_16x16x32_bf16 v[210:213], v[158:161], v[38:41], v[210:213]
  ds_read_b64_tr_b16 v[144:145], v9 offset:18432
  v_mfma_f32_16x16x32_bf16 v[238:241], v[158:161], v[42:45], v[238:241]
  ds_read_b64_tr_b16 v[146:147], v10 offset:16384
  v_mfma_f32_16x16x32_bf16 v[214:217], v[162:165], v[38:41], v[214:217]
  ds_read_b64_tr_b16 v[148:149], v10 offset:18432
  v_mfma_f32_16x16x32_bf16 v[242:245], v[162:165], v[42:45], v[242:245]
  ds_read_b64_tr_b16 v[150:151], v11 offset:16384
  s_waitcnt lgkmcnt(5)
  v_mfma_f32_16x16x32_bf16 v[218:221], v[166:169], v[38:41], v[218:221]
  ds_read_b64_tr_b16 v[152:153], v11 offset:18432
  v_mfma_f32_16x16x32_bf16 v[246:249], v[166:169], v[42:45], v[246:249]
  ds_read_b64_tr_b16 v[154:155], v12 offset:16384
  v_mfma_f32_16x16x32_bf16 v[222:225], v[170:173], v[38:41], v[222:225]
  ds_read_b64_tr_b16 v[156:157], v12 offset:18432
  v_mfma_f32_16x16x32_bf16 v[250:253], v[170:173], v[42:45], v[250:253]
  ds_read_b64_tr_b16 v[158:159], v9 offset:20480
  s_waitcnt lgkmcnt(5)
  v_mfma_f32_16x16x32_bf16 v[210:213], v[142:145], v[46:49], v[210:213]
  ds_read_b64_tr_b16 v[160:161], v9 offset:22528
  v_mfma_f32_16x16x32_bf16 v[238:241], v[142:145], v[50:53], v[238:241]
  ds_read_b64_tr_b16 v[162:163], v10 offset:20480
  v_mfma_f32_16x16x32_bf16 v[214:217], v[146:149], v[46:49], v[214:217]
  ds_read_b64_tr_b16 v[164:165], v10 offset:22528
  v_mfma_f32_16x16x32_bf16 v[242:245], v[146:149], v[50:53], v[242:245]
  ds_read_b64_tr_b16 v[166:167], v11 offset:20480
  s_waitcnt lgkmcnt(5)
  v_mfma_f32_16x16x32_bf16 v[218:221], v[150:153], v[46:49], v[218:221]
  ds_read_b64_tr_b16 v[168:169], v11 offset:22528
  v_mfma_f32_16x16x32_bf16 v[246:249], v[150:153], v[50:53], v[246:249]
  ds_read_b64_tr_b16 v[170:171], v12 offset:20480
  v_mfma_f32_16x16x32_bf16 v[222:225], v[154:157], v[46:49], v[222:225]
  ds_read_b64_tr_b16 v[172:173], v12 offset:22528
  v_mfma_f32_16x16x32_bf16 v[250:253], v[154:157], v[50:53], v[250:253]
  ds_read_b64_tr_b16 v[142:143], v9 offset:24576
  s_waitcnt lgkmcnt(5)
  v_mfma_f32_16x16x32_bf16 v[210:213], v[158:161], v[54:57], v[210:213]
  ds_read_b64_tr_b16 v[144:145], v9 offset:26624
  v_mfma_f32_16x16x32_bf16 v[238:241], v[158:161], v[58:61], v[238:241]
  ds_read_b64_tr_b16 v[146:147], v10 offset:24576
  v_mfma_f32_16x16x32_bf16 v[214:217], v[162:165], v[54:57], v[214:217]
  ds_read_b64_tr_b16 v[148:149], v10 offset:26624
  v_mfma_f32_16x16x32_bf16 v[242:245], v[162:165], v[58:61], v[242:245]
  ds_read_b64_tr_b16 v[150:151], v11 offset:24576
  s_waitcnt lgkmcnt(5)
  v_mfma_f32_16x16x32_bf16 v[218:221], v[166:169], v[54:57], v[218:221]
  ds_read_b64_tr_b16 v[152:153], v11 offset:26624
  v_mfma_f32_16x16x32_bf16 v[246:249], v[166:169], v[58:61], v[246:249]
  ds_read_b64_tr_b16 v[154:155], v12 offset:24576
  v_mfma_f32_16x16x32_bf16 v[222:225], v[170:173], v[54:57], v[222:225]
  ds_read_b64_tr_b16 v[156:157], v12 offset:26624
  v_mfma_f32_16x16x32_bf16 v[250:253], v[170:173], v[58:61], v[250:253]
  ds_read_b64_tr_b16 v[158:159], v9 offset:28672
  s_waitcnt lgkmcnt(5)
  v_mfma_f32_16x16x32_bf16 v[210:213], v[142:145], v[62:65], v[210:213]
  ds_read_b64_tr_b16 v[160:161], v9 offset:30720
  v_mfma_f32_16x16x32_bf16 v[238:241], v[142:145], v[66:69], v[238:241]
  ds_read_b64_tr_b16 v[162:163], v10 offset:28672
  v_mfma_f32_16x16x32_bf16 v[214:217], v[146:149], v[62:65], v[214:217]
  ds_read_b64_tr_b16 v[164:165], v10 offset:30720
  v_mfma_f32_16x16x32_bf16 v[242:245], v[146:149], v[66:69], v[242:245]
  ds_read_b64_tr_b16 v[166:167], v11 offset:28672
  s_waitcnt lgkmcnt(5)
  v_mfma_f32_16x16x32_bf16 v[218:221], v[150:153], v[62:65], v[218:221]
  ds_read_b64_tr_b16 v[168:169], v11 offset:30720
  v_mfma_f32_16x16x32_bf16 v[246:249], v[150:153], v[66:69], v[246:249]
  ds_read_b64_tr_b16 v[170:171], v12 offset:28672
  v_mfma_f32_16x16x32_bf16 v[222:225], v[154:157], v[62:65], v[222:225]
  ds_read_b64_tr_b16 v[172:173], v12 offset:30720
  v_mfma_f32_16x16x32_bf16 v[250:253], v[154:157], v[66:69], v[250:253]
  ds_read_b64_tr_b16 v[142:143], v9 offset:32768
  s_waitcnt lgkmcnt(5)
  v_mfma_f32_16x16x32_bf16 v[210:213], v[158:161], v[70:73], v[210:213]
  ds_read_b64_tr_b16 v[144:145], v9 offset:34816
  v_mfma_f32_16x16x32_bf16 v[238:241], v[158:161], v[74:77], v[238:241]
  ds_read_b64_tr_b16 v[146:147], v10 offset:32768
  v_mfma_f32_16x16x32_bf16 v[214:217], v[162:165], v[70:73], v[214:217]
  ds_read_b64_tr_b16 v[148:149], v10 offset:34816
  v_mfma_f32_16x16x32_bf16 v[242:245], v[162:165], v[74:77], v[242:245]
  ds_read_b64_tr_b16 v[150:151], v11 offset:32768
  s_waitcnt lgkmcnt(5)
  v_mfma_f32_16x16x32_bf16 v[218:221], v[166:169], v[70:73], v[218:221]
  ds_read_b64_tr_b16 v[152:153], v11 offset:34816
  v_mfma_f32_16x16x32_bf16 v[246:249], v[166:169], v[74:77], v[246:249]
  ds_read_b64_tr_b16 v[154:155], v12 offset:32768
  v_mfma_f32_16x16x32_bf16 v[222:225], v[170:173], v[70:73], v[222:225]
  ds_read_b64_tr_b16 v[156:157], v12 offset:34816
  v_mfma_f32_16x16x32_bf16 v[250:253], v[170:173], v[74:77], v[250:253]
  ds_read_b64_tr_b16 v[158:159], v9 offset:36864
  s_waitcnt lgkmcnt(5)
  v_mfma_f32_16x16x32_bf16 v[210:213], v[142:145], v[78:81], v[210:213]
  ds_read_b64_tr_b16 v[160:161], v9 offset:38912
  v_mfma_f32_16x16x32_bf16 v[238:241], v[142:145], v[82:85], v[238:241]
  ds_read_b64_tr_b16 v[162:163], v10 offset:36864
  v_mfma_f32_16x16x32_bf16 v[214:217], v[146:149], v[78:81], v[214:217]
  ds_read_b64_tr_b16 v[164:165], v10 offset:38912
  v_mfma_f32_16x16x32_bf16 v[242:245], v[146:149], v[82:85], v[242:245]
  ds_read_b64_tr_b16 v[166:167], v11 offset:36864
  s_waitcnt lgkmcnt(5)
  v_mfma_f32_16x16x32_bf16 v[218:221], v[150:153], v[78:81], v[218:221]
  ds_read_b64_tr_b16 v[168:169], v11 offset:38912
  v_mfma_f32_16x16x32_bf16 v[246:249], v[150:153], v[82:85], v[246:249]
  ds_read_b64_tr_b16 v[170:171], v12 offset:36864
  v_mfma_f32_16x16x32_bf16 v[222:225], v[154:157], v[78:81], v[222:225]
  ds_read_b64_tr_b16 v[172:173], v12 offset:38912
  v_mfma_f32_16x16x32_bf16 v[250:253], v[154:157], v[82:85], v[250:253]
  ds_read_b64_tr_b16 v[142:143], v9 offset:40960
  buffer_load_dwordx2 v[174:175], v191, s[36:39], s58 offen offset:0 sc1
  s_waitcnt lgkmcnt(5)
  v_mfma_f32_16x16x32_bf16 v[210:213], v[158:161], v[86:89], v[210:213]
  ds_read_b64_tr_b16 v[144:145], v9 offset:43008
  buffer_load_dwordx2 v[176:177], v191, s[36:39], s58 offen offset:1024 sc1
  v_mfma_f32_16x16x32_bf16 v[238:241], v[158:161], v[90:93], v[238:241]
  ds_read_b64_tr_b16 v[146:147], v10 offset:40960
  buffer_load_dwordx2 v[178:179], v191, s[36:39], s58 offen offset:2048 sc1
  v_mfma_f32_16x16x32_bf16 v[214:217], v[162:165], v[86:89], v[214:217]
  ds_read_b64_tr_b16 v[148:149], v10 offset:43008
  buffer_load_dwordx2 v[180:181], v191, s[36:39], s58 offen offset:3072 sc1
  v_mfma_f32_16x16x32_bf16 v[242:245], v[162:165], v[90:93], v[242:245]
  ds_read_b64_tr_b16 v[150:151], v11 offset:40960
  buffer_load_dwordx2 v[182:183], v191, s[36:39], s67 offen offset:0 sc1
  s_waitcnt lgkmcnt(5)
  v_mfma_f32_16x16x32_bf16 v[218:221], v[166:169], v[86:89], v[218:221]
  ds_read_b64_tr_b16 v[152:153], v11 offset:43008
  buffer_load_dwordx2 v[184:185], v191, s[36:39], s67 offen offset:1024 sc1
  v_mfma_f32_16x16x32_bf16 v[246:249], v[166:169], v[90:93], v[246:249]
  ds_read_b64_tr_b16 v[154:155], v12 offset:40960
  buffer_load_dwordx2 v[186:187], v191, s[36:39], s67 offen offset:2048 sc1
  v_mfma_f32_16x16x32_bf16 v[222:225], v[170:173], v[86:89], v[222:225]
  ds_read_b64_tr_b16 v[156:157], v12 offset:43008
  buffer_load_dwordx2 v[188:189], v191, s[36:39], s67 offen offset:3072 sc1
  v_mfma_f32_16x16x32_bf16 v[250:253], v[170:173], v[90:93], v[250:253]
  ds_read_b64_tr_b16 v[158:159], v9 offset:45056
  s_waitcnt lgkmcnt(5)
  v_mfma_f32_16x16x32_bf16 v[210:213], v[142:145], v[94:97], v[210:213]
  ds_read_b64_tr_b16 v[160:161], v9 offset:47104
  v_mfma_f32_16x16x32_bf16 v[238:241], v[142:145], v[98:101], v[238:241]
  ds_read_b64_tr_b16 v[162:163], v10 offset:45056
  v_mfma_f32_16x16x32_bf16 v[214:217], v[146:149], v[94:97], v[214:217]
  ds_read_b64_tr_b16 v[164:165], v10 offset:47104
  v_mfma_f32_16x16x32_bf16 v[242:245], v[146:149], v[98:101], v[242:245]
  ds_read_b64_tr_b16 v[166:167], v11 offset:45056
  s_waitcnt lgkmcnt(5)
  v_mfma_f32_16x16x32_bf16 v[218:221], v[150:153], v[94:97], v[218:221]
  ds_read_b64_tr_b16 v[168:169], v11 offset:47104
  v_mfma_f32_16x16x32_bf16 v[246:249], v[150:153], v[98:101], v[246:249]
  ds_read_b64_tr_b16 v[170:171], v12 offset:45056
  v_mfma_f32_16x16x32_bf16 v[222:225], v[154:157], v[94:97], v[222:225]
  ds_read_b64_tr_b16 v[172:173], v12 offset:47104
  v_mfma_f32_16x16x32_bf16 v[250:253], v[154:157], v[98:101], v[250:253]
  ds_read_b64_tr_b16 v[142:143], v9 offset:49152
  s_waitcnt lgkmcnt(5)
  v_mfma_f32_16x16x32_bf16 v[210:213], v[158:161], v[102:105], v[210:213]
  ds_read_b64_tr_b16 v[144:145], v9 offset:51200
  v_mfma_f32_16x16x32_bf16 v[238:241], v[158:161], v[106:109], v[238:241]
  ds_read_b64_tr_b16 v[146:147], v10 offset:49152
  v_mfma_f32_16x16x32_bf16 v[214:217], v[162:165], v[102:105], v[214:217]
  ds_read_b64_tr_b16 v[148:149], v10 offset:51200
  v_mfma_f32_16x16x32_bf16 v[242:245], v[162:165], v[106:109], v[242:245]
  ds_read_b64_tr_b16 v[150:151], v11 offset:49152
  s_waitcnt lgkmcnt(5)
  v_mfma_f32_16x16x32_bf16 v[218:221], v[166:169], v[102:105], v[218:221]
  ds_read_b64_tr_b16 v[152:153], v11 offset:51200
  v_mfma_f32_16x16x32_bf16 v[246:249], v[166:169], v[106:109], v[246:249]
  ds_read_b64_tr_b16 v[154:155], v12 offset:49152
  v_mfma_f32_16x16x32_bf16 v[222:225], v[170:173], v[102:105], v[222:225]
  ds_read_b64_tr_b16 v[156:157], v12 offset:51200
  v_mfma_f32_16x16x32_bf16 v[250:253], v[170:173], v[106:109], v[250:253]
  s_mov_b32 s6, 131072
  s_waitcnt vmcnt(0)
L_p3_poll3:
  v_min3_u32 v4, v175, v177, v179
  v_min3_u32 v4, v4, v181, v183
  v_min3_u32 v4, v4, v185, v187
  v_min_u32 v4, v4, v189
  v_cmp_eq_u32 vcc, 0, v4
  s_sub_u32 s6, s6, 1
  s_cbranch_scc1 L_p3_pollx3
  s_nop 2
  s_cbranch_vccz L_p3_pollx3
  buffer_load_dwordx2 v[174:175], v191, s[36:39], s58 offen offset:0 sc1
  buffer_load_dwordx2 v[176:177], v191, s[36:39], s58 offen offset:1024 sc1
  buffer_load_dwordx2 v[178:179], v191, s[36:39], s58 offen offset:2048 sc1
  buffer_load_dwordx2 v[180:181], v191, s[36:39], s58 offen offset:3072 sc1
  buffer_load_dwordx2 v[182:183], v191, s[36:39], s67 offen offset:0 sc1
  buffer_load_dwordx2 v[184:185], v191, s[36:39], s67 offen offset:1024 sc1
  buffer_load_dwordx2 v[186:187], v191, s[36:39], s67 offen offset:2048 sc1
  buffer_load_dwordx2 v[188:189], v191, s[36:39], s67 offen offset:3072 sc1
  s_waitcnt vmcnt(0)
  s_branch L_p3_poll3
L_p3_pollx3:
  v_pk_add_f32 v[174:175], v[174:175], v[176:177]
  v_pk_add_f32 v[178:179], v[178:179], v[180:181]
  v_pk_add_f32 v[182:183], v[182:183], v[184:185]
  v_pk_add_f32 v[186:187], v[186:187], v[188:189]
  v_pk_add_f32 v[174:175], v[174:175], v[178:179]
  v_pk_add_f32 v[182:183], v[182:183], v[186:187]
  v_pk_add_f32 v[174:175], v[174:175], v[182:183]
  v_mov_b32 v176, v174
  v_mov_b32 v177, v175
  s_nop 0
  v_permlane32_swap_b32 v174, v176
  v_permlane32_swap_b32 v175, v177
  v_pk_add_f32 v[174:175], v[174:175], v[176:177]
  v_mul_f32 v174, 0xba924925, v174
  v_mul_f32 v175, 0x3a924925, v175
  v_fma_f32 v175, -v174, v174, v175
  v_max_f32 v175, 0, v175
  v_add_f32 v175, 0x3727c5ac, v175
  v_rsq_f32 v175, v175
  s_nop 0
  v_mul_f32 v174, v174, v175
  ds_write_b32 v192, v175
  ds_write_b32 v192, v174 offset:128
  ds_read_b128 v[174:177], v193 offset:0
  ds_read_b128 v[182:185], v193 offset:128
  ds_read_b128 v[178:181], v193 offset:64
  ds_read_b128 v[186:189], v193 offset:192
  ds_read_b64_tr_b16 v[158:159], v9 offset:53248
  s_waitcnt lgkmcnt(11)
  v_mfma_f32_16x16x32_bf16 v[210:213], v[142:145], v[110:113], v[210:213]
  ds_read_b64_tr_b16 v[160:161], v9 offset:55296
  v_mfma_f32_16x16x32_bf16 v[238:241], v[142:145], v[114:117], v[238:241]
  ds_read_b64_tr_b16 v[162:163], v10 offset:53248
  v_mfma_f32_16x16x32_bf16 v[214:217], v[146:149], v[110:113], v[214:217]
  ds_read_b64_tr_b16 v[164:165], v10 offset:55296
  v_mfma_f32_16x16x32_bf16 v[242:245], v[146:149], v[114:117], v[242:245]
  ds_read_b64_tr_b16 v[166:167], v11 offset:53248
  s_waitcnt lgkmcnt(11)
  v_mfma_f32_16x16x32_bf16 v[218:221], v[150:153], v[110:113], v[218:221]
  ds_read_b64_tr_b16 v[168:169], v11 offset:55296
  v_mfma_f32_16x16x32_bf16 v[246:249], v[150:153], v[114:117], v[246:249]
  ds_read_b64_tr_b16 v[170:171], v12 offset:53248
  v_mfma_f32_16x16x32_bf16 v[222:225], v[154:157], v[110:113], v[222:225]
  ds_read_b64_tr_b16 v[172:173], v12 offset:55296
  v_mfma_f32_16x16x32_bf16 v[250:253], v[154:157], v[114:117], v[250:253]
  s_waitcnt lgkmcnt(8)
  v_pk_fma_f32 v[198:199], v[198:199], v[174:175], v[182:183]
  v_pk_fma_f32 v[200:201], v[200:201], v[176:177], v[184:185]
  v_pk_fma_f32 v[226:227], v[226:227], v[178:179], v[186:187]
  v_pk_fma_f32 v[228:229], v[228:229], v[180:181], v[188:189]
  v_cvt_pk_bf16_f32 v198, v198, v199
  v_cvt_pk_bf16_f32 v199, v200, v201
  v_cvt_pk_bf16_f32 v200, v226, v227
  v_cvt_pk_bf16_f32 v201, v228, v229
  s_nop 0
  v_permlane32_swap_b32 v198, v200
  v_permlane32_swap_b32 v199, v201
  v_pk_fma_f32 v[202:203], v[202:203], v[174:175], v[182:183]
  v_pk_fma_f32 v[204:205], v[204:205], v[176:177], v[184:185]
  v_pk_fma_f32 v[230:231], v[230:231], v[178:179], v[186:187]
  v_pk_fma_f32 v[232:233], v[232:233], v[180:181], v[188:189]
  v_cvt_pk_bf16_f32 v202, v202, v203
  v_cvt_pk_bf16_f32 v203, v204, v205
  v_cvt_pk_bf16_f32 v204, v230, v231
  v_cvt_pk_bf16_f32 v205, v232, v233
  v_permlane16_swap_b32 v198, v200
  v_permlane16_swap_b32 v199, v201
  buffer_store_dwordx4 v[198:201], v1, s[36:39], s83 offen offset:0 sc1
  v_permlane32_swap_b32 v202, v204
  v_permlane32_swap_b32 v203, v205
  v_pk_fma_f32 v[206:207], v[206:207], v[174:175], v[182:183]
  v_pk_fma_f32 v[208:209], v[208:209], v[176:177], v[184:185]
  v_pk_fma_f32 v[234:235], v[234:235], v[178:179], v[186:187]
  v_pk_fma_f32 v[236:237], v[236:237], v[180:181], v[188:189]
  v_cvt_pk_bf16_f32 v206, v206, v207
  v_cvt_pk_bf16_f32 v207, v208, v209
  v_cvt_pk_bf16_f32 v208, v234, v235
  v_cvt_pk_bf16_f32 v209, v236, v237
  v_permlane16_swap_b32 v202, v204
  v_permlane16_swap_b32 v203, v205
  buffer_store_dwordx4 v[202:205], v1, s[36:39], s84 offen offset:0 sc1
  v_permlane32_swap_b32 v206, v208
  v_permlane32_swap_b32 v207, v209
  s_nop 0
  v_permlane16_swap_b32 v206, v208
  v_permlane16_swap_b32 v207, v209
  buffer_store_dwordx4 v[206:209], v1, s[36:39], s85 offen offset:0 sc1
  ds_read_b64_tr_b16 v[142:143], v9 offset:57344
  s_waitcnt lgkmcnt(5)
  v_mfma_f32_16x16x32_bf16 v[210:213], v[158:161], v[118:121], v[210:213]
  ds_read_b64_tr_b16 v[144:145], v9 offset:59392
  v_mfma_f32_16x16x32_bf16 v[238:241], v[158:161], v[122:125], v[238:241]
  ds_read_b64_tr_b16 v[146:147], v10 offset:57344
  v_mfma_f32_16x16x32_bf16 v[214:217], v[162:165], v[118:121], v[214:217]
  ds_read_b64_tr_b16 v[148:149], v10 offset:59392
  v_mfma_f32_16x16x32_bf16 v[242:245], v[162:165], v[122:125], v[242:245]
  ds_read_b64_tr_b16 v[150:151], v11 offset:57344
  s_waitcnt lgkmcnt(5)
  v_mfma_f32_16x16x32_bf16 v[218:221], v[166:169], v[118:121], v[218:221]
  ds_read_b64_tr_b16 v[152:153], v11 offset:59392
  v_mfma_f32_16x16x32_bf16 v[246:249], v[166:169], v[122:125], v[246:249]
  ds_read_b64_tr_b16 v[154:155], v12 offset:57344
  v_mfma_f32_16x16x32_bf16 v[222:225], v[170:173], v[118:121], v[222:225]
  ds_read_b64_tr_b16 v[156:157], v12 offset:59392
  v_mfma_f32_16x16x32_bf16 v[250:253], v[170:173], v[122:125], v[250:253]
  ds_read_b64_tr_b16 v[158:159], v9 offset:61440
  s_waitcnt lgkmcnt(5)
  v_mfma_f32_16x16x32_bf16 v[210:213], v[142:145], v[126:129], v[210:213]
  ds_read_b64_tr_b16 v[160:161], v9 offset:63488
  v_mfma_f32_16x16x32_bf16 v[238:241], v[142:145], v[130:133], v[238:241]
  ds_read_b64_tr_b16 v[162:163], v10 offset:61440
  v_mfma_f32_16x16x32_bf16 v[214:217], v[146:149], v[126:129], v[214:217]
  ds_read_b64_tr_b16 v[164:165], v10 offset:63488
  v_mfma_f32_16x16x32_bf16 v[242:245], v[146:149], v[130:133], v[242:245]
  ds_read_b64_tr_b16 v[166:167], v11 offset:61440
  s_waitcnt lgkmcnt(5)
  v_mfma_f32_16x16x32_bf16 v[218:221], v[150:153], v[126:129], v[218:221]
  ds_read_b64_tr_b16 v[168:169], v11 offset:63488
  v_mfma_f32_16x16x32_bf16 v[246:249], v[150:153], v[130:133], v[246:249]
  ds_read_b64_tr_b16 v[170:171], v12 offset:61440
  v_mfma_f32_16x16x32_bf16 v[222:225], v[154:157], v[126:129], v[222:225]
  ds_read_b64_tr_b16 v[172:173], v12 offset:63488
  v_mfma_f32_16x16x32_bf16 v[250:253], v[154:157], v[130:133], v[250:253]
  s_waitcnt lgkmcnt(0)
  v_mfma_f32_16x16x32_bf16 v[210:213], v[158:161], v[134:137], v[210:213]
  v_mfma_f32_16x16x32_bf16 v[238:241], v[158:161], v[138:141], v[238:241]
  v_mfma_f32_16x16x32_bf16 v[214:217], v[162:165], v[134:137], v[214:217]
  v_mfma_f32_16x16x32_bf16 v[242:245], v[162:165], v[138:141], v[242:245]
  v_mfma_f32_16x16x32_bf16 v[218:221], v[166:169], v[134:137], v[218:221]
  v_mfma_f32_16x16x32_bf16 v[246:249], v[166:169], v[138:141], v[246:249]
  v_mfma_f32_16x16x32_bf16 v[222:225], v[170:173], v[134:137], v[222:225]
  v_mfma_f32_16x16x32_bf16 v[250:253], v[170:173], v[138:141], v[250:253]
  s_lshl_b32 s56, s48, 4
  s_add_u32 s56, s56, s49
  s_lshl_b32 s56, s56, 7
  s_add_u32 s56, s56, 0xb3c000
  v_mov_b32 v8, 1
  v_mov_b32 v9, 0
  s_waitcnt vmcnt(0)
  s_barrier
  s_cmp_eq_u32 s3, 0
  s_cbranch_scc0 L_skip11
  s_mov_b64 exec, 1
  buffer_store_dword v8, v9, s[36:39], s56 offen sc1
  s_mov_b64 exec, -1
L_skip11:
  s_barrier
  v_pk_mul_f32 v[14:15], v[210:211], v[210:211]
  v_pk_mul_f32 v[16:17], v[212:213], v[212:213]
  v_pk_mul_f32 v[18:19], v[214:215], v[214:215]
  v_pk_mul_f32 v[20:21], v[216:217], v[216:217]
  v_pk_fma_f32 v[14:15], v[14:15], v[196:197], v[194:195] op_sel_hi:[1,0,0]
  v_pk_fma_f32 v[16:17], v[16:17], v[196:197], v[194:195] op_sel_hi:[1,0,0]
  v_pk_fma_f32 v[18:19], v[18:19], v[196:197], v[194:195] op_sel_hi:[1,0,0]
  v_pk_fma_f32 v[20:21], v[20:21], v[196:197], v[194:195] op_sel_hi:[1,0,0]
  v_pk_mul_f32 v[14:15], v[14:15], v[210:211]
  v_pk_mul_f32 v[16:17], v[16:17], v[212:213]
  v_pk_mul_f32 v[18:19], v[18:19], v[214:215]
  v_pk_mul_f32 v[20:21], v[20:21], v[216:217]
  v_exp_f32 v14, v14
  v_exp_f32 v15, v15
  v_exp_f32 v16, v16
  v_exp_f32 v17, v17
  v_exp_f32 v18, v18
  v_exp_f32 v19, v19
  v_exp_f32 v20, v20
  v_exp_f32 v21, v21
  v_pk_fma_f32 v[14:15], v[14:15], v[6:7], v[6:7] op_sel_hi:[1,0,0]
  v_pk_fma_f32 v[16:17], v[16:17], v[6:7], v[6:7] op_sel_hi:[1,0,0]
  v_pk_fma_f32 v[18:19], v[18:19], v[6:7], v[6:7] op_sel_hi:[1,0,0]
  v_pk_fma_f32 v[20:21], v[20:21], v[6:7], v[6:7] op_sel_hi:[1,0,0]
  v_rcp_f32 v14, v14
  v_rcp_f32 v15, v15
  v_rcp_f32 v16, v16
  v_rcp_f32 v17, v17
  v_rcp_f32 v18, v18
  v_rcp_f32 v19, v19
  v_rcp_f32 v20, v20
  v_rcp_f32 v21, v21
  v_pk_mul_f32 v[210:211], v[210:211], v[14:15]
  v_pk_mul_f32 v[212:213], v[212:213], v[16:17]
  v_pk_mul_f32 v[214:215], v[214:215], v[18:19]
  v_pk_mul_f32 v[216:217], v[216:217], v[20:21]
  v_cvt_pk_bf16_f32 v104, v210, v211
  v_cvt_pk_bf16_f32 v105, v212, v213
  v_cvt_pk_bf16_f32 v106, v214, v215
  v_cvt_pk_bf16_f32 v107, v216, v217
  v_pk_mul_f32 v[14:15], v[238:239], v[238:239]
  v_pk_mul_f32 v[16:17], v[240:241], v[240:241]
  v_pk_mul_f32 v[18:19], v[242:243], v[242:243]
  v_pk_mul_f32 v[20:21], v[244:245], v[244:245]
  v_pk_fma_f32 v[14:15], v[14:15], v[196:197], v[194:195] op_sel:[0,1,1] op_sel_hi:[1,1,1]
  v_pk_fma_f32 v[16:17], v[16:17], v[196:197], v[194:195] op_sel:[0,1,1] op_sel_hi:[1,1,1]
  v_pk_fma_f32 v[18:19], v[18:19], v[196:197], v[194:195] op_sel:[0,1,1] op_sel_hi:[1,1,1]
  v_pk_fma_f32 v[20:21], v[20:21], v[196:197], v[194:195] op_sel:[0,1,1] op_sel_hi:[1,1,1]
  v_pk_mul_f32 v[14:15], v[14:15], v[238:239]
  v_pk_mul_f32 v[16:17], v[16:17], v[240:241]
  v_pk_mul_f32 v[18:19], v[18:19], v[242:243]
  v_pk_mul_f32 v[20:21], v[20:21], v[244:245]
  v_exp_f32 v14, v14
  v_exp_f32 v15, v15
  v_exp_f32 v16, v16
  v_exp_f32 v17, v17
  v_exp_f32 v18, v18
  v_exp_f32 v19, v19
  v_exp_f32 v20, v20
  v_exp_f32 v21, v21
  v_pk_fma_f32 v[14:15], v[14:15], v[6:7], v[6:7] op_sel:[0,1,1] op_sel_hi:[1,1,1]
  v_pk_fma_f32 v[16:17], v[16:17], v[6:7], v[6:7] op_sel:[0,1,1] op_sel_hi:[1,1,1]
  v_pk_fma_f32 v[18:19], v[18:19], v[6:7], v[6:7] op_sel:[0,1,1] op_sel_hi:[1,1,1]
  v_pk_fma_f32 v[20:21], v[20:21], v[6:7], v[6:7] op_sel:[0,1,1] op_sel_hi:[1,1,1]
  v_rcp_f32 v14, v14
  v_rcp_f32 v15, v15
  v_rcp_f32 v16, v16
  v_rcp_f32 v17, v17
  v_rcp_f32 v18, v18
  v_rcp_f32 v19, v19
  v_rcp_f32 v20, v20
  v_rcp_f32 v21, v21
  v_pk_mul_f32 v[238:239], v[238:239], v[14:15]
  v_pk_mul_f32 v[240:241], v[240:241], v[16:17]
  v_pk_mul_f32 v[242:243], v[242:243], v[18:19]
  v_pk_mul_f32 v[244:245], v[244:245], v[20:21]
  v_cvt_pk_bf16_f32 v108, v238, v239
  v_cvt_pk_bf16_f32 v109, v240, v241
  v_cvt_pk_bf16_f32 v110, v242, v243
  v_cvt_pk_bf16_f32 v111, v244, v245
  v_pk_mul_f32 v[14:15], v[218:219], v[218:219]
  v_pk_mul_f32 v[16:17], v[220:221], v[220:221]
  v_pk_mul_f32 v[18:19], v[222:223], v[222:223]
  v_pk_mul_f32 v[20:21], v[224:225], v[224:225]
  v_pk_fma_f32 v[14:15], v[14:15], v[196:197], v[194:195] op_sel_hi:[1,0,0]
  v_pk_fma_f32 v[16:17], v[16:17], v[196:197], v[194:195] op_sel_hi:[1,0,0]
  v_pk_fma_f32 v[18:19], v[18:19], v[196:197], v[194:195] op_sel_hi:[1,0,0]
  v_pk_fma_f32 v[20:21], v[20:21], v[196:197], v[194:195] op_sel_hi:[1,0,0]
  v_pk_mul_f32 v[14:15], v[14:15], v[218:219]
  v_pk_mul_f32 v[16:17], v[16:17], v[220:221]
  v_pk_mul_f32 v[18:19], v[18:19], v[222:223]
  v_pk_mul_f32 v[20:21], v[20:21], v[224:225]
  v_exp_f32 v14, v14
  v_exp_f32 v15, v15
  v_exp_f32 v16, v16
  v_exp_f32 v17, v17
  v_exp_f32 v18, v18
  v_exp_f32 v19, v19
  v_exp_f32 v20, v20
  v_exp_f32 v21, v21
  v_pk_fma_f32 v[14:15], v[14:15], v[6:7], v[6:7] op_sel_hi:[1,0,0]
  v_pk_fma_f32 v[16:17], v[16:17], v[6:7], v[6:7] op_sel_hi:[1,0,0]
  v_pk_fma_f32 v[18:19], v[18:19], v[6:7], v[6:7] op_sel_hi:[1,0,0]
  v_pk_fma_f32 v[20:21], v[20:21], v[6:7], v[6:7] op_sel_hi:[1,0,0]
  v_rcp_f32 v14, v14
  v_rcp_f32 v15, v15
  v_rcp_f32 v16, v16
  v_rcp_f32 v17, v17
  v_rcp_f32 v18, v18
  v_rcp_f32 v19, v19
  v_rcp_f32 v20, v20
  v_rcp_f32 v21, v21
  v_pk_mul_f32 v[218:219], v[218:219], v[14:15]
  v_pk_mul_f32 v[220:221], v[220:221], v[16:17]
  v_pk_mul_f32 v[222:223], v[222:223], v[18:19]
  v_pk_mul_f32 v[224:225], v[224:225], v[20:21]
  v_cvt_pk_bf16_f32 v112, v218, v219
  v_cvt_pk_bf16_f32 v113, v220, v221
  v_cvt_pk_bf16_f32 v114, v222, v223
  v_cvt_pk_bf16_f32 v115, v224, v225
  v_pk_mul_f32 v[14:15], v[246:247], v[246:247]
  v_pk_mul_f32 v[16:17], v[248:249], v[248:249]
  v_pk_mul_f32 v[18:19], v[250:251], v[250:251]
  v_pk_mul_f32 v[20:21], v[252:253], v[252:253]
  v_pk_fma_f32 v[14:15], v[14:15], v[196:197], v[194:195] op_sel:[0,1,1] op_sel_hi:[1,1,1]
  v_pk_fma_f32 v[16:17], v[16:17], v[196:197], v[194:195] op_sel:[0,1,1] op_sel_hi:[1,1,1]
  v_pk_fma_f32 v[18:19], v[18:19], v[196:197], v[194:195] op_sel:[0,1,1] op_sel_hi:[1,1,1]
  v_pk_fma_f32 v[20:21], v[20:21], v[196:197], v[194:195] op_sel:[0,1,1] op_sel_hi:[1,1,1]
  v_pk_mul_f32 v[14:15], v[14:15], v[246:247]
  v_pk_mul_f32 v[16:17], v[16:17], v[248:249]
  v_pk_mul_f32 v[18:19], v[18:19], v[250:251]
  v_pk_mul_f32 v[20:21], v[20:21], v[252:253]
  v_exp_f32 v14, v14
  v_exp_f32 v15, v15
  v_exp_f32 v16, v16
  v_exp_f32 v17, v17
  v_exp_f32 v18, v18
  v_exp_f32 v19, v19
  v_exp_f32 v20, v20
  v_exp_f32 v21, v21
  v_pk_fma_f32 v[14:15], v[14:15], v[6:7], v[6:7] op_sel:[0,1,1] op_sel_hi:[1,1,1]
  v_pk_fma_f32 v[16:17], v[16:17], v[6:7], v[6:7] op_sel:[0,1,1] op_sel_hi:[1,1,1]
  v_pk_fma_f32 v[18:19], v[18:19], v[6:7], v[6:7] op_sel:[0,1,1] op_sel_hi:[1,1,1]
  v_pk_fma_f32 v[20:21], v[20:21], v[6:7], v[6:7] op_sel:[0,1,1] op_sel_hi:[1,1,1]
  v_rcp_f32 v14, v14
  v_rcp_f32 v15, v15
  v_rcp_f32 v16, v16
  v_rcp_f32 v17, v17
  v_rcp_f32 v18, v18
  v_rcp_f32 v19, v19
  v_rcp_f32 v20, v20
  v_rcp_f32 v21, v21
  v_pk_mul_f32 v[246:247], v[246:247], v[14:15]
  v_pk_mul_f32 v[248:249], v[248:249], v[16:17]
  v_pk_mul_f32 v[250:251], v[250:251], v[18:19]
  v_pk_mul_f32 v[252:253], v[252:253], v[20:21]
  v_cvt_pk_bf16_f32 v116, v246, v247
  v_cvt_pk_bf16_f32 v117, v248, v249
  v_cvt_pk_bf16_f32 v118, v250, v251
  v_cvt_pk_bf16_f32 v119, v252, v253
L_p3_done:
  s_xor_b32 s72, s62, s63
  s_lshr_b32 s48, s4, 1
  s_lshl_b32 s48, s48, 3
  s_and_b32 s6, s5, 7
  s_add_u32 s48, s48, s6
  s_and_b32 s49, s4, 1
  s_lshl_b32 s49, s49, 2
  s_lshr_b32 s6, s5, 3
  s_add_u32 s49, s49, s6
  s_mul_i32 s58, s49, 458752
  s_and_b32 s6, s49, 1
  s_lshl_b32 s6, s6, 4
  s_lshl_b32 s7, s3, 2
  s_add_u32 s6, s6, s7
  s_bitcmp1_b32 s49, 1
  s_mov_b32 s7, 0x05316420
  s_cmov_b32 s7, 0x25306420
  s_lshr_b32 s6, s7, s6
  s_and_b32 s6, s6, 15
  s_lshl_b32 s6, s6, 10
  s_add_u32 s58, s58, s6
  s_add_u32 s58, s58, 0x780000
  v_xor_b32 v4, v2, v3
  v_lshlrev_b32 v4, 4, v4
  v_lshl_add_u32 v4, v3, 8, v4
  s_add_u32 s6, s48, 0
  s_and_b32 s6, s6, 3
  s_mul_i32 s7, s6, 7168
  s_add_u32 s68, s7, s58
  s_lshl_b32 s6, s6, 6
  v_xor_b32 v8, s6, v4
  v_add_u32 v12, 65536, v8
  v_add_u32 v16, 131072, v8
  s_add_u32 s6, s48, 1
  s_and_b32 s6, s6, 3
  s_mul_i32 s7, s6, 7168
  s_add_u32 s69, s7, s58
  s_lshl_b32 s6, s6, 6
  v_xor_b32 v9, s6, v4
  v_add_u32 v13, 65536, v9
  v_add_u32 v17, 131072, v9
  s_add_u32 s6, s48, 2
  s_and_b32 s6, s6, 3
  s_mul_i32 s7, s6, 7168
  s_add_u32 s70, s7, s58
  s_lshl_b32 s6, s6, 6
  v_xor_b32 v10, s6, v4
  v_add_u32 v14, 65536, v10
  v_add_u32 v18, 131072, v10
  s_add_u32 s6, s48, 3
  s_and_b32 s6, s6, 3
  s_mul_i32 s7, s6, 7168
  s_add_u32 s71, s7, s58
  s_lshl_b32 s6, s6, 6
  v_xor_b32 v11, s6, v4
  v_add_u32 v15, 65536, v11
  v_add_u32 v19, 131072, v11
  s_lshl_b32 s6, s48, 7
  v_lshlrev_b32 v4, 1, v3
  buffer_load_ushort v20, v4, s[40:43], s6 offen offset:0
  buffer_load_ushort v21, v4, s[40:43], s6 offen offset:32
  buffer_load_ushort v22, v4, s[40:43], s6 offen offset:64
  buffer_load_ushort v23, v4, s[40:43], s6 offen offset:96
  s_lshl_b32 s64, s48, 5
  s_add_u32 s64, s64, s49
  s_mul_i32 s64, s64, 3584
  s_lshl_b32 s6, s3, 10
  s_add_u32 s64, s64, s6
  s_add_u32 s64, s64, 0x400000
  s_mov_b32 s62, 0xb1b800
  s_add_u32 s65, s64, 28672
  s_add_u32 s66, s64, 57344
  s_add_u32 s67, s64, 86016
  v_lshlrev_b32 v7, 3, v0
  s_lshl_b32 s62, s49, 8
  s_add_u32 s62, s62, 0xb3c000
  s_cmp_eq_u32 s3, 0
  s_cbranch_scc0 L_skip12
  v_lshlrev_b32 v5, 7, v0
  v_lshrrev_b32 v4, 1, v0
  v_mul_u32_u24 v4, 1792, v4
  v_add_u32 v5, v5, v4
  s_mov_b32 exec_lo, 0xffffffff
  s_mov_b32 exec_hi, 0
  s_mov_b32 s6, 131072
L_pollS3:
  buffer_load_dword v4, v5, s[36:39], s62 offen sc1
  s_sub_u32 s6, s6, 1
  s_cbranch_scc1 L_pollxS3
  s_waitcnt vmcnt(0)
  v_cmp_eq_u32 vcc, 0, v4
  s_nop 4
  s_cbranch_vccz L_pollxS3
  s_branch L_pollS3
L_pollxS3:
  s_mov_b64 exec, -1
L_skip12:
  s_barrier
  s_cmp_eq_u32 s3, 3
  s_cbranch_scc1 L_p4_one
  buffer_load_dwordx4 v[120:123], v1, s[36:39], s68 offen offset:0 sc1
  buffer_load_dwordx4 v[124:127], v1, s[36:39], s68 offen offset:1024 sc1
  s_add_u32 s68, s68, 28672
  buffer_load_dwordx4 v[128:131], v1, s[36:39], s69 offen offset:0 sc1
  buffer_load_dwordx4 v[132:135], v1, s[36:39], s69 offen offset:1024 sc1
  s_add_u32 s69, s69, 28672
  buffer_load_dwordx4 v[136:139], v1, s[36:39], s70 offen offset:0 sc1
  buffer_load_dwordx4 v[140:143], v1, s[36:39], s70 offen offset:1024 sc1
  s_add_u32 s70, s70, 28672
  buffer_load_dwordx4 v[144:147], v1, s[36:39], s71 offen offset:0 sc1
  buffer_load_dwordx4 v[148:151], v1, s[36:39], s71 offen offset:1024 sc1
  s_add_u32 s71, s71, 28672
  s_waitcnt vmcnt(8)
  v_lshlrev_b32 v24, 16, v20
  v_lshlrev_b32 v25, 16, v20
  v_lshlrev_b32 v26, 16, v20
  v_lshlrev_b32 v27, 16, v20
  v_lshlrev_b32 v28, 16, v20
  v_lshlrev_b32 v29, 16, v20
  v_lshlrev_b32 v30, 16, v20
  v_lshlrev_b32 v31, 16, v20
  v_lshlrev_b32 v32, 16, v21
  v_lshlrev_b32 v33, 16, v21
  v_lshlrev_b32 v34, 16, v21
  v_lshlrev_b32 v35, 16, v21
  v_lshlrev_b32 v36, 16, v21
  v_lshlrev_b32 v37, 16, v21
  v_lshlrev_b32 v38, 16, v21
  v_lshlrev_b32 v39, 16, v21
  v_lshlrev_b32 v40, 16, v22
  v_lshlrev_b32 v41, 16, v22
  v_lshlrev_b32 v42, 16, v22
  v_lshlrev_b32 v43, 16, v22
  v_lshlrev_b32 v44, 16, v22
  v_lshlrev_b32 v45, 16, v22
  v_lshlrev_b32 v46, 16, v22
  v_lshlrev_b32 v47, 16, v22
  v_lshlrev_b32 v48, 16, v23
  v_lshlrev_b32 v49, 16, v23
  v_lshlrev_b32 v50, 16, v23
  v_lshlrev_b32 v51, 16, v23
  v_lshlrev_b32 v52, 16, v23
  v_lshlrev_b32 v53, 16, v23
  v_lshlrev_b32 v54, 16, v23
  v_lshlrev_b32 v55, 16, v23
  ds_read_b128 v[56:59], v8 offset:0
  ds_read_b128 v[60:63], v8 offset:4096
  ds_read_b128 v[64:67], v8 offset:8192
  ds_read_b128 v[68:71], v8 offset:12288
  buffer_load_dwordx4 v[152:155], v1, s[36:39], s68 offen offset:0 sc1
  buffer_load_dwordx4 v[156:159], v1, s[36:39], s68 offen offset:1024 sc1
  s_add_u32 s68, s68, 28672
  buffer_load_dwordx4 v[160:163], v1, s[36:39], s69 offen offset:0 sc1
  buffer_load_dwordx4 v[164:167], v1, s[36:39], s69 offen offset:1024 sc1
  s_add_u32 s69, s69, 28672
  buffer_store_dwordx4 v[104:107], v1, s[36:39], s54 offen sc1
  ds_read_b128 v[72:75], v9 offset:0
  buffer_load_dwordx4 v[184:187], v1, s[36:39], s68 offen offset:0 sc1
  s_waitcnt vmcnt(12) lgkmcnt(1)
  v_mfma_f32_16x16x32_bf16 v[24:27], v[120:123], v[56:59], v[24:27]
  ds_read_b128 v[76:79], v9 offset:4096
  buffer_load_dwordx4 v[188:191], v1, s[36:39], s68 offen offset:1024 sc1
  s_add_u32 s68, s68, 28672
  v_mfma_f32_16x16x32_bf16 v[32:35], v[120:123], v[60:63], v[32:35]
  buffer_load_dwordx4 v[168:171], v1, s[36:39], s70 offen offset:0 sc1
  v_mfma_f32_16x16x32_bf16 v[40:43], v[120:123], v[64:67], v[40:43]
  ds_read_b128 v[80:83], v9 offset:8192
  buffer_load_dwordx4 v[172:175], v1, s[36:39], s70 offen offset:1024 sc1
  s_add_u32 s70, s70, 28672
  v_mfma_f32_16x16x32_bf16 v[48:51], v[120:123], v[68:71], v[48:51]
  ds_read_b128 v[84:87], v9 offset:12288
  buffer_store_dwordx4 v[108:111], v1, s[36:39], s55 offen sc1
  v_mfma_f32_16x16x32_bf16 v[28:31], v[124:127], v[56:59], v[28:31]
  v_mfma_f32_16x16x32_bf16 v[36:39], v[124:127], v[60:63], v[36:39]
  v_mfma_f32_16x16x32_bf16 v[44:47], v[124:127], v[64:67], v[44:47]
  v_mfma_f32_16x16x32_bf16 v[52:55], v[124:127], v[68:71], v[52:55]
  ds_read_b128 v[88:91], v10 offset:0
  buffer_load_dwordx4 v[176:179], v1, s[36:39], s71 offen offset:0 sc1
  s_waitcnt vmcnt(15) lgkmcnt(1)
  v_mfma_f32_16x16x32_bf16 v[24:27], v[128:131], v[72:75], v[24:27]
  ds_read_b128 v[92:95], v10 offset:4096
  buffer_load_dwordx4 v[180:183], v1, s[36:39], s71 offen offset:1024 sc1
  s_add_u32 s71, s71, 28672
  v_mfma_f32_16x16x32_bf16 v[32:35], v[128:131], v[76:79], v[32:35]
  buffer_load_dwordx4 v[216:219], v1, s[36:39], s68 offen offset:0 sc1
  v_mfma_f32_16x16x32_bf16 v[40:43], v[128:131], v[80:83], v[40:43]
  ds_read_b128 v[96:99], v10 offset:8192
  buffer_load_dwordx4 v[220:223], v1, s[36:39], s68 offen offset:1024 sc1
  s_add_u32 s68, s68, 28672
  v_mfma_f32_16x16x32_bf16 v[48:51], v[128:131], v[84:87], v[48:51]
  ds_read_b128 v[100:103], v10 offset:12288
  s_cmp_eq_u32 s72, 1
  s_cbranch_scc0 L_skip13
  buffer_store_dwordx4 v[112:115], v1, s[36:39], s54 offen offset:1024 sc1
L_skip13:
  s_cmp_eq_u32 s72, 0
  s_cbranch_scc0 L_skip14
  buffer_store_dwordx2 v[112:113], v7, s[36:39], s60 offen offset:3072 sc1
L_skip14:
  v_mfma_f32_16x16x32_bf16 v[28:31], v[132:135], v[72:75], v[28:31]
  v_mfma_f32_16x16x32_bf16 v[36:39], v[132:135], v[76:79], v[36:39]
  v_mfma_f32_16x16x32_bf16 v[44:47], v[132:135], v[80:83], v[44:47]
  v_mfma_f32_16x16x32_bf16 v[52:55], v[132:135], v[84:87], v[52:55]
  ds_read_b128 v[56:59], v11 offset:0
  buffer_load_dwordx4 v[192:195], v1, s[36:39], s69 offen offset:0 sc1
  s_waitcnt vmcnt(18) lgkmcnt(1)
  v_mfma_f32_16x16x32_bf16 v[24:27], v[136:139], v[88:91], v[24:27]
  ds_read_b128 v[60:63], v11 offset:4096
  v_mfma_f32_16x16x32_bf16 v[32:35], v[136:139], v[92:95], v[32:35]
  buffer_load_dwordx4 v[196:199], v1, s[36:39], s69 offen offset:1024 sc1
  s_add_u32 s69, s69, 28672
  v_mfma_f32_16x16x32_bf16 v[40:43], v[136:139], v[96:99], v[40:43]
  ds_read_b128 v[64:67], v11 offset:8192
  v_mfma_f32_16x16x32_bf16 v[48:51], v[136:139], v[100:103], v[48:51]
  ds_read_b128 v[68:71], v11 offset:12288
  s_cmp_eq_u32 s72, 1
  s_cbranch_scc0 L_skip15
  buffer_store_dwordx4 v[116:119], v1, s[36:39], s55 offen offset:1024 sc1
L_skip15:
  s_cmp_eq_u32 s72, 0
  s_cbranch_scc0 L_skip16
  buffer_store_dwordx2 v[116:117], v7, s[36:39], s61 offen offset:3072 sc1
L_skip16:
  v_mfma_f32_16x16x32_bf16 v[28:31], v[140:143], v[88:91], v[28:31]
  v_mfma_f32_16x16x32_bf16 v[36:39], v[140:143], v[92:95], v[36:39]
  v_mfma_f32_16x16x32_bf16 v[44:47], v[140:143], v[96:99], v[44:47]
  v_mfma_f32_16x16x32_bf16 v[52:55], v[140:143], v[100:103], v[52:55]
  s_barrier
  ds_read_b128 v[72:75], v8 offset:16384
  buffer_load_dwordx4 v[200:203], v1, s[36:39], s70 offen offset:0 sc1
  s_waitcnt vmcnt(19) lgkmcnt(1)
  v_mfma_f32_16x16x32_bf16 v[24:27], v[144:147], v[56:59], v[24:27]
  ds_read_b128 v[76:79], v8 offset:20480
  v_mfma_f32_16x16x32_bf16 v[32:35], v[144:147], v[60:63], v[32:35]
  v_mfma_f32_16x16x32_bf16 v[40:43], v[144:147], v[64:67], v[40:43]
  ds_read_b128 v[80:83], v8 offset:24576
  buffer_load_dwordx4 v[204:207], v1, s[36:39], s70 offen offset:1024 sc1
  s_add_u32 s70, s70, 28672
  v_mfma_f32_16x16x32_bf16 v[48:51], v[144:147], v[68:71], v[48:51]
  ds_read_b128 v[84:87], v8 offset:28672
  v_mfma_f32_16x16x32_bf16 v[28:31], v[148:151], v[56:59], v[28:31]
  v_mfma_f32_16x16x32_bf16 v[36:39], v[148:151], v[60:63], v[36:39]
  v_mfma_f32_16x16x32_bf16 v[44:47], v[148:151], v[64:67], v[44:47]
  v_mfma_f32_16x16x32_bf16 v[52:55], v[148:151], v[68:71], v[52:55]
  ds_read_b128 v[88:91], v9 offset:16384
  buffer_load_dwordx4 v[208:211], v1, s[36:39], s71 offen offset:0 sc1
  s_waitcnt vmcnt(19) lgkmcnt(1)
  v_mfma_f32_16x16x32_bf16 v[24:27], v[152:155], v[72:75], v[24:27]
  ds_read_b128 v[92:95], v9 offset:20480
  v_mfma_f32_16x16x32_bf16 v[32:35], v[152:155], v[76:79], v[32:35]
  v_mfma_f32_16x16x32_bf16 v[40:43], v[152:155], v[80:83], v[40:43]
  ds_read_b128 v[96:99], v9 offset:24576
  buffer_load_dwordx4 v[212:215], v1, s[36:39], s71 offen offset:1024 sc1
  s_add_u32 s71, s71, 28672
  v_mfma_f32_16x16x32_bf16 v[48:51], v[152:155], v[84:87], v[48:51]
  ds_read_b128 v[100:103], v9 offset:28672
  v_mfma_f32_16x16x32_bf16 v[28:31], v[156:159], v[72:75], v[28:31]
  v_mfma_f32_16x16x32_bf16 v[36:39], v[156:159], v[76:79], v[36:39]
  v_mfma_f32_16x16x32_bf16 v[44:47], v[156:159], v[80:83], v[44:47]
  v_mfma_f32_16x16x32_bf16 v[52:55], v[156:159], v[84:87], v[52:55]
  ds_read_b128 v[56:59], v10 offset:16384
  buffer_load_dwordx4 v[120:123], v1, s[36:39], s68 offen offset:0 sc1
  s_waitcnt vmcnt(19) lgkmcnt(1)
  v_mfma_f32_16x16x32_bf16 v[24:27], v[160:163], v[88:91], v[24:27]
  ds_read_b128 v[60:63], v10 offset:20480
  v_mfma_f32_16x16x32_bf16 v[32:35], v[160:163], v[92:95], v[32:35]
  v_mfma_f32_16x16x32_bf16 v[40:43], v[160:163], v[96:99], v[40:43]
  ds_read_b128 v[64:67], v10 offset:24576
  buffer_load_dwordx4 v[124:127], v1, s[36:39], s68 offen offset:1024 sc1
  s_add_u32 s68, s68, 28672
  v_mfma_f32_16x16x32_bf16 v[48:51], v[160:163], v[100:103], v[48:51]
  ds_read_b128 v[68:71], v10 offset:28672
  v_mfma_f32_16x16x32_bf16 v[28:31], v[164:167], v[88:91], v[28:31]
  v_mfma_f32_16x16x32_bf16 v[36:39], v[164:167], v[92:95], v[36:39]
  v_mfma_f32_16x16x32_bf16 v[44:47], v[164:167], v[96:99], v[44:47]
  v_mfma_f32_16x16x32_bf16 v[52:55], v[164:167], v[100:103], v[52:55]
  ds_read_b128 v[72:75], v11 offset:16384
  buffer_load_dwordx4 v[224:227], v1, s[36:39], s69 offen offset:0 sc1
  s_waitcnt vmcnt(16) lgkmcnt(1)
  v_mfma_f32_16x16x32_bf16 v[24:27], v[168:171], v[56:59], v[24:27]
  ds_read_b128 v[76:79], v11 offset:20480
  v_mfma_f32_16x16x32_bf16 v[32:35], v[168:171], v[60:63], v[32:35]
  v_mfma_f32_16x16x32_bf16 v[40:43], v[168:171], v[64:67], v[40:43]
  ds_read_b128 v[80:83], v11 offset:24576
  buffer_load_dwordx4 v[228:231], v1, s[36:39], s69 offen offset:1024 sc1
  s_add_u32 s69, s69, 28672
  v_mfma_f32_16x16x32_bf16 v[48:51], v[168:171], v[68:71], v[48:51]
  ds_read_b128 v[84:87], v11 offset:28672
  v_mfma_f32_16x16x32_bf16 v[28:31], v[172:175], v[56:59], v[28:31]
  v_mfma_f32_16x16x32_bf16 v[36:39], v[172:175], v[60:63], v[36:39]
  v_mfma_f32_16x16x32_bf16 v[44:47], v[172:175], v[64:67], v[44:47]
  v_mfma_f32_16x16x32_bf16 v[52:55], v[172:175], v[68:71], v[52:55]
  s_barrier
  ds_read_b128 v[88:91], v8 offset:32768
  buffer_load_dwordx4 v[232:235], v1, s[36:39], s70 offen offset:0 sc1
  s_waitcnt vmcnt(15) lgkmcnt(1)
  v_mfma_f32_16x16x32_bf16 v[24:27], v[176:179], v[72:75], v[24:27]
  ds_read_b128 v[92:95], v8 offset:36864
  v_mfma_f32_16x16x32_bf16 v[32:35], v[176:179], v[76:79], v[32:35]
  v_mfma_f32_16x16x32_bf16 v[40:43], v[176:179], v[80:83], v[40:43]
  ds_read_b128 v[96:99], v8 offset:40960
  buffer_load_dwordx4 v[236:239], v1, s[36:39], s70 offen offset:1024 sc1
  s_add_u32 s70, s70, 28672
  v_mfma_f32_16x16x32_bf16 v[48:51], v[176:179], v[84:87], v[48:51]
  ds_read_b128 v[100:103], v8 offset:45056
  v_mfma_f32_16x16x32_bf16 v[28:31], v[180:183], v[72:75], v[28:31]
  v_mfma_f32_16x16x32_bf16 v[36:39], v[180:183], v[76:79], v[36:39]
  v_mfma_f32_16x16x32_bf16 v[44:47], v[180:183], v[80:83], v[44:47]
  v_mfma_f32_16x16x32_bf16 v[52:55], v[180:183], v[84:87], v[52:55]
  ds_read_b128 v[56:59], v9 offset:32768
  buffer_load_dwordx4 v[240:243], v1, s[36:39], s71 offen offset:0 sc1
  s_waitcnt lgkmcnt(1)
  v_mfma_f32_16x16x32_bf16 v[24:27], v[184:187], v[88:91], v[24:27]
  ds_read_b128 v[60:63], v9 offset:36864
  v_mfma_f32_16x16x32_bf16 v[32:35], v[184:187], v[92:95], v[32:35]
  v_mfma_f32_16x16x32_bf16 v[40:43], v[184:187], v[96:99], v[40:43]
  ds_read_b128 v[64:67], v9 offset:40960
  buffer_load_dwordx4 v[244:247], v1, s[36:39], s71 offen offset:1024 sc1
  s_add_u32 s71, s71, 28672
  v_mfma_f32_16x16x32_bf16 v[48:51], v[184:187], v[100:103], v[48:51]
  ds_read_b128 v[68:71], v9 offset:45056
  v_mfma_f32_16x16x32_bf16 v[28:31], v[188:191], v[88:91], v[28:31]
  v_mfma_f32_16x16x32_bf16 v[36:39], v[188:191], v[92:95], v[36:39]
  v_mfma_f32_16x16x32_bf16 v[44:47], v[188:191], v[96:99], v[44:47]
  v_mfma_f32_16x16x32_bf16 v[52:55], v[188:191], v[100:103], v[52:55]
  ds_read_b128 v[72:75], v10 offset:32768
  buffer_load_dwordx4 v[152:155], v1, s[36:39], s68 offen offset:0 sc1
  s_waitcnt vmcnt(14) lgkmcnt(1)
  v_mfma_f32_16x16x32_bf16 v[24:27], v[192:195], v[56:59], v[24:27]
  ds_read_b128 v[76:79], v10 offset:36864
  v_mfma_f32_16x16x32_bf16 v[32:35], v[192:195], v[60:63], v[32:35]
  v_mfma_f32_16x16x32_bf16 v[40:43], v[192:195], v[64:67], v[40:43]
  ds_read_b128 v[80:83], v10 offset:40960
  buffer_load_dwordx4 v[156:159], v1, s[36:39], s68 offen offset:1024 sc1
  s_add_u32 s68, s68, 28672
  v_mfma_f32_16x16x32_bf16 v[48:51], v[192:195], v[68:71], v[48:51]
  ds_read_b128 v[84:87], v10 offset:45056
  v_mfma_f32_16x16x32_bf16 v[28:31], v[196:199], v[56:59], v[28:31]
  v_mfma_f32_16x16x32_bf16 v[36:39], v[196:199], v[60:63], v[36:39]
  v_mfma_f32_16x16x32_bf16 v[44:47], v[196:199], v[64:67], v[44:47]
  v_mfma_f32_16x16x32_bf16 v[52:55], v[196:199], v[68:71], v[52:55]
  ds_read_b128 v[88:91], v11 offset:32768
  buffer_load_dwordx4 v[128:131], v1, s[36:39], s69 offen offset:0 sc1
  s_waitcnt vmcnt(13) lgkmcnt(1)
  v_mfma_f32_16x16x32_bf16 v[24:27], v[200:203], v[72:75], v[24:27]
  ds_read_b128 v[92:95], v11 offset:36864
  v_mfma_f32_16x16x32_bf16 v[32:35], v[200:203], v[76:79], v[32:35]
  v_mfma_f32_16x16x32_bf16 v[40:43], v[200:203], v[80:83], v[40:43]
  ds_read_b128 v[96:99], v11 offset:40960
  buffer_load_dwordx4 v[132:135], v1, s[36:39], s69 offen offset:1024 sc1
  s_add_u32 s69, s69, 28672
  v_mfma_f32_16x16x32_bf16 v[48:51], v[200:203], v[84:87], v[48:51]
  ds_read_b128 v[100:103], v11 offset:45056
  v_mfma_f32_16x16x32_bf16 v[28:31], v[204:207], v[72:75], v[28:31]
  v_mfma_f32_16x16x32_bf16 v[36:39], v[204:207], v[76:79], v[36:39]
  v_mfma_f32_16x16x32_bf16 v[44:47], v[204:207], v[80:83], v[44:47]
  v_mfma_f32_16x16x32_bf16 v[52:55], v[204:207], v[84:87], v[52:55]
  s_barrier
  ds_read_b128 v[56:59], v8 offset:49152
  buffer_load_dwordx4 v[136:139], v1, s[36:39], s70 offen offset:0 sc1
  s_waitcnt vmcnt(13) lgkmcnt(1)
  v_mfma_f32_16x16x32_bf16 v[24:27], v[208:211], v[88:91], v[24:27]
  ds_read_b128 v[60:63], v8 offset:53248
  v_mfma_f32_16x16x32_bf16 v[32:35], v[208:211], v[92:95], v[32:35]
  v_mfma_f32_16x16x32_bf16 v[40:43], v[208:211], v[96:99], v[40:43]
  ds_read_b128 v[64:67], v8 offset:57344
  buffer_load_dwordx4 v[140:143], v1, s[36:39], s70 offen offset:1024 sc1
  s_add_u32 s70, s70, 28672
  v_mfma_f32_16x16x32_bf16 v[48:51], v[208:211], v[100:103], v[48:51]
  ds_read_b128 v[68:71], v8 offset:61440
  v_mfma_f32_16x16x32_bf16 v[28:31], v[212:215], v[88:91], v[28:31]
  v_mfma_f32_16x16x32_bf16 v[36:39], v[212:215], v[92:95], v[36:39]
  v_mfma_f32_16x16x32_bf16 v[44:47], v[212:215], v[96:99], v[44:47]
  v_mfma_f32_16x16x32_bf16 v[52:55], v[212:215], v[100:103], v[52:55]
  ds_read_b128 v[72:75], v9 offset:49152
  buffer_load_dwordx4 v[144:147], v1, s[36:39], s71 offen offset:0 sc1
  s_waitcnt lgkmcnt(1)
  v_mfma_f32_16x16x32_bf16 v[24:27], v[216:219], v[56:59], v[24:27]
  ds_read_b128 v[76:79], v9 offset:53248
  v_mfma_f32_16x16x32_bf16 v[32:35], v[216:219], v[60:63], v[32:35]
  v_mfma_f32_16x16x32_bf16 v[40:43], v[216:219], v[64:67], v[40:43]
  ds_read_b128 v[80:83], v9 offset:57344
  buffer_load_dwordx4 v[148:151], v1, s[36:39], s71 offen offset:1024 sc1
  s_add_u32 s71, s71, 28672
  v_mfma_f32_16x16x32_bf16 v[48:51], v[216:219], v[68:71], v[48:51]
  ds_read_b128 v[84:87], v9 offset:61440
  v_mfma_f32_16x16x32_bf16 v[28:31], v[220:223], v[56:59], v[28:31]
  v_mfma_f32_16x16x32_bf16 v[36:39], v[220:223], v[60:63], v[36:39]
  v_mfma_f32_16x16x32_bf16 v[44:47], v[220:223], v[64:67], v[44:47]
  v_mfma_f32_16x16x32_bf16 v[52:55], v[220:223], v[68:71], v[52:55]
  ds_read_b128 v[88:91], v10 offset:49152
  buffer_load_dwordx4 v[184:187], v1, s[36:39], s68 offen offset:0 sc1
  s_waitcnt vmcnt(13) lgkmcnt(1)
  v_mfma_f32_16x16x32_bf16 v[24:27], v[224:227], v[72:75], v[24:27]
  ds_read_b128 v[92:95], v10 offset:53248
  v_mfma_f32_16x16x32_bf16 v[32:35], v[224:227], v[76:79], v[32:35]
  v_mfma_f32_16x16x32_bf16 v[40:43], v[224:227], v[80:83], v[40:43]
  ds_read_b128 v[96:99], v10 offset:57344
  buffer_load_dwordx4 v[188:191], v1, s[36:39], s68 offen offset:1024 sc1
  s_add_u32 s68, s68, 28672
  v_mfma_f32_16x16x32_bf16 v[48:51], v[224:227], v[84:87], v[48:51]
  ds_read_b128 v[100:103], v10 offset:61440
  v_mfma_f32_16x16x32_bf16 v[28:31], v[228:231], v[72:75], v[28:31]
  v_mfma_f32_16x16x32_bf16 v[36:39], v[228:231], v[76:79], v[36:39]
  v_mfma_f32_16x16x32_bf16 v[44:47], v[228:231], v[80:83], v[44:47]
  v_mfma_f32_16x16x32_bf16 v[52:55], v[228:231], v[84:87], v[52:55]
  ds_read_b128 v[56:59], v11 offset:49152
  buffer_load_dwordx4 v[160:163], v1, s[36:39], s69 offen offset:0 sc1
  s_waitcnt vmcnt(13) lgkmcnt(1)
  v_mfma_f32_16x16x32_bf16 v[24:27], v[232:235], v[88:91], v[24:27]
  ds_read_b128 v[60:63], v11 offset:53248
  v_mfma_f32_16x16x32_bf16 v[32:35], v[232:235], v[92:95], v[32:35]
  v_mfma_f32_16x16x32_bf16 v[40:43], v[232:235], v[96:99], v[40:43]
  ds_read_b128 v[64:67], v11 offset:57344
  buffer_load_dwordx4 v[164:167], v1, s[36:39], s69 offen offset:1024 sc1
  s_add_u32 s69, s69, 28672
  v_mfma_f32_16x16x32_bf16 v[48:51], v[232:235], v[100:103], v[48:51]
  ds_read_b128 v[68:71], v11 offset:61440
  v_mfma_f32_16x16x32_bf16 v[28:31], v[236:239], v[88:91], v[28:31]
  v_mfma_f32_16x16x32_bf16 v[36:39], v[236:239], v[92:95], v[36:39]
  v_mfma_f32_16x16x32_bf16 v[44:47], v[236:239], v[96:99], v[44:47]
  v_mfma_f32_16x16x32_bf16 v[52:55], v[236:239], v[100:103], v[52:55]
  s_barrier
  ds_read_b128 v[72:75], v16 offset:0
  buffer_load_dwordx4 v[168:171], v1, s[36:39], s70 offen offset:0 sc1
  s_waitcnt vmcnt(13) lgkmcnt(1)
  v_mfma_f32_16x16x32_bf16 v[24:27], v[240:243], v[56:59], v[24:27]
  ds_read_b128 v[76:79], v16 offset:4096
  v_mfma_f32_16x16x32_bf16 v[32:35], v[240:243], v[60:63], v[32:35]
  v_mfma_f32_16x16x32_bf16 v[40:43], v[240:243], v[64:67], v[40:43]
  ds_read_b128 v[80:83], v16 offset:8192
  buffer_load_dwordx4 v[172:175], v1, s[36:39], s70 offen offset:1024 sc1
  s_add_u32 s70, s70, 28672
  v_mfma_f32_16x16x32_bf16 v[48:51], v[240:243], v[68:71], v[48:51]
  ds_read_b128 v[84:87], v16 offset:12288
  v_mfma_f32_16x16x32_bf16 v[28:31], v[244:247], v[56:59], v[28:31]
  v_mfma_f32_16x16x32_bf16 v[36:39], v[244:247], v[60:63], v[36:39]
  v_mfma_f32_16x16x32_bf16 v[44:47], v[244:247], v[64:67], v[44:47]
  v_mfma_f32_16x16x32_bf16 v[52:55], v[244:247], v[68:71], v[52:55]
  ds_read_b128 v[88:91], v17 offset:0
  buffer_load_dwordx4 v[176:179], v1, s[36:39], s71 offen offset:0 sc1
  s_waitcnt lgkmcnt(1)
  v_mfma_f32_16x16x32_bf16 v[24:27], v[120:123], v[72:75], v[24:27]
  ds_read_b128 v[92:95], v17 offset:4096
  v_mfma_f32_16x16x32_bf16 v[32:35], v[120:123], v[76:79], v[32:35]
  v_mfma_f32_16x16x32_bf16 v[40:43], v[120:123], v[80:83], v[40:43]
  ds_read_b128 v[96:99], v17 offset:8192
  buffer_load_dwordx4 v[180:183], v1, s[36:39], s71 offen offset:1024 sc1
  s_add_u32 s71, s71, 28672
  v_mfma_f32_16x16x32_bf16 v[48:51], v[120:123], v[84:87], v[48:51]
  ds_read_b128 v[100:103], v17 offset:12288
  v_mfma_f32_16x16x32_bf16 v[28:31], v[124:127], v[72:75], v[28:31]
  v_mfma_f32_16x16x32_bf16 v[36:39], v[124:127], v[76:79], v[36:39]
  v_mfma_f32_16x16x32_bf16 v[44:47], v[124:127], v[80:83], v[44:47]
  v_mfma_f32_16x16x32_bf16 v[52:55], v[124:127], v[84:87], v[52:55]
  ds_read_b128 v[56:59], v18 offset:0
  buffer_load_dwordx4 v[216:219], v1, s[36:39], s68 offen offset:0 sc1
  s_waitcnt vmcnt(13) lgkmcnt(1)
  v_mfma_f32_16x16x32_bf16 v[24:27], v[128:131], v[88:91], v[24:27]
  ds_read_b128 v[60:63], v18 offset:4096
  v_mfma_f32_16x16x32_bf16 v[32:35], v[128:131], v[92:95], v[32:35]
  v_mfma_f32_16x16x32_bf16 v[40:43], v[128:131], v[96:99], v[40:43]
  ds_read_b128 v[64:67], v18 offset:8192
  buffer_load_dwordx4 v[220:223], v1, s[36:39], s68 offen offset:1024 sc1
  s_add_u32 s68, s68, 28672
  v_mfma_f32_16x16x32_bf16 v[48:51], v[128:131], v[100:103], v[48:51]
  ds_read_b128 v[68:71], v18 offset:12288
  v_mfma_f32_16x16x32_bf16 v[28:31], v[132:135], v[88:91], v[28:31]
  v_mfma_f32_16x16x32_bf16 v[36:39], v[132:135], v[92:95], v[36:39]
  v_mfma_f32_16x16x32_bf16 v[44:47], v[132:135], v[96:99], v[44:47]
  v_mfma_f32_16x16x32_bf16 v[52:55], v[132:135], v[100:103], v[52:55]
  ds_read_b128 v[72:75], v19 offset:0
  buffer_load_dwordx4 v[192:195], v1, s[36:39], s69 offen offset:0 sc1
  s_waitcnt vmcnt(13) lgkmcnt(1)
  v_mfma_f32_16x16x32_bf16 v[24:27], v[136:139], v[56:59], v[24:27]
  ds_read_b128 v[76:79], v19 offset:4096
  v_mfma_f32_16x16x32_bf16 v[32:35], v[136:139], v[60:63], v[32:35]
  v_mfma_f32_16x16x32_bf16 v[40:43], v[136:139], v[64:67], v[40:43]
  ds_read_b128 v[80:83], v19 offset:8192
  buffer_load_dwordx4 v[196:199], v1, s[36:39], s69 offen offset:1024 sc1
  s_add_u32 s69, s69, 28672
  v_mfma_f32_16x16x32_bf16 v[48:51], v[136:139], v[68:71], v[48:51]
  ds_read_b128 v[84:87], v19 offset:12288
  v_mfma_f32_16x16x32_bf16 v[28:31], v[140:143], v[56:59], v[28:31]
  v_mfma_f32_16x16x32_bf16 v[36:39], v[140:143], v[60:63], v[36:39]
  v_mfma_f32_16x16x32_bf16 v[44:47], v[140:143], v[64:67], v[44:47]
  v_mfma_f32_16x16x32_bf16 v[52:55], v[140:143], v[68:71], v[52:55]
  s_barrier
  ds_read_b128 v[88:91], v12 offset:0
  buffer_load_dwordx4 v[200:203], v1, s[36:39], s70 offen offset:0 sc1
  s_waitcnt vmcnt(13) lgkmcnt(1)
  v_mfma_f32_16x16x32_bf16 v[24:27], v[144:147], v[72:75], v[24:27]
  ds_read_b128 v[92:95], v12 offset:4096
  v_mfma_f32_16x16x32_bf16 v[32:35], v[144:147], v[76:79], v[32:35]
  v_mfma_f32_16x16x32_bf16 v[40:43], v[144:147], v[80:83], v[40:43]
  ds_read_b128 v[96:99], v12 offset:8192
  buffer_load_dwordx4 v[204:207], v1, s[36:39], s70 offen offset:1024 sc1
  s_add_u32 s70, s70, 28672
  v_mfma_f32_16x16x32_bf16 v[48:51], v[144:147], v[84:87], v[48:51]
  ds_read_b128 v[100:103], v12 offset:12288
  v_mfma_f32_16x16x32_bf16 v[28:31], v[148:151], v[72:75], v[28:31]
  v_mfma_f32_16x16x32_bf16 v[36:39], v[148:151], v[76:79], v[36:39]
  v_mfma_f32_16x16x32_bf16 v[44:47], v[148:151], v[80:83], v[44:47]
  v_mfma_f32_16x16x32_bf16 v[52:55], v[148:151], v[84:87], v[52:55]
  ds_read_b128 v[56:59], v13 offset:0
  buffer_load_dwordx4 v[208:211], v1, s[36:39], s71 offen offset:0 sc1
  s_waitcnt lgkmcnt(1)
  v_mfma_f32_16x16x32_bf16 v[24:27], v[152:155], v[88:91], v[24:27]
  ds_read_b128 v[60:63], v13 offset:4096
  v_mfma_f32_16x16x32_bf16 v[32:35], v[152:155], v[92:95], v[32:35]
  v_mfma_f32_16x16x32_bf16 v[40:43], v[152:155], v[96:99], v[40:43]
  ds_read_b128 v[64:67], v13 offset:8192
  buffer_load_dwordx4 v[212:215], v1, s[36:39], s71 offen offset:1024 sc1
  s_add_u32 s71, s71, 28672
  v_mfma_f32_16x16x32_bf16 v[48:51], v[152:155], v[100:103], v[48:51]
  ds_read_b128 v[68:71], v13 offset:12288
  v_mfma_f32_16x16x32_bf16 v[28:31], v[156:159], v[88:91], v[28:31]
  v_mfma_f32_16x16x32_bf16 v[36:39], v[156:159], v[92:95], v[36:39]
  v_mfma_f32_16x16x32_bf16 v[44:47], v[156:159], v[96:99], v[44:47]
  v_mfma_f32_16x16x32_bf16 v[52:55], v[156:159], v[100:103], v[52:55]
  ds_read_b128 v[72:75], v14 offset:0
  buffer_load_dwordx4 v[120:123], v1, s[36:39], s68 offen offset:0 sc1
  s_waitcnt vmcnt(13) lgkmcnt(1)
  v_mfma_f32_16x16x32_bf16 v[24:27], v[160:163], v[56:59], v[24:27]
  ds_read_b128 v[76:79], v14 offset:4096
  v_mfma_f32_16x16x32_bf16 v[32:35], v[160:163], v[60:63], v[32:35]
  v_mfma_f32_16x16x32_bf16 v[40:43], v[160:163], v[64:67], v[40:43]
  ds_read_b128 v[80:83], v14 offset:8192
  buffer_load_dwordx4 v[124:127], v1, s[36:39], s68 offen offset:1024 sc1
  s_add_u32 s68, s68, 28672
  v_mfma_f32_16x16x32_bf16 v[48:51], v[160:163], v[68:71], v[48:51]
  ds_read_b128 v[84:87], v14 offset:12288
  v_mfma_f32_16x16x32_bf16 v[28:31], v[164:167], v[56:59], v[28:31]
  v_mfma_f32_16x16x32_bf16 v[36:39], v[164:167], v[60:63], v[36:39]
  v_mfma_f32_16x16x32_bf16 v[44:47], v[164:167], v[64:67], v[44:47]
  v_mfma_f32_16x16x32_bf16 v[52:55], v[164:167], v[68:71], v[52:55]
  ds_read_b128 v[88:91], v15 offset:0
  buffer_load_dwordx4 v[224:227], v1, s[36:39], s69 offen offset:0 sc1
  s_waitcnt vmcnt(13) lgkmcnt(1)
  v_mfma_f32_16x16x32_bf16 v[24:27], v[168:171], v[72:75], v[24:27]
  ds_read_b128 v[92:95], v15 offset:4096
  v_mfma_f32_16x16x32_bf16 v[32:35], v[168:171], v[76:79], v[32:35]
  v_mfma_f32_16x16x32_bf16 v[40:43], v[168:171], v[80:83], v[40:43]
  ds_read_b128 v[96:99], v15 offset:8192
  buffer_load_dwordx4 v[228:231], v1, s[36:39], s69 offen offset:1024 sc1
  s_add_u32 s69, s69, 28672
  v_mfma_f32_16x16x32_bf16 v[48:51], v[168:171], v[84:87], v[48:51]
  ds_read_b128 v[100:103], v15 offset:12288
  v_mfma_f32_16x16x32_bf16 v[28:31], v[172:175], v[72:75], v[28:31]
  v_mfma_f32_16x16x32_bf16 v[36:39], v[172:175], v[76:79], v[36:39]
  v_mfma_f32_16x16x32_bf16 v[44:47], v[172:175], v[80:83], v[44:47]
  v_mfma_f32_16x16x32_bf16 v[52:55], v[172:175], v[84:87], v[52:55]
  s_barrier
  ds_read_b128 v[56:59], v12 offset:16384
  buffer_load_dwordx4 v[232:235], v1, s[36:39], s70 offen offset:0 sc1
  s_waitcnt vmcnt(13) lgkmcnt(1)
  v_mfma_f32_16x16x32_bf16 v[24:27], v[176:179], v[88:91], v[24:27]
  ds_read_b128 v[60:63], v12 offset:20480
  v_mfma_f32_16x16x32_bf16 v[32:35], v[176:179], v[92:95], v[32:35]
  v_mfma_f32_16x16x32_bf16 v[40:43], v[176:179], v[96:99], v[40:43]
  ds_read_b128 v[64:67], v12 offset:24576
  buffer_load_dwordx4 v[236:239], v1, s[36:39], s70 offen offset:1024 sc1
  s_add_u32 s70, s70, 28672
  v_mfma_f32_16x16x32_bf16 v[48:51], v[176:179], v[100:103], v[48:51]
  ds_read_b128 v[68:71], v12 offset:28672
  v_mfma_f32_16x16x32_bf16 v[28:31], v[180:183], v[88:91], v[28:31]
  v_mfma_f32_16x16x32_bf16 v[36:39], v[180:183], v[92:95], v[36:39]
  v_mfma_f32_16x16x32_bf16 v[44:47], v[180:183], v[96:99], v[44:47]
  v_mfma_f32_16x16x32_bf16 v[52:55], v[180:183], v[100:103], v[52:55]
  ds_read_b128 v[72:75], v13 offset:16384
  buffer_load_dwordx4 v[240:243], v1, s[36:39], s71 offen offset:0 sc1
  s_waitcnt lgkmcnt(1)
  v_mfma_f32_16x16x32_bf16 v[24:27], v[184:187], v[56:59], v[24:27]
  ds_read_b128 v[76:79], v13 offset:20480
  v_mfma_f32_16x16x32_bf16 v[32:35], v[184:187], v[60:63], v[32:35]
  v_mfma_f32_16x16x32_bf16 v[40:43], v[184:187], v[64:67], v[40:43]
  ds_read_b128 v[80:83], v13 offset:24576
  buffer_load_dwordx4 v[244:247], v1, s[36:39], s71 offen offset:1024 sc1
  s_add_u32 s71, s71, 28672
  v_mfma_f32_16x16x32_bf16 v[48:51], v[184:187], v[68:71], v[48:51]
  ds_read_b128 v[84:87], v13 offset:28672
  v_mfma_f32_16x16x32_bf16 v[28:31], v[188:191], v[56:59], v[28:31]
  v_mfma_f32_16x16x32_bf16 v[36:39], v[188:191], v[60:63], v[36:39]
  v_mfma_f32_16x16x32_bf16 v[44:47], v[188:191], v[64:67], v[44:47]
  v_mfma_f32_16x16x32_bf16 v[52:55], v[188:191], v[68:71], v[52:55]
  ds_read_b128 v[88:91], v14 offset:16384
  buffer_load_dwordx4 v[152:155], v1, s[36:39], s68 offen offset:0 sc1
  s_waitcnt vmcnt(13) lgkmcnt(1)
  v_mfma_f32_16x16x32_bf16 v[24:27], v[192:195], v[72:75], v[24:27]
  ds_read_b128 v[92:95], v14 offset:20480
  v_mfma_f32_16x16x32_bf16 v[32:35], v[192:195], v[76:79], v[32:35]
  v_mfma_f32_16x16x32_bf16 v[40:43], v[192:195], v[80:83], v[40:43]
  ds_read_b128 v[96:99], v14 offset:24576
  buffer_load_dwordx4 v[156:159], v1, s[36:39], s68 offen offset:1024 sc1
  s_add_u32 s68, s68, 28672
  v_mfma_f32_16x16x32_bf16 v[48:51], v[192:195], v[84:87], v[48:51]
  ds_read_b128 v[100:103], v14 offset:28672
  v_mfma_f32_16x16x32_bf16 v[28:31], v[196:199], v[72:75], v[28:31]
  v_mfma_f32_16x16x32_bf16 v[36:39], v[196:199], v[76:79], v[36:39]
  v_mfma_f32_16x16x32_bf16 v[44:47], v[196:199], v[80:83], v[44:47]
  v_mfma_f32_16x16x32_bf16 v[52:55], v[196:199], v[84:87], v[52:55]
  ds_read_b128 v[56:59], v15 offset:16384
  buffer_load_dwordx4 v[128:131], v1, s[36:39], s69 offen offset:0 sc1
  s_waitcnt vmcnt(13) lgkmcnt(1)
  v_mfma_f32_16x16x32_bf16 v[24:27], v[200:203], v[88:91], v[24:27]
  ds_read_b128 v[60:63], v15 offset:20480
  v_mfma_f32_16x16x32_bf16 v[32:35], v[200:203], v[92:95], v[32:35]
  v_mfma_f32_16x16x32_bf16 v[40:43], v[200:203], v[96:99], v[40:43]
  ds_read_b128 v[64:67], v15 offset:24576
  buffer_load_dwordx4 v[132:135], v1, s[36:39], s69 offen offset:1024 sc1
  s_add_u32 s69, s69, 28672
  v_mfma_f32_16x16x32_bf16 v[48:51], v[200:203], v[100:103], v[48:51]
  ds_read_b128 v[68:71], v15 offset:28672
  v_mfma_f32_16x16x32_bf16 v[28:31], v[204:207], v[88:91], v[28:31]
  v_mfma_f32_16x16x32_bf16 v[36:39], v[204:207], v[92:95], v[36:39]
  v_mfma_f32_16x16x32_bf16 v[44:47], v[204:207], v[96:99], v[44:47]
  v_mfma_f32_16x16x32_bf16 v[52:55], v[204:207], v[100:103], v[52:55]
  s_barrier
  ds_read_b128 v[72:75], v12 offset:32768
  buffer_load_dwordx4 v[136:139], v1, s[36:39], s70 offen offset:0 sc1
  s_waitcnt vmcnt(13) lgkmcnt(1)
  v_mfma_f32_16x16x32_bf16 v[24:27], v[208:211], v[56:59], v[24:27]
  ds_read_b128 v[76:79], v12 offset:36864
  v_mfma_f32_16x16x32_bf16 v[32:35], v[208:211], v[60:63], v[32:35]
  v_mfma_f32_16x16x32_bf16 v[40:43], v[208:211], v[64:67], v[40:43]
  ds_read_b128 v[80:83], v12 offset:40960
  buffer_load_dwordx4 v[140:143], v1, s[36:39], s70 offen offset:1024 sc1
  s_add_u32 s70, s70, 28672
  v_mfma_f32_16x16x32_bf16 v[48:51], v[208:211], v[68:71], v[48:51]
  ds_read_b128 v[84:87], v12 offset:45056
  v_mfma_f32_16x16x32_bf16 v[28:31], v[212:215], v[56:59], v[28:31]
  v_mfma_f32_16x16x32_bf16 v[36:39], v[212:215], v[60:63], v[36:39]
  v_mfma_f32_16x16x32_bf16 v[44:47], v[212:215], v[64:67], v[44:47]
  v_mfma_f32_16x16x32_bf16 v[52:55], v[212:215], v[68:71], v[52:55]
  ds_read_b128 v[88:91], v13 offset:32768
  buffer_load_dwordx4 v[144:147], v1, s[36:39], s71 offen offset:0 sc1
  s_waitcnt lgkmcnt(1)
  v_mfma_f32_16x16x32_bf16 v[24:27], v[216:219], v[72:75], v[24:27]
  ds_read_b128 v[92:95], v13 offset:36864
  v_mfma_f32_16x16x32_bf16 v[32:35], v[216:219], v[76:79], v[32:35]
  v_mfma_f32_16x16x32_bf16 v[40:43], v[216:219], v[80:83], v[40:43]
  ds_read_b128 v[96:99], v13 offset:40960
  buffer_load_dwordx4 v[148:151], v1, s[36:39], s71 offen offset:1024 sc1
  s_add_u32 s71, s71, 28672
  v_mfma_f32_16x16x32_bf16 v[48:51], v[216:219], v[84:87], v[48:51]
  ds_read_b128 v[100:103], v13 offset:45056
  v_mfma_f32_16x16x32_bf16 v[28:31], v[220:223], v[72:75], v[28:31]
  v_mfma_f32_16x16x32_bf16 v[36:39], v[220:223], v[76:79], v[36:39]
  v_mfma_f32_16x16x32_bf16 v[44:47], v[220:223], v[80:83], v[44:47]
  v_mfma_f32_16x16x32_bf16 v[52:55], v[220:223], v[84:87], v[52:55]
  ds_read_b128 v[56:59], v14 offset:32768
  buffer_load_dwordx4 v[184:187], v1, s[36:39], s68 offen offset:0 sc1
  s_waitcnt vmcnt(13) lgkmcnt(1)
  v_mfma_f32_16x16x32_bf16 v[24:27], v[224:227], v[88:91], v[24:27]
  ds_read_b128 v[60:63], v14 offset:36864
  v_mfma_f32_16x16x32_bf16 v[32:35], v[224:227], v[92:95], v[32:35]
  v_mfma_f32_16x16x32_bf16 v[40:43], v[224:227], v[96:99], v[40:43]
  ds_read_b128 v[64:67], v14 offset:40960
  buffer_load_dwordx4 v[188:191], v1, s[36:39], s68 offen offset:1024 sc1
  s_add_u32 s68, s68, 28672
  v_mfma_f32_16x16x32_bf16 v[48:51], v[224:227], v[100:103], v[48:51]
  ds_read_b128 v[68:71], v14 offset:45056
  v_mfma_f32_16x16x32_bf16 v[28:31], v[228:231], v[88:91], v[28:31]
  v_mfma_f32_16x16x32_bf16 v[36:39], v[228:231], v[92:95], v[36:39]
  v_mfma_f32_16x16x32_bf16 v[44:47], v[228:231], v[96:99], v[44:47]
  v_mfma_f32_16x16x32_bf16 v[52:55], v[228:231], v[100:103], v[52:55]
  ds_read_b128 v[72:75], v15 offset:32768
  buffer_load_dwordx4 v[160:163], v1, s[36:39], s69 offen offset:0 sc1
  s_waitcnt vmcnt(13) lgkmcnt(1)
  v_mfma_f32_16x16x32_bf16 v[24:27], v[232:235], v[56:59], v[24:27]
  ds_read_b128 v[76:79], v15 offset:36864
  v_mfma_f32_16x16x32_bf16 v[32:35], v[232:235], v[60:63], v[32:35]
  v_mfma_f32_16x16x32_bf16 v[40:43], v[232:235], v[64:67], v[40:43]
  ds_read_b128 v[80:83], v15 offset:40960
  buffer_load_dwordx4 v[164:167], v1, s[36:39], s69 offen offset:1024 sc1
  s_add_u32 s69, s69, 28672
  v_mfma_f32_16x16x32_bf16 v[48:51], v[232:235], v[68:71], v[48:51]
  ds_read_b128 v[84:87], v15 offset:45056
  v_mfma_f32_16x16x32_bf16 v[28:31], v[236:239], v[56:59], v[28:31]
  v_mfma_f32_16x16x32_bf16 v[36:39], v[236:239], v[60:63], v[36:39]
  v_mfma_f32_16x16x32_bf16 v[44:47], v[236:239], v[64:67], v[44:47]
  v_mfma_f32_16x16x32_bf16 v[52:55], v[236:239], v[68:71], v[52:55]
  s_barrier
  ds_read_b128 v[88:91], v12 offset:49152
  buffer_load_dwordx4 v[168:171], v1, s[36:39], s70 offen offset:0 sc1
  s_waitcnt vmcnt(13) lgkmcnt(1)
  v_mfma_f32_16x16x32_bf16 v[24:27], v[240:243], v[72:75], v[24:27]
  ds_read_b128 v[92:95], v12 offset:53248
  v_mfma_f32_16x16x32_bf16 v[32:35], v[240:243], v[76:79], v[32:35]
  v_mfma_f32_16x16x32_bf16 v[40:43], v[240:243], v[80:83], v[40:43]
  ds_read_b128 v[96:99], v12 offset:57344
  buffer_load_dwordx4 v[172:175], v1, s[36:39], s70 offen offset:1024 sc1
  s_add_u32 s70, s70, 28672
  v_mfma_f32_16x16x32_bf16 v[48:51], v[240:243], v[84:87], v[48:51]
  ds_read_b128 v[100:103], v12 offset:61440
  v_mfma_f32_16x16x32_bf16 v[28:31], v[244:247], v[72:75], v[28:31]
  v_mfma_f32_16x16x32_bf16 v[36:39], v[244:247], v[76:79], v[36:39]
  v_mfma_f32_16x16x32_bf16 v[44:47], v[244:247], v[80:83], v[44:47]
  v_mfma_f32_16x16x32_bf16 v[52:55], v[244:247], v[84:87], v[52:55]
  ds_read_b128 v[56:59], v13 offset:49152
  buffer_load_dwordx4 v[176:179], v1, s[36:39], s71 offen offset:0 sc1
  s_waitcnt lgkmcnt(1)
  v_mfma_f32_16x16x32_bf16 v[24:27], v[120:123], v[88:91], v[24:27]
  ds_read_b128 v[60:63], v13 offset:53248
  v_mfma_f32_16x16x32_bf16 v[32:35], v[120:123], v[92:95], v[32:35]
  v_mfma_f32_16x16x32_bf16 v[40:43], v[120:123], v[96:99], v[40:43]
  ds_read_b128 v[64:67], v13 offset:57344
  buffer_load_dwordx4 v[180:183], v1, s[36:39], s71 offen offset:1024 sc1
  s_add_u32 s71, s71, 28672
  v_mfma_f32_16x16x32_bf16 v[48:51], v[120:123], v[100:103], v[48:51]
  ds_read_b128 v[68:71], v13 offset:61440
  v_mfma_f32_16x16x32_bf16 v[28:31], v[124:127], v[88:91], v[28:31]
  v_mfma_f32_16x16x32_bf16 v[36:39], v[124:127], v[92:95], v[36:39]
  v_mfma_f32_16x16x32_bf16 v[44:47], v[124:127], v[96:99], v[44:47]
  v_mfma_f32_16x16x32_bf16 v[52:55], v[124:127], v[100:103], v[52:55]
  ds_read_b128 v[72:75], v14 offset:49152
  buffer_load_dwordx4 v[216:219], v1, s[36:39], s68 offen offset:0 sc1
  s_waitcnt vmcnt(13) lgkmcnt(1)
  v_mfma_f32_16x16x32_bf16 v[24:27], v[128:131], v[56:59], v[24:27]
  ds_read_b128 v[76:79], v14 offset:53248
  v_mfma_f32_16x16x32_bf16 v[32:35], v[128:131], v[60:63], v[32:35]
  v_mfma_f32_16x16x32_bf16 v[40:43], v[128:131], v[64:67], v[40:43]
  ds_read_b128 v[80:83], v14 offset:57344
  buffer_load_dwordx4 v[220:223], v1, s[36:39], s68 offen offset:1024 sc1
  s_add_u32 s68, s68, 28672
  v_mfma_f32_16x16x32_bf16 v[48:51], v[128:131], v[68:71], v[48:51]
  ds_read_b128 v[84:87], v14 offset:61440
  v_mfma_f32_16x16x32_bf16 v[28:31], v[132:135], v[56:59], v[28:31]
  v_mfma_f32_16x16x32_bf16 v[36:39], v[132:135], v[60:63], v[36:39]
  v_mfma_f32_16x16x32_bf16 v[44:47], v[132:135], v[64:67], v[44:47]
  v_mfma_f32_16x16x32_bf16 v[52:55], v[132:135], v[68:71], v[52:55]
  ds_read_b128 v[88:91], v15 offset:49152
  buffer_load_dwordx4 v[192:195], v1, s[36:39], s69 offen offset:0 sc1
  s_waitcnt vmcnt(13) lgkmcnt(1)
  v_mfma_f32_16x16x32_bf16 v[24:27], v[136:139], v[72:75], v[24:27]
  ds_read_b128 v[92:95], v15 offset:53248
  v_mfma_f32_16x16x32_bf16 v[32:35], v[136:139], v[76:79], v[32:35]
  v_mfma_f32_16x16x32_bf16 v[40:43], v[136:139], v[80:83], v[40:43]
  ds_read_b128 v[96:99], v15 offset:57344
  buffer_load_dwordx4 v[196:199], v1, s[36:39], s69 offen offset:1024 sc1
  s_add_u32 s69, s69, 28672
  v_mfma_f32_16x16x32_bf16 v[48:51], v[136:139], v[84:87], v[48:51]
  ds_read_b128 v[100:103], v15 offset:61440
  v_mfma_f32_16x16x32_bf16 v[28:31], v[140:143], v[72:75], v[28:31]
  v_mfma_f32_16x16x32_bf16 v[36:39], v[140:143], v[76:79], v[36:39]
  v_mfma_f32_16x16x32_bf16 v[44:47], v[140:143], v[80:83], v[44:47]
  v_mfma_f32_16x16x32_bf16 v[52:55], v[140:143], v[84:87], v[52:55]
  s_barrier
  ds_read_b128 v[56:59], v8 offset:0
  buffer_load_dwordx4 v[200:203], v1, s[36:39], s70 offen offset:0 sc1
  s_waitcnt vmcnt(13) lgkmcnt(1)
  v_mfma_f32_16x16x32_bf16 v[24:27], v[144:147], v[88:91], v[24:27]
  ds_read_b128 v[60:63], v8 offset:4096
  v_mfma_f32_16x16x32_bf16 v[32:35], v[144:147], v[92:95], v[32:35]
  v_mfma_f32_16x16x32_bf16 v[40:43], v[144:147], v[96:99], v[40:43]
  ds_read_b128 v[64:67], v8 offset:8192
  buffer_load_dwordx4 v[204:207], v1, s[36:39], s70 offen offset:1024 sc1
  s_add_u32 s70, s70, 28672
  v_mfma_f32_16x16x32_bf16 v[48:51], v[144:147], v[100:103], v[48:51]
  ds_read_b128 v[68:71], v8 offset:12288
  v_mfma_f32_16x16x32_bf16 v[28:31], v[148:151], v[88:91], v[28:31]
  v_mfma_f32_16x16x32_bf16 v[36:39], v[148:151], v[92:95], v[36:39]
  v_mfma_f32_16x16x32_bf16 v[44:47], v[148:151], v[96:99], v[44:47]
  v_mfma_f32_16x16x32_bf16 v[52:55], v[148:151], v[100:103], v[52:55]
  ds_read_b128 v[72:75], v9 offset:0
  buffer_load_dwordx4 v[208:211], v1, s[36:39], s71 offen offset:0 sc1
  s_waitcnt lgkmcnt(1)
  v_mfma_f32_16x16x32_bf16 v[24:27], v[152:155], v[56:59], v[24:27]
  ds_read_b128 v[76:79], v9 offset:4096
  v_mfma_f32_16x16x32_bf16 v[32:35], v[152:155], v[60:63], v[32:35]
  v_mfma_f32_16x16x32_bf16 v[40:43], v[152:155], v[64:67], v[40:43]
  ds_read_b128 v[80:83], v9 offset:8192
  buffer_load_dwordx4 v[212:215], v1, s[36:39], s71 offen offset:1024 sc1
  s_add_u32 s71, s71, 28672
  v_mfma_f32_16x16x32_bf16 v[48:51], v[152:155], v[68:71], v[48:51]
  ds_read_b128 v[84:87], v9 offset:12288
  v_mfma_f32_16x16x32_bf16 v[28:31], v[156:159], v[56:59], v[28:31]
  v_mfma_f32_16x16x32_bf16 v[36:39], v[156:159], v[60:63], v[36:39]
  v_mfma_f32_16x16x32_bf16 v[44:47], v[156:159], v[64:67], v[44:47]
  v_mfma_f32_16x16x32_bf16 v[52:55], v[156:159], v[68:71], v[52:55]
  ds_read_b128 v[88:91], v10 offset:0
  buffer_load_dwordx4 v[120:123], v1, s[36:39], s68 offen offset:0 sc1
  s_waitcnt vmcnt(13) lgkmcnt(1)
  v_mfma_f32_16x16x32_bf16 v[24:27], v[160:163], v[72:75], v[24:27]
  ds_read_b128 v[92:95], v10 offset:4096
  v_mfma_f32_16x16x32_bf16 v[32:35], v[160:163], v[76:79], v[32:35]
  v_mfma_f32_16x16x32_bf16 v[40:43], v[160:163], v[80:83], v[40:43]
  ds_read_b128 v[96:99], v10 offset:8192
  buffer_load_dwordx4 v[124:127], v1, s[36:39], s68 offen offset:1024 sc1
  s_add_u32 s68, s68, 28672
  v_mfma_f32_16x16x32_bf16 v[48:51], v[160:163], v[84:87], v[48:51]
  ds_read_b128 v[100:103], v10 offset:12288
  v_mfma_f32_16x16x32_bf16 v[28:31], v[164:167], v[72:75], v[28:31]
  v_mfma_f32_16x16x32_bf16 v[36:39], v[164:167], v[76:79], v[36:39]
  v_mfma_f32_16x16x32_bf16 v[44:47], v[164:167], v[80:83], v[44:47]
  v_mfma_f32_16x16x32_bf16 v[52:55], v[164:167], v[84:87], v[52:55]
  ds_read_b128 v[56:59], v11 offset:0
  buffer_load_dwordx4 v[224:227], v1, s[36:39], s69 offen offset:0 sc1
  s_waitcnt vmcnt(13) lgkmcnt(1)
  v_mfma_f32_16x16x32_bf16 v[24:27], v[168:171], v[88:91], v[24:27]
  ds_read_b128 v[60:63], v11 offset:4096
  v_mfma_f32_16x16x32_bf16 v[32:35], v[168:171], v[92:95], v[32:35]
  v_mfma_f32_16x16x32_bf16 v[40:43], v[168:171], v[96:99], v[40:43]
  ds_read_b128 v[64:67], v11 offset:8192
  buffer_load_dwordx4 v[228:231], v1, s[36:39], s69 offen offset:1024 sc1
  s_add_u32 s69, s69, 28672
  v_mfma_f32_16x16x32_bf16 v[48:51], v[168:171], v[100:103], v[48:51]
  ds_read_b128 v[68:71], v11 offset:12288
  v_mfma_f32_16x16x32_bf16 v[28:31], v[172:175], v[88:91], v[28:31]
  v_mfma_f32_16x16x32_bf16 v[36:39], v[172:175], v[92:95], v[36:39]
  v_mfma_f32_16x16x32_bf16 v[44:47], v[172:175], v[96:99], v[44:47]
  v_mfma_f32_16x16x32_bf16 v[52:55], v[172:175], v[100:103], v[52:55]
  s_barrier
  ds_read_b128 v[72:75], v8 offset:16384
  buffer_load_dwordx4 v[232:235], v1, s[36:39], s70 offen offset:0 sc1
  s_waitcnt vmcnt(13) lgkmcnt(1)
  v_mfma_f32_16x16x32_bf16 v[24:27], v[176:179], v[56:59], v[24:27]
  ds_read_b128 v[76:79], v8 offset:20480
  v_mfma_f32_16x16x32_bf16 v[32:35], v[176:179], v[60:63], v[32:35]
  v_mfma_f32_16x16x32_bf16 v[40:43], v[176:179], v[64:67], v[40:43]
  ds_read_b128 v[80:83], v8 offset:24576
  buffer_load_dwordx4 v[236:239], v1, s[36:39], s70 offen offset:1024 sc1
  s_add_u32 s70, s70, 28672
  v_mfma_f32_16x16x32_bf16 v[48:51], v[176:179], v[68:71], v[48:51]
  ds_read_b128 v[84:87], v8 offset:28672
  v_mfma_f32_16x16x32_bf16 v[28:31], v[180:183], v[56:59], v[28:31]
  v_mfma_f32_16x16x32_bf16 v[36:39], v[180:183], v[60:63], v[36:39]
  v_mfma_f32_16x16x32_bf16 v[44:47], v[180:183], v[64:67], v[44:47]
  v_mfma_f32_16x16x32_bf16 v[52:55], v[180:183], v[68:71], v[52:55]
  ds_read_b128 v[88:91], v9 offset:16384
  buffer_load_dwordx4 v[240:243], v1, s[36:39], s71 offen offset:0 sc1
  s_waitcnt lgkmcnt(1)
  v_mfma_f32_16x16x32_bf16 v[24:27], v[184:187], v[72:75], v[24:27]
  ds_read_b128 v[92:95], v9 offset:20480
  v_mfma_f32_16x16x32_bf16 v[32:35], v[184:187], v[76:79], v[32:35]
  v_mfma_f32_16x16x32_bf16 v[40:43], v[184:187], v[80:83], v[40:43]
  ds_read_b128 v[96:99], v9 offset:24576
  buffer_load_dwordx4 v[244:247], v1, s[36:39], s71 offen offset:1024 sc1
  s_add_u32 s71, s71, 28672
  v_mfma_f32_16x16x32_bf16 v[48:51], v[184:187], v[84:87], v[48:51]
  ds_read_b128 v[100:103], v9 offset:28672
  v_mfma_f32_16x16x32_bf16 v[28:31], v[188:191], v[72:75], v[28:31]
  v_mfma_f32_16x16x32_bf16 v[36:39], v[188:191], v[76:79], v[36:39]
  v_mfma_f32_16x16x32_bf16 v[44:47], v[188:191], v[80:83], v[44:47]
  v_mfma_f32_16x16x32_bf16 v[52:55], v[188:191], v[84:87], v[52:55]
  ds_read_b128 v[56:59], v10 offset:16384
  buffer_load_dwordx4 v[152:155], v1, s[36:39], s68 offen offset:0 sc1
  s_waitcnt vmcnt(13) lgkmcnt(1)
  v_mfma_f32_16x16x32_bf16 v[24:27], v[192:195], v[88:91], v[24:27]
  ds_read_b128 v[60:63], v10 offset:20480
  v_mfma_f32_16x16x32_bf16 v[32:35], v[192:195], v[92:95], v[32:35]
  v_mfma_f32_16x16x32_bf16 v[40:43], v[192:195], v[96:99], v[40:43]
  ds_read_b128 v[64:67], v10 offset:24576
  buffer_load_dwordx4 v[156:159], v1, s[36:39], s68 offen offset:1024 sc1
  s_add_u32 s68, s68, 28672
  v_mfma_f32_16x16x32_bf16 v[48:51], v[192:195], v[100:103], v[48:51]
  ds_read_b128 v[68:71], v10 offset:28672
  v_mfma_f32_16x16x32_bf16 v[28:31], v[196:199], v[88:91], v[28:31]
  v_mfma_f32_16x16x32_bf16 v[36:39], v[196:199], v[92:95], v[36:39]
  v_mfma_f32_16x16x32_bf16 v[44:47], v[196:199], v[96:99], v[44:47]
  v_mfma_f32_16x16x32_bf16 v[52:55], v[196:199], v[100:103], v[52:55]
  ds_read_b128 v[72:75], v11 offset:16384
  buffer_load_dwordx4 v[128:131], v1, s[36:39], s69 offen offset:0 sc1
  s_waitcnt vmcnt(13) lgkmcnt(1)
  v_mfma_f32_16x16x32_bf16 v[24:27], v[200:203], v[56:59], v[24:27]
  ds_read_b128 v[76:79], v11 offset:20480
  v_mfma_f32_16x16x32_bf16 v[32:35], v[200:203], v[60:63], v[32:35]
  v_mfma_f32_16x16x32_bf16 v[40:43], v[200:203], v[64:67], v[40:43]
  ds_read_b128 v[80:83], v11 offset:24576
  buffer_load_dwordx4 v[132:135], v1, s[36:39], s69 offen offset:1024 sc1
  s_add_u32 s69, s69, 28672
  v_mfma_f32_16x16x32_bf16 v[48:51], v[200:203], v[68:71], v[48:51]
  ds_read_b128 v[84:87], v11 offset:28672
  v_mfma_f32_16x16x32_bf16 v[28:31], v[204:207], v[56:59], v[28:31]
  v_mfma_f32_16x16x32_bf16 v[36:39], v[204:207], v[60:63], v[36:39]
  v_mfma_f32_16x16x32_bf16 v[44:47], v[204:207], v[64:67], v[44:47]
  v_mfma_f32_16x16x32_bf16 v[52:55], v[204:207], v[68:71], v[52:55]
  s_barrier
  ds_read_b128 v[88:91], v8 offset:32768
  buffer_load_dwordx4 v[136:139], v1, s[36:39], s70 offen offset:0 sc1
  s_waitcnt vmcnt(13) lgkmcnt(1)
  v_mfma_f32_16x16x32_bf16 v[24:27], v[208:211], v[72:75], v[24:27]
  ds_read_b128 v[92:95], v8 offset:36864
  v_mfma_f32_16x16x32_bf16 v[32:35], v[208:211], v[76:79], v[32:35]
  v_mfma_f32_16x16x32_bf16 v[40:43], v[208:211], v[80:83], v[40:43]
  ds_read_b128 v[96:99], v8 offset:40960
  buffer_load_dwordx4 v[140:143], v1, s[36:39], s70 offen offset:1024 sc1
  s_add_u32 s70, s70, 28672
  v_mfma_f32_16x16x32_bf16 v[48:51], v[208:211], v[84:87], v[48:51]
  ds_read_b128 v[100:103], v8 offset:45056
  v_mfma_f32_16x16x32_bf16 v[28:31], v[212:215], v[72:75], v[28:31]
  v_mfma_f32_16x16x32_bf16 v[36:39], v[212:215], v[76:79], v[36:39]
  v_mfma_f32_16x16x32_bf16 v[44:47], v[212:215], v[80:83], v[44:47]
  v_mfma_f32_16x16x32_bf16 v[52:55], v[212:215], v[84:87], v[52:55]
  ds_read_b128 v[56:59], v9 offset:32768
  buffer_load_dwordx4 v[144:147], v1, s[36:39], s71 offen offset:0 sc1
  s_waitcnt lgkmcnt(1)
  v_mfma_f32_16x16x32_bf16 v[24:27], v[216:219], v[88:91], v[24:27]
  ds_read_b128 v[60:63], v9 offset:36864
  v_mfma_f32_16x16x32_bf16 v[32:35], v[216:219], v[92:95], v[32:35]
  v_mfma_f32_16x16x32_bf16 v[40:43], v[216:219], v[96:99], v[40:43]
  ds_read_b128 v[64:67], v9 offset:40960
  buffer_load_dwordx4 v[148:151], v1, s[36:39], s71 offen offset:1024 sc1
  s_add_u32 s71, s71, 28672
  v_mfma_f32_16x16x32_bf16 v[48:51], v[216:219], v[100:103], v[48:51]
  ds_read_b128 v[68:71], v9 offset:45056
  v_mfma_f32_16x16x32_bf16 v[28:31], v[220:223], v[88:91], v[28:31]
  v_mfma_f32_16x16x32_bf16 v[36:39], v[220:223], v[92:95], v[36:39]
  v_mfma_f32_16x16x32_bf16 v[44:47], v[220:223], v[96:99], v[44:47]
  v_mfma_f32_16x16x32_bf16 v[52:55], v[220:223], v[100:103], v[52:55]
  ds_read_b128 v[72:75], v10 offset:32768
  buffer_load_dwordx4 v[184:187], v1, s[36:39], s68 offen offset:0 sc1
  s_waitcnt vmcnt(13) lgkmcnt(1)
  v_mfma_f32_16x16x32_bf16 v[24:27], v[224:227], v[56:59], v[24:27]
  ds_read_b128 v[76:79], v10 offset:36864
  v_mfma_f32_16x16x32_bf16 v[32:35], v[224:227], v[60:63], v[32:35]
  v_mfma_f32_16x16x32_bf16 v[40:43], v[224:227], v[64:67], v[40:43]
  ds_read_b128 v[80:83], v10 offset:40960
  buffer_load_dwordx4 v[188:191], v1, s[36:39], s68 offen offset:1024 sc1
  s_add_u32 s68, s68, 28672
  v_mfma_f32_16x16x32_bf16 v[48:51], v[224:227], v[68:71], v[48:51]
  ds_read_b128 v[84:87], v10 offset:45056
  v_mfma_f32_16x16x32_bf16 v[28:31], v[228:231], v[56:59], v[28:31]
  v_mfma_f32_16x16x32_bf16 v[36:39], v[228:231], v[60:63], v[36:39]
  v_mfma_f32_16x16x32_bf16 v[44:47], v[228:231], v[64:67], v[44:47]
  v_mfma_f32_16x16x32_bf16 v[52:55], v[228:231], v[68:71], v[52:55]
  ds_read_b128 v[88:91], v11 offset:32768
  buffer_load_dwordx4 v[160:163], v1, s[36:39], s69 offen offset:0 sc1
  s_waitcnt vmcnt(13) lgkmcnt(1)
  v_mfma_f32_16x16x32_bf16 v[24:27], v[232:235], v[72:75], v[24:27]
  ds_read_b128 v[92:95], v11 offset:36864
  v_mfma_f32_16x16x32_bf16 v[32:35], v[232:235], v[76:79], v[32:35]
  v_mfma_f32_16x16x32_bf16 v[40:43], v[232:235], v[80:83], v[40:43]
  ds_read_b128 v[96:99], v11 offset:40960
  buffer_load_dwordx4 v[164:167], v1, s[36:39], s69 offen offset:1024 sc1
  s_add_u32 s69, s69, 28672
  v_mfma_f32_16x16x32_bf16 v[48:51], v[232:235], v[84:87], v[48:51]
  ds_read_b128 v[100:103], v11 offset:45056
  v_mfma_f32_16x16x32_bf16 v[28:31], v[236:239], v[72:75], v[28:31]
  v_mfma_f32_16x16x32_bf16 v[36:39], v[236:239], v[76:79], v[36:39]
  v_mfma_f32_16x16x32_bf16 v[44:47], v[236:239], v[80:83], v[44:47]
  v_mfma_f32_16x16x32_bf16 v[52:55], v[236:239], v[84:87], v[52:55]
  s_barrier
  ds_read_b128 v[56:59], v8 offset:49152
  buffer_load_dwordx4 v[168:171], v1, s[36:39], s70 offen offset:0 sc1
  s_waitcnt vmcnt(13) lgkmcnt(1)
  v_mfma_f32_16x16x32_bf16 v[24:27], v[240:243], v[88:91], v[24:27]
  ds_read_b128 v[60:63], v8 offset:53248
  v_mfma_f32_16x16x32_bf16 v[32:35], v[240:243], v[92:95], v[32:35]
  v_mfma_f32_16x16x32_bf16 v[40:43], v[240:243], v[96:99], v[40:43]
  ds_read_b128 v[64:67], v8 offset:57344
  buffer_load_dwordx4 v[172:175], v1, s[36:39], s70 offen offset:1024 sc1
  s_add_u32 s70, s70, 28672
  v_mfma_f32_16x16x32_bf16 v[48:51], v[240:243], v[100:103], v[48:51]
  ds_read_b128 v[68:71], v8 offset:61440
  v_mfma_f32_16x16x32_bf16 v[28:31], v[244:247], v[88:91], v[28:31]
  v_mfma_f32_16x16x32_bf16 v[36:39], v[244:247], v[92:95], v[36:39]
  v_mfma_f32_16x16x32_bf16 v[44:47], v[244:247], v[96:99], v[44:47]
  v_mfma_f32_16x16x32_bf16 v[52:55], v[244:247], v[100:103], v[52:55]
  ds_read_b128 v[72:75], v9 offset:49152
  buffer_load_dwordx4 v[176:179], v1, s[36:39], s71 offen offset:0 sc1
  s_waitcnt lgkmcnt(1)
  v_mfma_f32_16x16x32_bf16 v[24:27], v[120:123], v[56:59], v[24:27]
  ds_read_b128 v[76:79], v9 offset:53248
  v_mfma_f32_16x16x32_bf16 v[32:35], v[120:123], v[60:63], v[32:35]
  v_mfma_f32_16x16x32_bf16 v[40:43], v[120:123], v[64:67], v[40:43]
  ds_read_b128 v[80:83], v9 offset:57344
  buffer_load_dwordx4 v[180:183], v1, s[36:39], s71 offen offset:1024 sc1
  s_add_u32 s71, s71, 28672
  v_mfma_f32_16x16x32_bf16 v[48:51], v[120:123], v[68:71], v[48:51]
  ds_read_b128 v[84:87], v9 offset:61440
  v_mfma_f32_16x16x32_bf16 v[28:31], v[124:127], v[56:59], v[28:31]
  v_mfma_f32_16x16x32_bf16 v[36:39], v[124:127], v[60:63], v[36:39]
  v_mfma_f32_16x16x32_bf16 v[44:47], v[124:127], v[64:67], v[44:47]
  v_mfma_f32_16x16x32_bf16 v[52:55], v[124:127], v[68:71], v[52:55]
  ds_read_b128 v[88:91], v10 offset:49152
  buffer_load_dwordx4 v[216:219], v1, s[36:39], s68 offen offset:0 sc1
  s_waitcnt vmcnt(13) lgkmcnt(1)
  v_mfma_f32_16x16x32_bf16 v[24:27], v[128:131], v[72:75], v[24:27]
  ds_read_b128 v[92:95], v10 offset:53248
  v_mfma_f32_16x16x32_bf16 v[32:35], v[128:131], v[76:79], v[32:35]
  v_mfma_f32_16x16x32_bf16 v[40:43], v[128:131], v[80:83], v[40:43]
  ds_read_b128 v[96:99], v10 offset:57344
  buffer_load_dwordx4 v[220:223], v1, s[36:39], s68 offen offset:1024 sc1
  s_add_u32 s68, s68, 28672
  v_mfma_f32_16x16x32_bf16 v[48:51], v[128:131], v[84:87], v[48:51]
  ds_read_b128 v[100:103], v10 offset:61440
  v_mfma_f32_16x16x32_bf16 v[28:31], v[132:135], v[72:75], v[28:31]
  v_mfma_f32_16x16x32_bf16 v[36:39], v[132:135], v[76:79], v[36:39]
  v_mfma_f32_16x16x32_bf16 v[44:47], v[132:135], v[80:83], v[44:47]
  v_mfma_f32_16x16x32_bf16 v[52:55], v[132:135], v[84:87], v[52:55]
  ds_read_b128 v[56:59], v11 offset:49152
  buffer_load_dwordx4 v[192:195], v1, s[36:39], s69 offen offset:0 sc1
  s_waitcnt vmcnt(13) lgkmcnt(1)
  v_mfma_f32_16x16x32_bf16 v[24:27], v[136:139], v[88:91], v[24:27]
  ds_read_b128 v[60:63], v11 offset:53248
  v_mfma_f32_16x16x32_bf16 v[32:35], v[136:139], v[92:95], v[32:35]
  v_mfma_f32_16x16x32_bf16 v[40:43], v[136:139], v[96:99], v[40:43]
  ds_read_b128 v[64:67], v11 offset:57344
  buffer_load_dwordx4 v[196:199], v1, s[36:39], s69 offen offset:1024 sc1
  s_add_u32 s69, s69, 28672
  v_mfma_f32_16x16x32_bf16 v[48:51], v[136:139], v[100:103], v[48:51]
  ds_read_b128 v[68:71], v11 offset:61440
  v_mfma_f32_16x16x32_bf16 v[28:31], v[140:143], v[88:91], v[28:31]
  v_mfma_f32_16x16x32_bf16 v[36:39], v[140:143], v[92:95], v[36:39]
  v_mfma_f32_16x16x32_bf16 v[44:47], v[140:143], v[96:99], v[44:47]
  v_mfma_f32_16x16x32_bf16 v[52:55], v[140:143], v[100:103], v[52:55]
  s_barrier
  ds_read_b128 v[72:75], v16 offset:0
  buffer_load_dwordx4 v[200:203], v1, s[36:39], s70 offen offset:0 sc1
  s_waitcnt vmcnt(13) lgkmcnt(1)
  v_mfma_f32_16x16x32_bf16 v[24:27], v[144:147], v[56:59], v[24:27]
  ds_read_b128 v[76:79], v16 offset:4096
  v_mfma_f32_16x16x32_bf16 v[32:35], v[144:147], v[60:63], v[32:35]
  v_mfma_f32_16x16x32_bf16 v[40:43], v[144:147], v[64:67], v[40:43]
  ds_read_b128 v[80:83], v16 offset:8192
  buffer_load_dwordx4 v[204:207], v1, s[36:39], s70 offen offset:1024 sc1
  s_add_u32 s70, s70, 28672
  v_mfma_f32_16x16x32_bf16 v[48:51], v[144:147], v[68:71], v[48:51]
  ds_read_b128 v[84:87], v16 offset:12288
  v_mfma_f32_16x16x32_bf16 v[28:31], v[148:151], v[56:59], v[28:31]
  v_mfma_f32_16x16x32_bf16 v[36:39], v[148:151], v[60:63], v[36:39]
  v_mfma_f32_16x16x32_bf16 v[44:47], v[148:151], v[64:67], v[44:47]
  v_mfma_f32_16x16x32_bf16 v[52:55], v[148:151], v[68:71], v[52:55]
  ds_read_b128 v[88:91], v17 offset:0
  buffer_load_dwordx4 v[208:211], v1, s[36:39], s71 offen offset:0 sc1
  s_waitcnt lgkmcnt(1)
  v_mfma_f32_16x16x32_bf16 v[24:27], v[152:155], v[72:75], v[24:27]
  ds_read_b128 v[92:95], v17 offset:4096
  v_mfma_f32_16x16x32_bf16 v[32:35], v[152:155], v[76:79], v[32:35]
  v_mfma_f32_16x16x32_bf16 v[40:43], v[152:155], v[80:83], v[40:43]
  ds_read_b128 v[96:99], v17 offset:8192
  buffer_load_dwordx4 v[212:215], v1, s[36:39], s71 offen offset:1024 sc1
  s_add_u32 s71, s71, 28672
  v_mfma_f32_16x16x32_bf16 v[48:51], v[152:155], v[84:87], v[48:51]
  ds_read_b128 v[100:103], v17 offset:12288
  v_mfma_f32_16x16x32_bf16 v[28:31], v[156:159], v[72:75], v[28:31]
  v_mfma_f32_16x16x32_bf16 v[36:39], v[156:159], v[76:79], v[36:39]
  v_mfma_f32_16x16x32_bf16 v[44:47], v[156:159], v[80:83], v[44:47]
  v_mfma_f32_16x16x32_bf16 v[52:55], v[156:159], v[84:87], v[52:55]
  ds_read_b128 v[56:59], v18 offset:0
  s_waitcnt vmcnt(12) lgkmcnt(1)
  v_mfma_f32_16x16x32_bf16 v[24:27], v[160:163], v[88:91], v[24:27]
  ds_read_b128 v[60:63], v18 offset:4096
  v_mfma_f32_16x16x32_bf16 v[32:35], v[160:163], v[92:95], v[32:35]
  v_mfma_f32_16x16x32_bf16 v[40:43], v[160:163], v[96:99], v[40:43]
  ds_read_b128 v[64:67], v18 offset:8192
  v_mfma_f32_16x16x32_bf16 v[48:51], v[160:163], v[100:103], v[48:51]
  ds_read_b128 v[68:71], v18 offset:12288
  v_mfma_f32_16x16x32_bf16 v[28:31], v[164:167], v[88:91], v[28:31]
  v_mfma_f32_16x16x32_bf16 v[36:39], v[164:167], v[92:95], v[36:39]
  v_mfma_f32_16x16x32_bf16 v[44:47], v[164:167], v[96:99], v[44:47]
  v_mfma_f32_16x16x32_bf16 v[52:55], v[164:167], v[100:103], v[52:55]
  ds_read_b128 v[72:75], v19 offset:0
  buffer_load_dwordx4 v[224:227], v1, s[36:39], s69 offen offset:0 sc1
  s_waitcnt vmcnt(11) lgkmcnt(1)
  v_mfma_f32_16x16x32_bf16 v[24:27], v[168:171], v[56:59], v[24:27]
  ds_read_b128 v[76:79], v19 offset:4096
  v_mfma_f32_16x16x32_bf16 v[32:35], v[168:171], v[60:63], v[32:35]
  v_mfma_f32_16x16x32_bf16 v[40:43], v[168:171], v[64:67], v[40:43]
  ds_read_b128 v[80:83], v19 offset:8192
  buffer_load_dwordx4 v[228:231], v1, s[36:39], s69 offen offset:1024 sc1
  s_add_u32 s69, s69, 28672
  v_mfma_f32_16x16x32_bf16 v[48:51], v[168:171], v[68:71], v[48:51]
  ds_read_b128 v[84:87], v19 offset:12288
  v_mfma_f32_16x16x32_bf16 v[28:31], v[172:175], v[56:59], v[28:31]
  v_mfma_f32_16x16x32_bf16 v[36:39], v[172:175], v[60:63], v[36:39]
  v_mfma_f32_16x16x32_bf16 v[44:47], v[172:175], v[64:67], v[44:47]
  v_mfma_f32_16x16x32_bf16 v[52:55], v[172:175], v[68:71], v[52:55]
  s_barrier
  ds_read_b128 v[88:91], v12 offset:0
  buffer_load_dwordx4 v[232:235], v1, s[36:39], s70 offen offset:0 sc1
  s_waitcnt vmcnt(11) lgkmcnt(1)
  v_mfma_f32_16x16x32_bf16 v[24:27], v[176:179], v[72:75], v[24:27]
  ds_read_b128 v[92:95], v12 offset:4096
  v_mfma_f32_16x16x32_bf16 v[32:35], v[176:179], v[76:79], v[32:35]
  buffer_load_dwordx4 v[236:239], v1, s[36:39], s70 offen offset:1024 sc1
  s_add_u32 s70, s70, 28672
  v_mfma_f32_16x16x32_bf16 v[40:43], v[176:179], v[80:83], v[40:43]
  ds_read_b128 v[96:99], v12 offset:8192
  v_mfma_f32_16x16x32_bf16 v[48:51], v[176:179], v[84:87], v[48:51]
  ds_read_b128 v[100:103], v12 offset:12288
  buffer_load_dwordx4 v[104:107], v1, s[36:39], s64 offen sc1
  v_mfma_f32_16x16x32_bf16 v[28:31], v[180:183], v[72:75], v[28:31]
  v_mfma_f32_16x16x32_bf16 v[36:39], v[180:183], v[76:79], v[36:39]
  v_mfma_f32_16x16x32_bf16 v[44:47], v[180:183], v[80:83], v[44:47]
  v_mfma_f32_16x16x32_bf16 v[52:55], v[180:183], v[84:87], v[52:55]
  ds_read_b128 v[56:59], v13 offset:0
  buffer_load_dwordx4 v[240:243], v1, s[36:39], s71 offen offset:0 sc1
  s_waitcnt lgkmcnt(1)
  v_mfma_f32_16x16x32_bf16 v[24:27], v[184:187], v[88:91], v[24:27]
  ds_read_b128 v[60:63], v13 offset:4096
  v_mfma_f32_16x16x32_bf16 v[32:35], v[184:187], v[92:95], v[32:35]
  buffer_load_dwordx4 v[244:247], v1, s[36:39], s71 offen offset:1024 sc1
  s_add_u32 s71, s71, 28672
  v_mfma_f32_16x16x32_bf16 v[40:43], v[184:187], v[96:99], v[40:43]
  ds_read_b128 v[64:67], v13 offset:8192
  v_mfma_f32_16x16x32_bf16 v[48:51], v[184:187], v[100:103], v[48:51]
  ds_read_b128 v[68:71], v13 offset:12288
  buffer_load_dwordx4 v[108:111], v1, s[36:39], s65 offen sc1
  v_mfma_f32_16x16x32_bf16 v[28:31], v[188:191], v[88:91], v[28:31]
  v_mfma_f32_16x16x32_bf16 v[36:39], v[188:191], v[92:95], v[36:39]
  v_mfma_f32_16x16x32_bf16 v[44:47], v[188:191], v[96:99], v[44:47]
  v_mfma_f32_16x16x32_bf16 v[52:55], v[188:191], v[100:103], v[52:55]
  ds_read_b128 v[72:75], v14 offset:0
  s_waitcnt vmcnt(12) lgkmcnt(1)
  v_mfma_f32_16x16x32_bf16 v[24:27], v[192:195], v[56:59], v[24:27]
  ds_read_b128 v[76:79], v14 offset:4096
  v_mfma_f32_16x16x32_bf16 v[32:35], v[192:195], v[60:63], v[32:35]
  v_mfma_f32_16x16x32_bf16 v[40:43], v[192:195], v[64:67], v[40:43]
  ds_read_b128 v[80:83], v14 offset:8192
  v_mfma_f32_16x16x32_bf16 v[48:51], v[192:195], v[68:71], v[48:51]
  ds_read_b128 v[84:87], v14 offset:12288
  buffer_load_dwordx4 v[112:115], v1, s[36:39], s66 offen sc1
  v_mfma_f32_16x16x32_bf16 v[28:31], v[196:199], v[56:59], v[28:31]
  v_mfma_f32_16x16x32_bf16 v[36:39], v[196:199], v[60:63], v[36:39]
  v_mfma_f32_16x16x32_bf16 v[44:47], v[196:199], v[64:67], v[44:47]
  v_mfma_f32_16x16x32_bf16 v[52:55], v[196:199], v[68:71], v[52:55]
  ds_read_b128 v[88:91], v15 offset:0
  s_waitcnt vmcnt(11) lgkmcnt(1)
  v_mfma_f32_16x16x32_bf16 v[24:27], v[200:203], v[72:75], v[24:27]
  ds_read_b128 v[92:95], v15 offset:4096
  v_mfma_f32_16x16x32_bf16 v[32:35], v[200:203], v[76:79], v[32:35]
  v_mfma_f32_16x16x32_bf16 v[40:43], v[200:203], v[80:83], v[40:43]
  ds_read_b128 v[96:99], v15 offset:8192
  v_mfma_f32_16x16x32_bf16 v[48:51], v[200:203], v[84:87], v[48:51]
  ds_read_b128 v[100:103], v15 offset:12288
  buffer_load_dwordx4 v[116:119], v1, s[36:39], s67 offen sc1
  v_mfma_f32_16x16x32_bf16 v[28:31], v[204:207], v[72:75], v[28:31]
  v_mfma_f32_16x16x32_bf16 v[36:39], v[204:207], v[76:79], v[36:39]
  v_mfma_f32_16x16x32_bf16 v[44:47], v[204:207], v[80:83], v[44:47]
  v_mfma_f32_16x16x32_bf16 v[52:55], v[204:207], v[84:87], v[52:55]
  s_barrier
  ds_read_b128 v[56:59], v12 offset:16384
  s_waitcnt vmcnt(10) lgkmcnt(1)
  v_mfma_f32_16x16x32_bf16 v[24:27], v[208:211], v[88:91], v[24:27]
  ds_read_b128 v[60:63], v12 offset:20480
  v_mfma_f32_16x16x32_bf16 v[32:35], v[208:211], v[92:95], v[32:35]
  v_mfma_f32_16x16x32_bf16 v[40:43], v[208:211], v[96:99], v[40:43]
  ds_read_b128 v[64:67], v12 offset:24576
  v_mfma_f32_16x16x32_bf16 v[48:51], v[208:211], v[100:103], v[48:51]
  ds_read_b128 v[68:71], v12 offset:28672
  v_mfma_f32_16x16x32_bf16 v[28:31], v[212:215], v[88:91], v[28:31]
  v_mfma_f32_16x16x32_bf16 v[36:39], v[212:215], v[92:95], v[36:39]
  v_mfma_f32_16x16x32_bf16 v[44:47], v[212:215], v[96:99], v[44:47]
  v_mfma_f32_16x16x32_bf16 v[52:55], v[212:215], v[100:103], v[52:55]
  ds_read_b128 v[72:75], v13 offset:16384
  s_waitcnt lgkmcnt(1)
  v_mfma_f32_16x16x32_bf16 v[24:27], v[216:219], v[56:59], v[24:27]
  ds_read_b128 v[76:79], v13 offset:20480
  v_mfma_f32_16x16x32_bf16 v[32:35], v[216:219], v[60:63], v[32:35]
  v_mfma_f32_16x16x32_bf16 v[40:43], v[216:219], v[64:67], v[40:43]
  ds_read_b128 v[80:83], v13 offset:24576
  v_mfma_f32_16x16x32_bf16 v[48:51], v[216:219], v[68:71], v[48:51]
  ds_read_b128 v[84:87], v13 offset:28672
  v_mfma_f32_16x16x32_bf16 v[28:31], v[220:223], v[56:59], v[28:31]
  v_mfma_f32_16x16x32_bf16 v[36:39], v[220:223], v[60:63], v[36:39]
  v_mfma_f32_16x16x32_bf16 v[44:47], v[220:223], v[64:67], v[44:47]
  v_mfma_f32_16x16x32_bf16 v[52:55], v[220:223], v[68:71], v[52:55]
  ds_read_b128 v[88:91], v14 offset:16384
  s_waitcnt vmcnt(8) lgkmcnt(1)
  v_mfma_f32_16x16x32_bf16 v[24:27], v[224:227], v[72:75], v[24:27]
  ds_read_b128 v[92:95], v14 offset:20480
  v_mfma_f32_16x16x32_bf16 v[32:35], v[224:227], v[76:79], v[32:35]
  v_mfma_f32_16x16x32_bf16 v[40:43], v[224:227], v[80:83], v[40:43]
  ds_read_b128 v[96:99], v14 offset:24576
  v_mfma_f32_16x16x32_bf16 v[48:51], v[224:227], v[84:87], v[48:51]
  ds_read_b128 v[100:103], v14 offset:28672
  v_mfma_f32_16x16x32_bf16 v[28:31], v[228:231], v[72:75], v[28:31]
  v_mfma_f32_16x16x32_bf16 v[36:39], v[228:231], v[76:79], v[36:39]
  v_mfma_f32_16x16x32_bf16 v[44:47], v[228:231], v[80:83], v[44:47]
  v_mfma_f32_16x16x32_bf16 v[52:55], v[228:231], v[84:87], v[52:55]
  ds_read_b128 v[56:59], v15 offset:16384
  s_waitcnt vmcnt(6) lgkmcnt(1)
  v_mfma_f32_16x16x32_bf16 v[24:27], v[232:235], v[88:91], v[24:27]
  ds_read_b128 v[60:63], v15 offset:20480
  v_mfma_f32_16x16x32_bf16 v[32:35], v[232:235], v[92:95], v[32:35]
  v_mfma_f32_16x16x32_bf16 v[40:43], v[232:235], v[96:99], v[40:43]
  ds_read_b128 v[64:67], v15 offset:24576
  v_mfma_f32_16x16x32_bf16 v[48:51], v[232:235], v[100:103], v[48:51]
  ds_read_b128 v[68:71], v15 offset:28672
  v_mfma_f32_16x16x32_bf16 v[28:31], v[236:239], v[88:91], v[28:31]
  v_mfma_f32_16x16x32_bf16 v[36:39], v[236:239], v[92:95], v[36:39]
  v_mfma_f32_16x16x32_bf16 v[44:47], v[236:239], v[96:99], v[44:47]
  v_mfma_f32_16x16x32_bf16 v[52:55], v[236:239], v[100:103], v[52:55]
  s_waitcnt vmcnt(3) lgkmcnt(0)
  v_mfma_f32_16x16x32_bf16 v[24:27], v[240:243], v[56:59], v[24:27]
  s_barrier
  v_mfma_f32_16x16x32_bf16 v[32:35], v[240:243], v[60:63], v[32:35]
  v_mfma_f32_16x16x32_bf16 v[40:43], v[240:243], v[64:67], v[40:43]
  v_mfma_f32_16x16x32_bf16 v[48:51], v[240:243], v[68:71], v[48:51]
  v_mfma_f32_16x16x32_bf16 v[28:31], v[244:247], v[56:59], v[28:31]
  v_mfma_f32_16x16x32_bf16 v[36:39], v[244:247], v[60:63], v[36:39]
  v_mfma_f32_16x16x32_bf16 v[44:47], v[244:247], v[64:67], v[44:47]
  v_mfma_f32_16x16x32_bf16 v[52:55], v[244:247], v[68:71], v[52:55]
  s_waitcnt vmcnt(0)
  v_lshlrev_b32 v120, 16, v104
  v_and_b32 v121, 0xffff0000, v104
  v_lshlrev_b32 v122, 16, v105
  v_and_b32 v123, 0xffff0000, v105
  v_lshlrev_b32 v124, 16, v106
  v_and_b32 v125, 0xffff0000, v106
  v_lshlrev_b32 v126, 16, v107
  v_and_b32 v127, 0xffff0000, v107
  v_lshlrev_b32 v128, 16, v108
  v_and_b32 v129, 0xffff0000, v108
  v_lshlrev_b32 v130, 16, v109
  v_and_b32 v131, 0xffff0000, v109
  v_lshlrev_b32 v132, 16, v110
  v_and_b32 v133, 0xffff0000, v110
  v_lshlrev_b32 v134, 16, v111
  v_and_b32 v135, 0xffff0000, v111
  v_lshlrev_b32 v136, 16, v112
  v_and_b32 v137, 0xffff0000, v112
  v_lshlrev_b32 v138, 16, v113
  v_and_b32 v139, 0xffff0000, v113
  v_lshlrev_b32 v140, 16, v114
  v_and_b32 v141, 0xffff0000, v114
  v_lshlrev_b32 v142, 16, v115
  v_and_b32 v143, 0xffff0000, v115
  v_lshlrev_b32 v144, 16, v116
  v_and_b32 v145, 0xffff0000, v116
  v_lshlrev_b32 v146, 16, v117
  v_and_b32 v147, 0xffff0000, v117
  v_lshlrev_b32 v148, 16, v118
  v_and_b32 v149, 0xffff0000, v118
  v_lshlrev_b32 v150, 16, v119
  v_and_b32 v151, 0xffff0000, v119
  v_pk_mul_f32 v[24:25], v[24:25], v[120:121]
  v_pk_mul_f32 v[26:27], v[26:27], v[122:123]
  v_pk_mul_f32 v[28:29], v[28:29], v[124:125]
  v_pk_mul_f32 v[30:31], v[30:31], v[126:127]
  v_cvt_pk_bf16_f32 v56, v24, v25
  v_cvt_pk_bf16_f32 v57, v26, v27
  v_cvt_pk_bf16_f32 v58, v28, v29
  v_cvt_pk_bf16_f32 v59, v30, v31
  buffer_store_dwordx4 v[56:59], v1, s[36:39], s64 offen sc1
  v_pk_mul_f32 v[32:33], v[32:33], v[128:129]
  v_pk_mul_f32 v[34:35], v[34:35], v[130:131]
  v_pk_mul_f32 v[36:37], v[36:37], v[132:133]
  v_pk_mul_f32 v[38:39], v[38:39], v[134:135]
  v_cvt_pk_bf16_f32 v60, v32, v33
  v_cvt_pk_bf16_f32 v61, v34, v35
  v_cvt_pk_bf16_f32 v62, v36, v37
  v_cvt_pk_bf16_f32 v63, v38, v39
  buffer_store_dwordx4 v[60:63], v1, s[36:39], s65 offen sc1
  v_pk_mul_f32 v[40:41], v[40:41], v[136:137]
  v_pk_mul_f32 v[42:43], v[42:43], v[138:139]
  v_pk_mul_f32 v[44:45], v[44:45], v[140:141]
  v_pk_mul_f32 v[46:47], v[46:47], v[142:143]
  v_cvt_pk_bf16_f32 v64, v40, v41
  v_cvt_pk_bf16_f32 v65, v42, v43
  v_cvt_pk_bf16_f32 v66, v44, v45
  v_cvt_pk_bf16_f32 v67, v46, v47
  buffer_store_dwordx4 v[64:67], v1, s[36:39], s66 offen sc1
  v_pk_mul_f32 v[48:49], v[48:49], v[144:145]
  v_pk_mul_f32 v[50:51], v[50:51], v[146:147]
  v_pk_mul_f32 v[52:53], v[52:53], v[148:149]
  v_pk_mul_f32 v[54:55], v[54:55], v[150:151]
  v_cvt_pk_bf16_f32 v68, v48, v49
  v_cvt_pk_bf16_f32 v69, v50, v51
  v_cvt_pk_bf16_f32 v70, v52, v53
  v_cvt_pk_bf16_f32 v71, v54, v55
  buffer_store_dwordx4 v[68:71], v1, s[36:39], s67 offen sc1
  s_branch L_p4_done
L_p4_one:
  buffer_load_dwordx4 v[120:123], v1, s[36:39], s68 offen offset:0 sc1
  s_add_u32 s68, s68, 28672
  buffer_load_dwordx4 v[128:131], v1, s[36:39], s69 offen offset:0 sc1
  s_add_u32 s69, s69, 28672
  buffer_load_dwordx4 v[136:139], v1, s[36:39], s70 offen offset:0 sc1
  s_add_u32 s70, s70, 28672
  buffer_load_dwordx4 v[144:147], v1, s[36:39], s71 offen offset:0 sc1
  s_add_u32 s71, s71, 28672
  s_waitcnt vmcnt(4)
  v_lshlrev_b32 v24, 16, v20
  v_lshlrev_b32 v25, 16, v20
  v_lshlrev_b32 v26, 16, v20
  v_lshlrev_b32 v27, 16, v20
  v_lshlrev_b32 v32, 16, v21
  v_lshlrev_b32 v33, 16, v21
  v_lshlrev_b32 v34, 16, v21
  v_lshlrev_b32 v35, 16, v21
  v_lshlrev_b32 v40, 16, v22
  v_lshlrev_b32 v41, 16, v22
  v_lshlrev_b32 v42, 16, v22
  v_lshlrev_b32 v43, 16, v22
  v_lshlrev_b32 v48, 16, v23
  v_lshlrev_b32 v49, 16, v23
  v_lshlrev_b32 v50, 16, v23
  v_lshlrev_b32 v51, 16, v23
  ds_read_b128 v[56:59], v8 offset:0
  ds_read_b128 v[60:63], v8 offset:4096
  ds_read_b128 v[64:67], v8 offset:8192
  ds_read_b128 v[68:71], v8 offset:12288
  buffer_load_dwordx4 v[152:155], v1, s[36:39], s68 offen offset:0 sc1
  s_add_u32 s68, s68, 28672
  buffer_load_dwordx4 v[160:163], v1, s[36:39], s69 offen offset:0 sc1
  s_add_u32 s69, s69, 28672
  buffer_store_dwordx4 v[104:107], v1, s[36:39], s54 offen sc1
  ds_read_b128 v[72:75], v9 offset:0
  ds_read_b128 v[76:79], v9 offset:4096
  buffer_load_dwordx4 v[184:187], v1, s[36:39], s68 offen offset:0 sc1
  s_add_u32 s68, s68, 28672
  s_waitcnt vmcnt(7) lgkmcnt(2)
  v_mfma_f32_16x16x32_bf16 v[24:27], v[120:123], v[56:59], v[24:27]
  ds_read_b128 v[80:83], v9 offset:8192
  buffer_load_dwordx4 v[168:171], v1, s[36:39], s70 offen offset:0 sc1
  s_add_u32 s70, s70, 28672
  v_mfma_f32_16x16x32_bf16 v[32:35], v[120:123], v[60:63], v[32:35]
  ds_read_b128 v[84:87], v9 offset:12288
  buffer_store_dwordx4 v[108:111], v1, s[36:39], s55 offen sc1
  v_mfma_f32_16x16x32_bf16 v[40:43], v[120:123], v[64:67], v[40:43]
  v_mfma_f32_16x16x32_bf16 v[48:51], v[120:123], v[68:71], v[48:51]
  ds_read_b128 v[88:91], v10 offset:0
  ds_read_b128 v[92:95], v10 offset:4096
  buffer_load_dwordx4 v[176:179], v1, s[36:39], s71 offen offset:0 sc1
  s_add_u32 s71, s71, 28672
  s_waitcnt vmcnt(9) lgkmcnt(2)
  v_mfma_f32_16x16x32_bf16 v[24:27], v[128:131], v[72:75], v[24:27]
  ds_read_b128 v[96:99], v10 offset:8192
  buffer_load_dwordx4 v[216:219], v1, s[36:39], s68 offen offset:0 sc1
  s_add_u32 s68, s68, 28672
  v_mfma_f32_16x16x32_bf16 v[32:35], v[128:131], v[76:79], v[32:35]
  ds_read_b128 v[100:103], v10 offset:12288
  s_cmp_eq_u32 s72, 1
  s_cbranch_scc0 L_skip17
  buffer_store_dwordx4 v[112:115], v1, s[36:39], s54 offen offset:1024 sc1
L_skip17:
  s_cmp_eq_u32 s72, 0
  s_cbranch_scc0 L_skip18
  buffer_store_dwordx2 v[112:113], v7, s[36:39], s60 offen offset:3072 sc1
L_skip18:
  v_mfma_f32_16x16x32_bf16 v[40:43], v[128:131], v[80:83], v[40:43]
  v_mfma_f32_16x16x32_bf16 v[48:51], v[128:131], v[84:87], v[48:51]
  ds_read_b128 v[56:59], v11 offset:0
  ds_read_b128 v[60:63], v11 offset:4096
  buffer_load_dwordx4 v[192:195], v1, s[36:39], s69 offen offset:0 sc1
  s_add_u32 s69, s69, 28672
  s_waitcnt vmcnt(11) lgkmcnt(2)
  v_mfma_f32_16x16x32_bf16 v[24:27], v[136:139], v[88:91], v[24:27]
  ds_read_b128 v[64:67], v11 offset:8192
  s_cmp_eq_u32 s72, 1
  s_cbranch_scc0 L_skip19
  buffer_store_dwordx4 v[116:119], v1, s[36:39], s55 offen offset:1024 sc1
L_skip19:
  s_cmp_eq_u32 s72, 0
  s_cbranch_scc0 L_skip20
  buffer_store_dwordx2 v[116:117], v7, s[36:39], s61 offen offset:3072 sc1
L_skip20:
  v_mfma_f32_16x16x32_bf16 v[32:35], v[136:139], v[92:95], v[32:35]
  ds_read_b128 v[68:71], v11 offset:12288
  v_mfma_f32_16x16x32_bf16 v[40:43], v[136:139], v[96:99], v[40:43]
  v_mfma_f32_16x16x32_bf16 v[48:51], v[136:139], v[100:103], v[48:51]
  s_barrier
  ds_read_b128 v[72:75], v8 offset:16384
  ds_read_b128 v[76:79], v8 offset:20480
  buffer_load_dwordx4 v[200:203], v1, s[36:39], s70 offen offset:0 sc1
  s_add_u32 s70, s70, 28672
  s_waitcnt vmcnt(12) lgkmcnt(2)
  v_mfma_f32_16x16x32_bf16 v[24:27], v[144:147], v[56:59], v[24:27]
  ds_read_b128 v[80:83], v8 offset:24576
  v_mfma_f32_16x16x32_bf16 v[32:35], v[144:147], v[60:63], v[32:35]
  ds_read_b128 v[84:87], v8 offset:28672
  v_mfma_f32_16x16x32_bf16 v[40:43], v[144:147], v[64:67], v[40:43]
  v_mfma_f32_16x16x32_bf16 v[48:51], v[144:147], v[68:71], v[48:51]
  ds_read_b128 v[88:91], v9 offset:16384
  ds_read_b128 v[92:95], v9 offset:20480
  buffer_load_dwordx4 v[208:211], v1, s[36:39], s71 offen offset:0 sc1
  s_add_u32 s71, s71, 28672
  s_waitcnt vmcnt(12) lgkmcnt(2)
  v_mfma_f32_16x16x32_bf16 v[24:27], v[152:155], v[72:75], v[24:27]
  ds_read_b128 v[96:99], v9 offset:24576
  v_mfma_f32_16x16x32_bf16 v[32:35], v[152:155], v[76:79], v[32:35]
  ds_read_b128 v[100:103], v9 offset:28672
  v_mfma_f32_16x16x32_bf16 v[40:43], v[152:155], v[80:83], v[40:43]
  v_mfma_f32_16x16x32_bf16 v[48:51], v[152:155], v[84:87], v[48:51]
  ds_read_b128 v[56:59], v10 offset:16384
  ds_read_b128 v[60:63], v10 offset:20480
  buffer_load_dwordx4 v[120:123], v1, s[36:39], s68 offen offset:0 sc1
  s_add_u32 s68, s68, 28672
  s_waitcnt vmcnt(12) lgkmcnt(2)
  v_mfma_f32_16x16x32_bf16 v[24:27], v[160:163], v[88:91], v[24:27]
  ds_read_b128 v[64:67], v10 offset:24576
  v_mfma_f32_16x16x32_bf16 v[32:35], v[160:163], v[92:95], v[32:35]
  ds_read_b128 v[68:71], v10 offset:28672
  v_mfma_f32_16x16x32_bf16 v[40:43], v[160:163], v[96:99], v[40:43]
  v_mfma_f32_16x16x32_bf16 v[48:51], v[160:163], v[100:103], v[48:51]
  ds_read_b128 v[72:75], v11 offset:16384
  ds_read_b128 v[76:79], v11 offset:20480
  buffer_load_dwordx4 v[224:227], v1, s[36:39], s69 offen offset:0 sc1
  s_add_u32 s69, s69, 28672
  s_waitcnt vmcnt(10) lgkmcnt(2)
  v_mfma_f32_16x16x32_bf16 v[24:27], v[168:171], v[56:59], v[24:27]
  ds_read_b128 v[80:83], v11 offset:24576
  v_mfma_f32_16x16x32_bf16 v[32:35], v[168:171], v[60:63], v[32:35]
  ds_read_b128 v[84:87], v11 offset:28672
  v_mfma_f32_16x16x32_bf16 v[40:43], v[168:171], v[64:67], v[40:43]
  v_mfma_f32_16x16x32_bf16 v[48:51], v[168:171], v[68:71], v[48:51]
  s_barrier
  ds_read_b128 v[88:91], v8 offset:32768
  ds_read_b128 v[92:95], v8 offset:36864
  buffer_load_dwordx4 v[232:235], v1, s[36:39], s70 offen offset:0 sc1
  s_add_u32 s70, s70, 28672
  s_waitcnt vmcnt(9) lgkmcnt(2)
  v_mfma_f32_16x16x32_bf16 v[24:27], v[176:179], v[72:75], v[24:27]
  ds_read_b128 v[96:99], v8 offset:40960
  v_mfma_f32_16x16x32_bf16 v[32:35], v[176:179], v[76:79], v[32:35]
  ds_read_b128 v[100:103], v8 offset:45056
  v_mfma_f32_16x16x32_bf16 v[40:43], v[176:179], v[80:83], v[40:43]
  v_mfma_f32_16x16x32_bf16 v[48:51], v[176:179], v[84:87], v[48:51]
  ds_read_b128 v[56:59], v9 offset:32768
  ds_read_b128 v[60:63], v9 offset:36864
  buffer_load_dwordx4 v[240:243], v1, s[36:39], s71 offen offset:0 sc1
  s_add_u32 s71, s71, 28672
  s_waitcnt lgkmcnt(2)
  v_mfma_f32_16x16x32_bf16 v[24:27], v[184:187], v[88:91], v[24:27]
  ds_read_b128 v[64:67], v9 offset:40960
  v_mfma_f32_16x16x32_bf16 v[32:35], v[184:187], v[92:95], v[32:35]
  ds_read_b128 v[68:71], v9 offset:45056
  v_mfma_f32_16x16x32_bf16 v[40:43], v[184:187], v[96:99], v[40:43]
  v_mfma_f32_16x16x32_bf16 v[48:51], v[184:187], v[100:103], v[48:51]
  ds_read_b128 v[72:75], v10 offset:32768
  ds_read_b128 v[76:79], v10 offset:36864
  buffer_load_dwordx4 v[152:155], v1, s[36:39], s68 offen offset:0 sc1
  s_add_u32 s68, s68, 28672
  s_waitcnt vmcnt(8) lgkmcnt(2)
  v_mfma_f32_16x16x32_bf16 v[24:27], v[192:195], v[56:59], v[24:27]
  ds_read_b128 v[80:83], v10 offset:40960
  v_mfma_f32_16x16x32_bf16 v[32:35], v[192:195], v[60:63], v[32:35]
  ds_read_b128 v[84:87], v10 offset:45056
  v_mfma_f32_16x16x32_bf16 v[40:43], v[192:195], v[64:67], v[40:43]
  v_mfma_f32_16x16x32_bf16 v[48:51], v[192:195], v[68:71], v[48:51]
  ds_read_b128 v[88:91], v11 offset:32768
  ds_read_b128 v[92:95], v11 offset:36864
  buffer_load_dwordx4 v[128:131], v1, s[36:39], s69 offen offset:0 sc1
  s_add_u32 s69, s69, 28672
  s_waitcnt vmcnt(7) lgkmcnt(2)
  v_mfma_f32_16x16x32_bf16 v[24:27], v[200:203], v[72:75], v[24:27]
  ds_read_b128 v[96:99], v11 offset:40960
  v_mfma_f32_16x16x32_bf16 v[32:35], v[200:203], v[76:79], v[32:35]
  ds_read_b128 v[100:103], v11 offset:45056
  v_mfma_f32_16x16x32_bf16 v[40:43], v[200:203], v[80:83], v[40:43]
  v_mfma_f32_16x16x32_bf16 v[48:51], v[200:203], v[84:87], v[48:51]
  s_barrier
  ds_read_b128 v[56:59], v8 offset:49152
  ds_read_b128 v[60:63], v8 offset:53248
  buffer_load_dwordx4 v[136:139], v1, s[36:39], s70 offen offset:0 sc1
  s_add_u32 s70, s70, 28672
  s_waitcnt vmcnt(7) lgkmcnt(2)
  v_mfma_f32_16x16x32_bf16 v[24:27], v[208:211], v[88:91], v[24:27]
  ds_read_b128 v[64:67], v8 offset:57344
  v_mfma_f32_16x16x32_bf16 v[32:35], v[208:211], v[92:95], v[32:35]
  ds_read_b128 v[68:71], v8 offset:61440
  v_mfma_f32_16x16x32_bf16 v[40:43], v[208:211], v[96:99], v[40:43]
  v_mfma_f32_16x16x32_bf16 v[48:51], v[208:211], v[100:103], v[48:51]
  ds_read_b128 v[72:75], v9 offset:49152
  ds_read_b128 v[76:79], v9 offset:53248
  buffer_load_dwordx4 v[144:147], v1, s[36:39], s71 offen offset:0 sc1
  s_add_u32 s71, s71, 28672
  s_waitcnt lgkmcnt(2)
  v_mfma_f32_16x16x32_bf16 v[24:27], v[216:219], v[56:59], v[24:27]
  ds_read_b128 v[80:83], v9 offset:57344
  v_mfma_f32_16x16x32_bf16 v[32:35], v[216:219], v[60:63], v[32:35]
  ds_read_b128 v[84:87], v9 offset:61440
  v_mfma_f32_16x16x32_bf16 v[40:43], v[216:219], v[64:67], v[40:43]
  v_mfma_f32_16x16x32_bf16 v[48:51], v[216:219], v[68:71], v[48:51]
  ds_read_b128 v[88:91], v10 offset:49152
  ds_read_b128 v[92:95], v10 offset:53248
  buffer_load_dwordx4 v[184:187], v1, s[36:39], s68 offen offset:0 sc1
  s_add_u32 s68, s68, 28672
  s_waitcnt vmcnt(7) lgkmcnt(2)
  v_mfma_f32_16x16x32_bf16 v[24:27], v[224:227], v[72:75], v[24:27]
  ds_read_b128 v[96:99], v10 offset:57344
  v_mfma_f32_16x16x32_bf16 v[32:35], v[224:227], v[76:79], v[32:35]
  ds_read_b128 v[100:103], v10 offset:61440
  v_mfma_f32_16x16x32_bf16 v[40:43], v[224:227], v[80:83], v[40:43]
  v_mfma_f32_16x16x32_bf16 v[48:51], v[224:227], v[84:87], v[48:51]
  ds_read_b128 v[56:59], v11 offset:49152
  ds_read_b128 v[60:63], v11 offset:53248
  buffer_load_dwordx4 v[160:163], v1, s[36:39], s69 offen offset:0 sc1
  s_add_u32 s69, s69, 28672
  s_waitcnt vmcnt(7) lgkmcnt(2)
  v_mfma_f32_16x16x32_bf16 v[24:27], v[232:235], v[88:91], v[24:27]
  ds_read_b128 v[64:67], v11 offset:57344
  v_mfma_f32_16x16x32_bf16 v[32:35], v[232:235], v[92:95], v[32:35]
  ds_read_b128 v[68:71], v11 offset:61440
  v_mfma_f32_16x16x32_bf16 v[40:43], v[232:235], v[96:99], v[40:43]
  v_mfma_f32_16x16x32_bf16 v[48:51], v[232:235], v[100:103], v[48:51]
  s_barrier
  ds_read_b128 v[72:75], v16 offset:0
  ds_read_b128 v[76:79], v16 offset:4096
  buffer_load_dwordx4 v[168:171], v1, s[36:39], s70 offen offset:0 sc1
  s_add_u32 s70, s70, 28672
  s_waitcnt vmcnt(7) lgkmcnt(2)
  v_mfma_f32_16x16x32_bf16 v[24:27], v[240:243], v[56:59], v[24:27]
  ds_read_b128 v[80:83], v16 offset:8192
  v_mfma_f32_16x16x32_bf16 v[32:35], v[240:243], v[60:63], v[32:35]
  ds_read_b128 v[84:87], v16 offset:12288
  v_mfma_f32_16x16x32_bf16 v[40:43], v[240:243], v[64:67], v[40:43]
  v_mfma_f32_16x16x32_bf16 v[48:51], v[240:243], v[68:71], v[48:51]
  ds_read_b128 v[88:91], v17 offset:0
  ds_read_b128 v[92:95], v17 offset:4096
  buffer_load_dwordx4 v[176:179], v1, s[36:39], s71 offen offset:0 sc1
  s_add_u32 s71, s71, 28672
  s_waitcnt lgkmcnt(2)
  v_mfma_f32_16x16x32_bf16 v[24:27], v[120:123], v[72:75], v[24:27]
  ds_read_b128 v[96:99], v17 offset:8192
  v_mfma_f32_16x16x32_bf16 v[32:35], v[120:123], v[76:79], v[32:35]
  ds_read_b128 v[100:103], v17 offset:12288
  v_mfma_f32_16x16x32_bf16 v[40:43], v[120:123], v[80:83], v[40:43]
  v_mfma_f32_16x16x32_bf16 v[48:51], v[120:123], v[84:87], v[48:51]
  ds_read_b128 v[56:59], v18 offset:0
  ds_read_b128 v[60:63], v18 offset:4096
  buffer_load_dwordx4 v[216:219], v1, s[36:39], s68 offen offset:0 sc1
  s_add_u32 s68, s68, 28672
  s_waitcnt vmcnt(7) lgkmcnt(2)
  v_mfma_f32_16x16x32_bf16 v[24:27], v[128:131], v[88:91], v[24:27]
  ds_read_b128 v[64:67], v18 offset:8192
  v_mfma_f32_16x16x32_bf16 v[32:35], v[128:131], v[92:95], v[32:35]
  ds_read_b128 v[68:71], v18 offset:12288
  v_mfma_f32_16x16x32_bf16 v[40:43], v[128:131], v[96:99], v[40:43]
  v_mfma_f32_16x16x32_bf16 v[48:51], v[128:131], v[100:103], v[48:51]
  ds_read_b128 v[72:75], v19 offset:0
  ds_read_b128 v[76:79], v19 offset:4096
  buffer_load_dwordx4 v[192:195], v1, s[36:39], s69 offen offset:0 sc1
  s_add_u32 s69, s69, 28672
  s_waitcnt vmcnt(7) lgkmcnt(2)
  v_mfma_f32_16x16x32_bf16 v[24:27], v[136:139], v[56:59], v[24:27]
  ds_read_b128 v[80:83], v19 offset:8192
  v_mfma_f32_16x16x32_bf16 v[32:35], v[136:139], v[60:63], v[32:35]
  ds_read_b128 v[84:87], v19 offset:12288
  v_mfma_f32_16x16x32_bf16 v[40:43], v[136:139], v[64:67], v[40:43]
  v_mfma_f32_16x16x32_bf16 v[48:51], v[136:139], v[68:71], v[48:51]
  s_barrier
  ds_read_b128 v[88:91], v12 offset:0
  ds_read_b128 v[92:95], v12 offset:4096
  buffer_load_dwordx4 v[200:203], v1, s[36:39], s70 offen offset:0 sc1
  s_add_u32 s70, s70, 28672
  s_waitcnt vmcnt(7) lgkmcnt(2)
  v_mfma_f32_16x16x32_bf16 v[24:27], v[144:147], v[72:75], v[24:27]
  ds_read_b128 v[96:99], v12 offset:8192
  v_mfma_f32_16x16x32_bf16 v[32:35], v[144:147], v[76:79], v[32:35]
  ds_read_b128 v[100:103], v12 offset:12288
  v_mfma_f32_16x16x32_bf16 v[40:43], v[144:147], v[80:83], v[40:43]
  v_mfma_f32_16x16x32_bf16 v[48:51], v[144:147], v[84:87], v[48:51]
  ds_read_b128 v[56:59], v13 offset:0
  ds_read_b128 v[60:63], v13 offset:4096
  buffer_load_dwordx4 v[208:211], v1, s[36:39], s71 offen offset:0 sc1
  s_add_u32 s71, s71, 28672
  s_waitcnt lgkmcnt(2)
  v_mfma_f32_16x16x32_bf16 v[24:27], v[152:155], v[88:91], v[24:27]
  ds_read_b128 v[64:67], v13 offset:8192
  v_mfma_f32_16x16x32_bf16 v[32:35], v[152:155], v[92:95], v[32:35]
  ds_read_b128 v[68:71], v13 offset:12288
  v_mfma_f32_16x16x32_bf16 v[40:43], v[152:155], v[96:99], v[40:43]
  v_mfma_f32_16x16x32_bf16 v[48:51], v[152:155], v[100:103], v[48:51]
  ds_read_b128 v[72:75], v14 offset:0
  ds_read_b128 v[76:79], v14 offset:4096
  buffer_load_dwordx4 v[120:123], v1, s[36:39], s68 offen offset:0 sc1
  s_add_u32 s68, s68, 28672
  s_waitcnt vmcnt(7) lgkmcnt(2)
  v_mfma_f32_16x16x32_bf16 v[24:27], v[160:163], v[56:59], v[24:27]
  ds_read_b128 v[80:83], v14 offset:8192
  v_mfma_f32_16x16x32_bf16 v[32:35], v[160:163], v[60:63], v[32:35]
  ds_read_b128 v[84:87], v14 offset:12288
  v_mfma_f32_16x16x32_bf16 v[40:43], v[160:163], v[64:67], v[40:43]
  v_mfma_f32_16x16x32_bf16 v[48:51], v[160:163], v[68:71], v[48:51]
  ds_read_b128 v[88:91], v15 offset:0
  ds_read_b128 v[92:95], v15 offset:4096
  buffer_load_dwordx4 v[224:227], v1, s[36:39], s69 offen offset:0 sc1
  s_add_u32 s69, s69, 28672
  s_waitcnt vmcnt(7) lgkmcnt(2)
  v_mfma_f32_16x16x32_bf16 v[24:27], v[168:171], v[72:75], v[24:27]
  ds_read_b128 v[96:99], v15 offset:8192
  v_mfma_f32_16x16x32_bf16 v[32:35], v[168:171], v[76:79], v[32:35]
  ds_read_b128 v[100:103], v15 offset:12288
  v_mfma_f32_16x16x32_bf16 v[40:43], v[168:171], v[80:83], v[40:43]
  v_mfma_f32_16x16x32_bf16 v[48:51], v[168:171], v[84:87], v[48:51]
  s_barrier
  ds_read_b128 v[56:59], v12 offset:16384
  ds_read_b128 v[60:63], v12 offset:20480
  buffer_load_dwordx4 v[232:235], v1, s[36:39], s70 offen offset:0 sc1
  s_add_u32 s70, s70, 28672
  s_waitcnt vmcnt(7) lgkmcnt(2)
  v_mfma_f32_16x16x32_bf16 v[24:27], v[176:179], v[88:91], v[24:27]
  ds_read_b128 v[64:67], v12 offset:24576
  v_mfma_f32_16x16x32_bf16 v[32:35], v[176:179], v[92:95], v[32:35]
  ds_read_b128 v[68:71], v12 offset:28672
  v_mfma_f32_16x16x32_bf16 v[40:43], v[176:179], v[96:99], v[40:43]
  v_mfma_f32_16x16x32_bf16 v[48:51], v[176:179], v[100:103], v[48:51]
  ds_read_b128 v[72:75], v13 offset:16384
  ds_read_b128 v[76:79], v13 offset:20480
  buffer_load_dwordx4 v[240:243], v1, s[36:39], s71 offen offset:0 sc1
  s_add_u32 s71, s71, 28672
  s_waitcnt lgkmcnt(2)
  v_mfma_f32_16x16x32_bf16 v[24:27], v[184:187], v[56:59], v[24:27]
  ds_read_b128 v[80:83], v13 offset:24576
  v_mfma_f32_16x16x32_bf16 v[32:35], v[184:187], v[60:63], v[32:35]
  ds_read_b128 v[84:87], v13 offset:28672
  v_mfma_f32_16x16x32_bf16 v[40:43], v[184:187], v[64:67], v[40:43]
  v_mfma_f32_16x16x32_bf16 v[48:51], v[184:187], v[68:71], v[48:51]
  ds_read_b128 v[88:91], v14 offset:16384
  ds_read_b128 v[92:95], v14 offset:20480
  buffer_load_dwordx4 v[152:155], v1, s[36:39], s68 offen offset:0 sc1
  s_add_u32 s68, s68, 28672
  s_waitcnt vmcnt(7) lgkmcnt(2)
  v_mfma_f32_16x16x32_bf16 v[24:27], v[192:195], v[72:75], v[24:27]
  ds_read_b128 v[96:99], v14 offset:24576
  v_mfma_f32_16x16x32_bf16 v[32:35], v[192:195], v[76:79], v[32:35]
  ds_read_b128 v[100:103], v14 offset:28672
  v_mfma_f32_16x16x32_bf16 v[40:43], v[192:195], v[80:83], v[40:43]
  v_mfma_f32_16x16x32_bf16 v[48:51], v[192:195], v[84:87], v[48:51]
  ds_read_b128 v[56:59], v15 offset:16384
  ds_read_b128 v[60:63], v15 offset:20480
  buffer_load_dwordx4 v[128:131], v1, s[36:39], s69 offen offset:0 sc1
  s_add_u32 s69, s69, 28672
  s_waitcnt vmcnt(7) lgkmcnt(2)
  v_mfma_f32_16x16x32_bf16 v[24:27], v[200:203], v[88:91], v[24:27]
  ds_read_b128 v[64:67], v15 offset:24576
  v_mfma_f32_16x16x32_bf16 v[32:35], v[200:203], v[92:95], v[32:35]
  ds_read_b128 v[68:71], v15 offset:28672
  v_mfma_f32_16x16x32_bf16 v[40:43], v[200:203], v[96:99], v[40:43]
  v_mfma_f32_16x16x32_bf16 v[48:51], v[200:203], v[100:103], v[48:51]
  s_barrier
  ds_read_b128 v[72:75], v12 offset:32768
  ds_read_b128 v[76:79], v12 offset:36864
  buffer_load_dwordx4 v[136:139], v1, s[36:39], s70 offen offset:0 sc1
  s_add_u32 s70, s70, 28672
  s_waitcnt vmcnt(7) lgkmcnt(2)
  v_mfma_f32_16x16x32_bf16 v[24:27], v[208:211], v[56:59], v[24:27]
  ds_read_b128 v[80:83], v12 offset:40960
  v_mfma_f32_16x16x32_bf16 v[32:35], v[208:211], v[60:63], v[32:35]
  ds_read_b128 v[84:87], v12 offset:45056
  v_mfma_f32_16x16x32_bf16 v[40:43], v[208:211], v[64:67], v[40:43]
  v_mfma_f32_16x16x32_bf16 v[48:51], v[208:211], v[68:71], v[48:51]
  ds_read_b128 v[88:91], v13 offset:32768
  ds_read_b128 v[92:95], v13 offset:36864
  buffer_load_dwordx4 v[144:147], v1, s[36:39], s71 offen offset:0 sc1
  s_add_u32 s71, s71, 28672
  s_waitcnt lgkmcnt(2)
  v_mfma_f32_16x16x32_bf16 v[24:27], v[216:219], v[72:75], v[24:27]
  ds_read_b128 v[96:99], v13 offset:40960
  v_mfma_f32_16x16x32_bf16 v[32:35], v[216:219], v[76:79], v[32:35]
  ds_read_b128 v[100:103], v13 offset:45056
  v_mfma_f32_16x16x32_bf16 v[40:43], v[216:219], v[80:83], v[40:43]
  v_mfma_f32_16x16x32_bf16 v[48:51], v[216:219], v[84:87], v[48:51]
  ds_read_b128 v[56:59], v14 offset:32768
  ds_read_b128 v[60:63], v14 offset:36864
  buffer_load_dwordx4 v[184:187], v1, s[36:39], s68 offen offset:0 sc1
  s_add_u32 s68, s68, 28672
  s_waitcnt vmcnt(7) lgkmcnt(2)
  v_mfma_f32_16x16x32_bf16 v[24:27], v[224:227], v[88:91], v[24:27]
  ds_read_b128 v[64:67], v14 offset:40960
  v_mfma_f32_16x16x32_bf16 v[32:35], v[224:227], v[92:95], v[32:35]
  ds_read_b128 v[68:71], v14 offset:45056
  v_mfma_f32_16x16x32_bf16 v[40:43], v[224:227], v[96:99], v[40:43]
  v_mfma_f32_16x16x32_bf16 v[48:51], v[224:227], v[100:103], v[48:51]
  ds_read_b128 v[72:75], v15 offset:32768
  ds_read_b128 v[76:79], v15 offset:36864
  buffer_load_dwordx4 v[160:163], v1, s[36:39], s69 offen offset:0 sc1
  s_add_u32 s69, s69, 28672
  s_waitcnt vmcnt(7) lgkmcnt(2)
  v_mfma_f32_16x16x32_bf16 v[24:27], v[232:235], v[56:59], v[24:27]
  ds_read_b128 v[80:83], v15 offset:40960
  v_mfma_f32_16x16x32_bf16 v[32:35], v[232:235], v[60:63], v[32:35]
  ds_read_b128 v[84:87], v15 offset:45056
  v_mfma_f32_16x16x32_bf16 v[40:43], v[232:235], v[64:67], v[40:43]
  v_mfma_f32_16x16x32_bf16 v[48:51], v[232:235], v[68:71], v[48:51]
  s_barrier
  ds_read_b128 v[88:91], v12 offset:49152
  ds_read_b128 v[92:95], v12 offset:53248
  buffer_load_dwordx4 v[168:171], v1, s[36:39], s70 offen offset:0 sc1
  s_add_u32 s70, s70, 28672
  s_waitcnt vmcnt(7) lgkmcnt(2)
  v_mfma_f32_16x16x32_bf16 v[24:27], v[240:243], v[72:75], v[24:27]
  ds_read_b128 v[96:99], v12 offset:57344
  v_mfma_f32_16x16x32_bf16 v[32:35], v[240:243], v[76:79], v[32:35]
  ds_read_b128 v[100:103], v12 offset:61440
  v_mfma_f32_16x16x32_bf16 v[40:43], v[240:243], v[80:83], v[40:43]
  v_mfma_f32_16x16x32_bf16 v[48:51], v[240:243], v[84:87], v[48:51]
  ds_read_b128 v[56:59], v13 offset:49152
  ds_read_b128 v[60:63], v13 offset:53248
  buffer_load_dwordx4 v[176:179], v1, s[36:39], s71 offen offset:0 sc1
  s_add_u32 s71, s71, 28672
  s_waitcnt lgkmcnt(2)
  v_mfma_f32_16x16x32_bf16 v[24:27], v[120:123], v[88:91], v[24:27]
  ds_read_b128 v[64:67], v13 offset:57344
  v_mfma_f32_16x16x32_bf16 v[32:35], v[120:123], v[92:95], v[32:35]
  ds_read_b128 v[68:71], v13 offset:61440
  v_mfma_f32_16x16x32_bf16 v[40:43], v[120:123], v[96:99], v[40:43]
  v_mfma_f32_16x16x32_bf16 v[48:51], v[120:123], v[100:103], v[48:51]
  ds_read_b128 v[72:75], v14 offset:49152
  ds_read_b128 v[76:79], v14 offset:53248
  buffer_load_dwordx4 v[216:219], v1, s[36:39], s68 offen offset:0 sc1
  s_add_u32 s68, s68, 28672
  s_waitcnt vmcnt(7) lgkmcnt(2)
  v_mfma_f32_16x16x32_bf16 v[24:27], v[128:131], v[56:59], v[24:27]
  ds_read_b128 v[80:83], v14 offset:57344
  v_mfma_f32_16x16x32_bf16 v[32:35], v[128:131], v[60:63], v[32:35]
  ds_read_b128 v[84:87], v14 offset:61440
  v_mfma_f32_16x16x32_bf16 v[40:43], v[128:131], v[64:67], v[40:43]
  v_mfma_f32_16x16x32_bf16 v[48:51], v[128:131], v[68:71], v[48:51]
  ds_read_b128 v[88:91], v15 offset:49152
  ds_read_b128 v[92:95], v15 offset:53248
  buffer_load_dwordx4 v[192:195], v1, s[36:39], s69 offen offset:0 sc1
  s_add_u32 s69, s69, 28672
  s_waitcnt vmcnt(7) lgkmcnt(2)
  v_mfma_f32_16x16x32_bf16 v[24:27], v[136:139], v[72:75], v[24:27]
  ds_read_b128 v[96:99], v15 offset:57344
  v_mfma_f32_16x16x32_bf16 v[32:35], v[136:139], v[76:79], v[32:35]
  ds_read_b128 v[100:103], v15 offset:61440
  v_mfma_f32_16x16x32_bf16 v[40:43], v[136:139], v[80:83], v[40:43]
  v_mfma_f32_16x16x32_bf16 v[48:51], v[136:139], v[84:87], v[48:51]
  s_barrier
  ds_read_b128 v[56:59], v8 offset:0
  ds_read_b128 v[60:63], v8 offset:4096
  buffer_load_dwordx4 v[200:203], v1, s[36:39], s70 offen offset:0 sc1
  s_add_u32 s70, s70, 28672
  s_waitcnt vmcnt(7) lgkmcnt(2)
  v_mfma_f32_16x16x32_bf16 v[24:27], v[144:147], v[88:91], v[24:27]
  ds_read_b128 v[64:67], v8 offset:8192
  v_mfma_f32_16x16x32_bf16 v[32:35], v[144:147], v[92:95], v[32:35]
  ds_read_b128 v[68:71], v8 offset:12288
  v_mfma_f32_16x16x32_bf16 v[40:43], v[144:147], v[96:99], v[40:43]
  v_mfma_f32_16x16x32_bf16 v[48:51], v[144:147], v[100:103], v[48:51]
  ds_read_b128 v[72:75], v9 offset:0
  ds_read_b128 v[76:79], v9 offset:4096
  buffer_load_dwordx4 v[208:211], v1, s[36:39], s71 offen offset:0 sc1
  s_add_u32 s71, s71, 28672
  s_waitcnt lgkmcnt(2)
  v_mfma_f32_16x16x32_bf16 v[24:27], v[152:155], v[56:59], v[24:27]
  ds_read_b128 v[80:83], v9 offset:8192
  v_mfma_f32_16x16x32_bf16 v[32:35], v[152:155], v[60:63], v[32:35]
  ds_read_b128 v[84:87], v9 offset:12288
  v_mfma_f32_16x16x32_bf16 v[40:43], v[152:155], v[64:67], v[40:43]
  v_mfma_f32_16x16x32_bf16 v[48:51], v[152:155], v[68:71], v[48:51]
  ds_read_b128 v[88:91], v10 offset:0
  ds_read_b128 v[92:95], v10 offset:4096
  buffer_load_dwordx4 v[120:123], v1, s[36:39], s68 offen offset:0 sc1
  s_add_u32 s68, s68, 28672
  s_waitcnt vmcnt(7) lgkmcnt(2)
  v_mfma_f32_16x16x32_bf16 v[24:27], v[160:163], v[72:75], v[24:27]
  ds_read_b128 v[96:99], v10 offset:8192
  v_mfma_f32_16x16x32_bf16 v[32:35], v[160:163], v[76:79], v[32:35]
  ds_read_b128 v[100:103], v10 offset:12288
  v_mfma_f32_16x16x32_bf16 v[40:43], v[160:163], v[80:83], v[40:43]
  v_mfma_f32_16x16x32_bf16 v[48:51], v[160:163], v[84:87], v[48:51]
  ds_read_b128 v[56:59], v11 offset:0
  ds_read_b128 v[60:63], v11 offset:4096
  buffer_load_dwordx4 v[224:227], v1, s[36:39], s69 offen offset:0 sc1
  s_add_u32 s69, s69, 28672
  s_waitcnt vmcnt(7) lgkmcnt(2)
  v_mfma_f32_16x16x32_bf16 v[24:27], v[168:171], v[88:91], v[24:27]
  ds_read_b128 v[64:67], v11 offset:8192
  v_mfma_f32_16x16x32_bf16 v[32:35], v[168:171], v[92:95], v[32:35]
  ds_read_b128 v[68:71], v11 offset:12288
  v_mfma_f32_16x16x32_bf16 v[40:43], v[168:171], v[96:99], v[40:43]
  v_mfma_f32_16x16x32_bf16 v[48:51], v[168:171], v[100:103], v[48:51]
  s_barrier
  ds_read_b128 v[72:75], v8 offset:16384
  ds_read_b128 v[76:79], v8 offset:20480
  buffer_load_dwordx4 v[232:235], v1, s[36:39], s70 offen offset:0 sc1
  s_add_u32 s70, s70, 28672
  s_waitcnt vmcnt(7) lgkmcnt(2)
  v_mfma_f32_16x16x32_bf16 v[24:27], v[176:179], v[56:59], v[24:27]
  ds_read_b128 v[80:83], v8 offset:24576
  v_mfma_f32_16x16x32_bf16 v[32:35], v[176:179], v[60:63], v[32:35]
  ds_read_b128 v[84:87], v8 offset:28672
  v_mfma_f32_16x16x32_bf16 v[40:43], v[176:179], v[64:67], v[40:43]
  v_mfma_f32_16x16x32_bf16 v[48:51], v[176:179], v[68:71], v[48:51]
  ds_read_b128 v[88:91], v9 offset:16384
  ds_read_b128 v[92:95], v9 offset:20480
  buffer_load_dwordx4 v[240:243], v1, s[36:39], s71 offen offset:0 sc1
  s_add_u32 s71, s71, 28672
  s_waitcnt lgkmcnt(2)
  v_mfma_f32_16x16x32_bf16 v[24:27], v[184:187], v[72:75], v[24:27]
  ds_read_b128 v[96:99], v9 offset:24576
  v_mfma_f32_16x16x32_bf16 v[32:35], v[184:187], v[76:79], v[32:35]
  ds_read_b128 v[100:103], v9 offset:28672
  v_mfma_f32_16x16x32_bf16 v[40:43], v[184:187], v[80:83], v[40:43]
  v_mfma_f32_16x16x32_bf16 v[48:51], v[184:187], v[84:87], v[48:51]
  ds_read_b128 v[56:59], v10 offset:16384
  ds_read_b128 v[60:63], v10 offset:20480
  buffer_load_dwordx4 v[152:155], v1, s[36:39], s68 offen offset:0 sc1
  s_add_u32 s68, s68, 28672
  s_waitcnt vmcnt(7) lgkmcnt(2)
  v_mfma_f32_16x16x32_bf16 v[24:27], v[192:195], v[88:91], v[24:27]
  ds_read_b128 v[64:67], v10 offset:24576
  v_mfma_f32_16x16x32_bf16 v[32:35], v[192:195], v[92:95], v[32:35]
  ds_read_b128 v[68:71], v10 offset:28672
  v_mfma_f32_16x16x32_bf16 v[40:43], v[192:195], v[96:99], v[40:43]
  v_mfma_f32_16x16x32_bf16 v[48:51], v[192:195], v[100:103], v[48:51]
  ds_read_b128 v[72:75], v11 offset:16384
  ds_read_b128 v[76:79], v11 offset:20480
  buffer_load_dwordx4 v[128:131], v1, s[36:39], s69 offen offset:0 sc1
  s_add_u32 s69, s69, 28672
  s_waitcnt vmcnt(7) lgkmcnt(2)
  v_mfma_f32_16x16x32_bf16 v[24:27], v[200:203], v[56:59], v[24:27]
  ds_read_b128 v[80:83], v11 offset:24576
  v_mfma_f32_16x16x32_bf16 v[32:35], v[200:203], v[60:63], v[32:35]
  ds_read_b128 v[84:87], v11 offset:28672
  v_mfma_f32_16x16x32_bf16 v[40:43], v[200:203], v[64:67], v[40:43]
  v_mfma_f32_16x16x32_bf16 v[48:51], v[200:203], v[68:71], v[48:51]
  s_barrier
  ds_read_b128 v[88:91], v8 offset:32768
  ds_read_b128 v[92:95], v8 offset:36864
  buffer_load_dwordx4 v[136:139], v1, s[36:39], s70 offen offset:0 sc1
  s_add_u32 s70, s70, 28672
  s_waitcnt vmcnt(7) lgkmcnt(2)
  v_mfma_f32_16x16x32_bf16 v[24:27], v[208:211], v[72:75], v[24:27]
  ds_read_b128 v[96:99], v8 offset:40960
  v_mfma_f32_16x16x32_bf16 v[32:35], v[208:211], v[76:79], v[32:35]
  ds_read_b128 v[100:103], v8 offset:45056
  v_mfma_f32_16x16x32_bf16 v[40:43], v[208:211], v[80:83], v[40:43]
  v_mfma_f32_16x16x32_bf16 v[48:51], v[208:211], v[84:87], v[48:51]
  ds_read_b128 v[56:59], v9 offset:32768
  ds_read_b128 v[60:63], v9 offset:36864
  buffer_load_dwordx4 v[144:147], v1, s[36:39], s71 offen offset:0 sc1
  s_add_u32 s71, s71, 28672
  s_waitcnt lgkmcnt(2)
  v_mfma_f32_16x16x32_bf16 v[24:27], v[216:219], v[88:91], v[24:27]
  ds_read_b128 v[64:67], v9 offset:40960
  v_mfma_f32_16x16x32_bf16 v[32:35], v[216:219], v[92:95], v[32:35]
  ds_read_b128 v[68:71], v9 offset:45056
  v_mfma_f32_16x16x32_bf16 v[40:43], v[216:219], v[96:99], v[40:43]
  v_mfma_f32_16x16x32_bf16 v[48:51], v[216:219], v[100:103], v[48:51]
  ds_read_b128 v[72:75], v10 offset:32768
  ds_read_b128 v[76:79], v10 offset:36864
  buffer_load_dwordx4 v[184:187], v1, s[36:39], s68 offen offset:0 sc1
  s_add_u32 s68, s68, 28672
  s_waitcnt vmcnt(7) lgkmcnt(2)
  v_mfma_f32_16x16x32_bf16 v[24:27], v[224:227], v[56:59], v[24:27]
  ds_read_b128 v[80:83], v10 offset:40960
  v_mfma_f32_16x16x32_bf16 v[32:35], v[224:227], v[60:63], v[32:35]
  ds_read_b128 v[84:87], v10 offset:45056
  v_mfma_f32_16x16x32_bf16 v[40:43], v[224:227], v[64:67], v[40:43]
  v_mfma_f32_16x16x32_bf16 v[48:51], v[224:227], v[68:71], v[48:51]
  ds_read_b128 v[88:91], v11 offset:32768
  ds_read_b128 v[92:95], v11 offset:36864
  buffer_load_dwordx4 v[160:163], v1, s[36:39], s69 offen offset:0 sc1
  s_add_u32 s69, s69, 28672
  s_waitcnt vmcnt(7) lgkmcnt(2)
  v_mfma_f32_16x16x32_bf16 v[24:27], v[232:235], v[72:75], v[24:27]
  ds_read_b128 v[96:99], v11 offset:40960
  v_mfma_f32_16x16x32_bf16 v[32:35], v[232:235], v[76:79], v[32:35]
  ds_read_b128 v[100:103], v11 offset:45056
  v_mfma_f32_16x16x32_bf16 v[40:43], v[232:235], v[80:83], v[40:43]
  v_mfma_f32_16x16x32_bf16 v[48:51], v[232:235], v[84:87], v[48:51]
  s_barrier
  ds_read_b128 v[56:59], v8 offset:49152
  ds_read_b128 v[60:63], v8 offset:53248
  buffer_load_dwordx4 v[168:171], v1, s[36:39], s70 offen offset:0 sc1
  s_add_u32 s70, s70, 28672
  s_waitcnt vmcnt(7) lgkmcnt(2)
  v_mfma_f32_16x16x32_bf16 v[24:27], v[240:243], v[88:91], v[24:27]
  ds_read_b128 v[64:67], v8 offset:57344
  v_mfma_f32_16x16x32_bf16 v[32:35], v[240:243], v[92:95], v[32:35]
  ds_read_b128 v[68:71], v8 offset:61440
  v_mfma_f32_16x16x32_bf16 v[40:43], v[240:243], v[96:99], v[40:43]
  v_mfma_f32_16x16x32_bf16 v[48:51], v[240:243], v[100:103], v[48:51]
  ds_read_b128 v[72:75], v9 offset:49152
  ds_read_b128 v[76:79], v9 offset:53248
  buffer_load_dwordx4 v[176:179], v1, s[36:39], s71 offen offset:0 sc1
  s_add_u32 s71, s71, 28672
  s_waitcnt lgkmcnt(2)
  v_mfma_f32_16x16x32_bf16 v[24:27], v[120:123], v[56:59], v[24:27]
  ds_read_b128 v[80:83], v9 offset:57344
  v_mfma_f32_16x16x32_bf16 v[32:35], v[120:123], v[60:63], v[32:35]
  ds_read_b128 v[84:87], v9 offset:61440
  v_mfma_f32_16x16x32_bf16 v[40:43], v[120:123], v[64:67], v[40:43]
  v_mfma_f32_16x16x32_bf16 v[48:51], v[120:123], v[68:71], v[48:51]
  ds_read_b128 v[88:91], v10 offset:49152
  ds_read_b128 v[92:95], v10 offset:53248
  buffer_load_dwordx4 v[216:219], v1, s[36:39], s68 offen offset:0 sc1
  s_add_u32 s68, s68, 28672
  s_waitcnt vmcnt(7) lgkmcnt(2)
  v_mfma_f32_16x16x32_bf16 v[24:27], v[128:131], v[72:75], v[24:27]
  ds_read_b128 v[96:99], v10 offset:57344
  v_mfma_f32_16x16x32_bf16 v[32:35], v[128:131], v[76:79], v[32:35]
  ds_read_b128 v[100:103], v10 offset:61440
  v_mfma_f32_16x16x32_bf16 v[40:43], v[128:131], v[80:83], v[40:43]
  v_mfma_f32_16x16x32_bf16 v[48:51], v[128:131], v[84:87], v[48:51]
  ds_read_b128 v[56:59], v11 offset:49152
  ds_read_b128 v[60:63], v11 offset:53248
  buffer_load_dwordx4 v[192:195], v1, s[36:39], s69 offen offset:0 sc1
  s_add_u32 s69, s69, 28672
  s_waitcnt vmcnt(7) lgkmcnt(2)
  v_mfma_f32_16x16x32_bf16 v[24:27], v[136:139], v[88:91], v[24:27]
  ds_read_b128 v[64:67], v11 offset:57344
  v_mfma_f32_16x16x32_bf16 v[32:35], v[136:139], v[92:95], v[32:35]
  ds_read_b128 v[68:71], v11 offset:61440
  v_mfma_f32_16x16x32_bf16 v[40:43], v[136:139], v[96:99], v[40:43]
  v_mfma_f32_16x16x32_bf16 v[48:51], v[136:139], v[100:103], v[48:51]
  s_barrier
  ds_read_b128 v[72:75], v16 offset:0
  ds_read_b128 v[76:79], v16 offset:4096
  buffer_load_dwordx4 v[200:203], v1, s[36:39], s70 offen offset:0 sc1
  s_add_u32 s70, s70, 28672
  s_waitcnt vmcnt(7) lgkmcnt(2)
  v_mfma_f32_16x16x32_bf16 v[24:27], v[144:147], v[56:59], v[24:27]
  ds_read_b128 v[80:83], v16 offset:8192
  v_mfma_f32_16x16x32_bf16 v[32:35], v[144:147], v[60:63], v[32:35]
  ds_read_b128 v[84:87], v16 offset:12288
  v_mfma_f32_16x16x32_bf16 v[40:43], v[144:147], v[64:67], v[40:43]
  v_mfma_f32_16x16x32_bf16 v[48:51], v[144:147], v[68:71], v[48:51]
  ds_read_b128 v[88:91], v17 offset:0
  ds_read_b128 v[92:95], v17 offset:4096
  buffer_load_dwordx4 v[208:211], v1, s[36:39], s71 offen offset:0 sc1
  s_add_u32 s71, s71, 28672
  s_waitcnt lgkmcnt(2)
  v_mfma_f32_16x16x32_bf16 v[24:27], v[152:155], v[72:75], v[24:27]
  ds_read_b128 v[96:99], v17 offset:8192
  v_mfma_f32_16x16x32_bf16 v[32:35], v[152:155], v[76:79], v[32:35]
  ds_read_b128 v[100:103], v17 offset:12288
  v_mfma_f32_16x16x32_bf16 v[40:43], v[152:155], v[80:83], v[40:43]
  v_mfma_f32_16x16x32_bf16 v[48:51], v[152:155], v[84:87], v[48:51]
  ds_read_b128 v[56:59], v18 offset:0
  ds_read_b128 v[60:63], v18 offset:4096
  s_waitcnt vmcnt(6) lgkmcnt(2)
  v_mfma_f32_16x16x32_bf16 v[24:27], v[160:163], v[88:91], v[24:27]
  ds_read_b128 v[64:67], v18 offset:8192
  v_mfma_f32_16x16x32_bf16 v[32:35], v[160:163], v[92:95], v[32:35]
  ds_read_b128 v[68:71], v18 offset:12288
  v_mfma_f32_16x16x32_bf16 v[40:43], v[160:163], v[96:99], v[40:43]
  v_mfma_f32_16x16x32_bf16 v[48:51], v[160:163], v[100:103], v[48:51]
  ds_read_b128 v[72:75], v19 offset:0
  ds_read_b128 v[76:79], v19 offset:4096
  buffer_load_dwordx4 v[224:227], v1, s[36:39], s69 offen offset:0 sc1
  s_add_u32 s69, s69, 28672
  s_waitcnt vmcnt(6) lgkmcnt(2)
  v_mfma_f32_16x16x32_bf16 v[24:27], v[168:171], v[56:59], v[24:27]
  ds_read_b128 v[80:83], v19 offset:8192
  v_mfma_f32_16x16x32_bf16 v[32:35], v[168:171], v[60:63], v[32:35]
  ds_read_b128 v[84:87], v19 offset:12288
  v_mfma_f32_16x16x32_bf16 v[40:43], v[168:171], v[64:67], v[40:43]
  v_mfma_f32_16x16x32_bf16 v[48:51], v[168:171], v[68:71], v[48:51]
  s_barrier
  ds_read_b128 v[88:91], v12 offset:0
  ds_read_b128 v[92:95], v12 offset:4096
  buffer_load_dwordx4 v[232:235], v1, s[36:39], s70 offen offset:0 sc1
  s_add_u32 s70, s70, 28672
  s_waitcnt vmcnt(6) lgkmcnt(2)
  v_mfma_f32_16x16x32_bf16 v[24:27], v[176:179], v[72:75], v[24:27]
  ds_read_b128 v[96:99], v12 offset:8192
  buffer_load_dwordx2 v[104:105], v7, s[36:39], s64 offen sc1
  v_mfma_f32_16x16x32_bf16 v[32:35], v[176:179], v[76:79], v[32:35]
  ds_read_b128 v[100:103], v12 offset:12288
  v_mfma_f32_16x16x32_bf16 v[40:43], v[176:179], v[80:83], v[40:43]
  v_mfma_f32_16x16x32_bf16 v[48:51], v[176:179], v[84:87], v[48:51]
  ds_read_b128 v[56:59], v13 offset:0
  ds_read_b128 v[60:63], v13 offset:4096
  buffer_load_dwordx4 v[240:243], v1, s[36:39], s71 offen offset:0 sc1
  s_add_u32 s71, s71, 28672
  s_waitcnt lgkmcnt(2)
  v_mfma_f32_16x16x32_bf16 v[24:27], v[184:187], v[88:91], v[24:27]
  ds_read_b128 v[64:67], v13 offset:8192
  buffer_load_dwordx2 v[108:109], v7, s[36:39], s65 offen sc1
  v_mfma_f32_16x16x32_bf16 v[32:35], v[184:187], v[92:95], v[32:35]
  ds_read_b128 v[68:71], v13 offset:12288
  v_mfma_f32_16x16x32_bf16 v[40:43], v[184:187], v[96:99], v[40:43]
  v_mfma_f32_16x16x32_bf16 v[48:51], v[184:187], v[100:103], v[48:51]
  ds_read_b128 v[72:75], v14 offset:0
  ds_read_b128 v[76:79], v14 offset:4096
  s_waitcnt vmcnt(7) lgkmcnt(2)
  v_mfma_f32_16x16x32_bf16 v[24:27], v[192:195], v[56:59], v[24:27]
  ds_read_b128 v[80:83], v14 offset:8192
  buffer_load_dwordx2 v[112:113], v7, s[36:39], s66 offen sc1
  v_mfma_f32_16x16x32_bf16 v[32:35], v[192:195], v[60:63], v[32:35]
  ds_read_b128 v[84:87], v14 offset:12288
  v_mfma_f32_16x16x32_bf16 v[40:43], v[192:195], v[64:67], v[40:43]
  v_mfma_f32_16x16x32_bf16 v[48:51], v[192:195], v[68:71], v[48:51]
  ds_read_b128 v[88:91], v15 offset:0
  ds_read_b128 v[92:95], v15 offset:4096
  s_waitcnt vmcnt(7) lgkmcnt(2)
  v_mfma_f32_16x16x32_bf16 v[24:27], v[200:203], v[72:75], v[24:27]
  ds_read_b128 v[96:99], v15 offset:8192
  buffer_load_dwordx2 v[116:117], v7, s[36:39], s67 offen sc1
  v_mfma_f32_16x16x32_bf16 v[32:35], v[200:203], v[76:79], v[32:35]
  ds_read_b128 v[100:103], v15 offset:12288
  v_mfma_f32_16x16x32_bf16 v[40:43], v[200:203], v[80:83], v[40:43]
  v_mfma_f32_16x16x32_bf16 v[48:51], v[200:203], v[84:87], v[48:51]
  s_barrier
  ds_read_b128 v[56:59], v12 offset:16384
  ds_read_b128 v[60:63], v12 offset:20480
  s_waitcnt vmcnt(7) lgkmcnt(2)
  v_mfma_f32_16x16x32_bf16 v[24:27], v[208:211], v[88:91], v[24:27]
  ds_read_b128 v[64:67], v12 offset:24576
  v_mfma_f32_16x16x32_bf16 v[32:35], v[208:211], v[92:95], v[32:35]
  ds_read_b128 v[68:71], v12 offset:28672
  v_mfma_f32_16x16x32_bf16 v[40:43], v[208:211], v[96:99], v[40:43]
  v_mfma_f32_16x16x32_bf16 v[48:51], v[208:211], v[100:103], v[48:51]
  ds_read_b128 v[72:75], v13 offset:16384
  ds_read_b128 v[76:79], v13 offset:20480
  s_waitcnt lgkmcnt(2)
  v_mfma_f32_16x16x32_bf16 v[24:27], v[216:219], v[56:59], v[24:27]
  ds_read_b128 v[80:83], v13 offset:24576
  v_mfma_f32_16x16x32_bf16 v[32:35], v[216:219], v[60:63], v[32:35]
  ds_read_b128 v[84:87], v13 offset:28672
  v_mfma_f32_16x16x32_bf16 v[40:43], v[216:219], v[64:67], v[40:43]
  v_mfma_f32_16x16x32_bf16 v[48:51], v[216:219], v[68:71], v[48:51]
  ds_read_b128 v[88:91], v14 offset:16384
  ds_read_b128 v[92:95], v14 offset:20480
  s_waitcnt vmcnt(6) lgkmcnt(2)
  v_mfma_f32_16x16x32_bf16 v[24:27], v[224:227], v[72:75], v[24:27]
  ds_read_b128 v[96:99], v14 offset:24576
  v_mfma_f32_16x16x32_bf16 v[32:35], v[224:227], v[76:79], v[32:35]
  ds_read_b128 v[100:103], v14 offset:28672
  v_mfma_f32_16x16x32_bf16 v[40:43], v[224:227], v[80:83], v[40:43]
  v_mfma_f32_16x16x32_bf16 v[48:51], v[224:227], v[84:87], v[48:51]
  ds_read_b128 v[56:59], v15 offset:16384
  ds_read_b128 v[60:63], v15 offset:20480
  s_waitcnt vmcnt(5) lgkmcnt(2)
  v_mfma_f32_16x16x32_bf16 v[24:27], v[232:235], v[88:91], v[24:27]
  ds_read_b128 v[64:67], v15 offset:24576
  v_mfma_f32_16x16x32_bf16 v[32:35], v[232:235], v[92:95], v[32:35]
  ds_read_b128 v[68:71], v15 offset:28672
  v_mfma_f32_16x16x32_bf16 v[40:43], v[232:235], v[96:99], v[40:43]
  v_mfma_f32_16x16x32_bf16 v[48:51], v[232:235], v[100:103], v[48:51]
  s_waitcnt vmcnt(3) lgkmcnt(0)
  v_mfma_f32_16x16x32_bf16 v[24:27], v[240:243], v[56:59], v[24:27]
  s_barrier
  v_mfma_f32_16x16x32_bf16 v[32:35], v[240:243], v[60:63], v[32:35]
  v_mfma_f32_16x16x32_bf16 v[40:43], v[240:243], v[64:67], v[40:43]
  v_mfma_f32_16x16x32_bf16 v[48:51], v[240:243], v[68:71], v[48:51]
  s_waitcnt vmcnt(0)
  v_lshlrev_b32 v120, 16, v104
  v_and_b32 v121, 0xffff0000, v104
  v_lshlrev_b32 v122, 16, v105
  v_and_b32 v123, 0xffff0000, v105
  v_lshlrev_b32 v128, 16, v108
  v_and_b32 v129, 0xffff0000, v108
  v_lshlrev_b32 v130, 16, v109
  v_and_b32 v131, 0xffff0000, v109
  v_lshlrev_b32 v136, 16, v112
  v_and_b32 v137, 0xffff0000, v112
  v_lshlrev_b32 v138, 16, v113
  v_and_b32 v139, 0xffff0000, v113
  v_lshlrev_b32 v144, 16, v116
  v_and_b32 v145, 0xffff0000, v116
  v_lshlrev_b32 v146, 16, v117
  v_and_b32 v147, 0xffff0000, v117
  v_pk_mul_f32 v[24:25], v[24:25], v[120:121]
  v_pk_mul_f32 v[26:27], v[26:27], v[122:123]
  v_cvt_pk_bf16_f32 v56, v24, v25
  v_cvt_pk_bf16_f32 v57, v26, v27
  buffer_store_dwordx2 v[56:57], v7, s[36:39], s64 offen sc1
  v_pk_mul_f32 v[32:33], v[32:33], v[128:129]
  v_pk_mul_f32 v[34:35], v[34:35], v[130:131]
  v_cvt_pk_bf16_f32 v60, v32, v33
  v_cvt_pk_bf16_f32 v61, v34, v35
  buffer_store_dwordx2 v[60:61], v7, s[36:39], s65 offen sc1
  v_pk_mul_f32 v[40:41], v[40:41], v[136:137]
  v_pk_mul_f32 v[42:43], v[42:43], v[138:139]
  v_cvt_pk_bf16_f32 v64, v40, v41
  v_cvt_pk_bf16_f32 v65, v42, v43
  buffer_store_dwordx2 v[64:65], v7, s[36:39], s66 offen sc1
  v_pk_mul_f32 v[48:49], v[48:49], v[144:145]
  v_pk_mul_f32 v[50:51], v[50:51], v[146:147]
  v_cvt_pk_bf16_f32 v68, v48, v49
  v_cvt_pk_bf16_f32 v69, v50, v51
  buffer_store_dwordx2 v[68:69], v7, s[36:39], s67 offen sc1
L_p4_done:
  s_lshl_b32 s62, s48, 3
  s_add_u32 s62, s62, s49
  s_lshl_b32 s62, s62, 7
  s_add_u32 s62, s62, 0xb24000
  v_mov_b32 v4, 1
  v_mov_b32 v5, 0
  s_waitcnt vmcnt(0)
  s_barrier
  s_cmp_eq_u32 s3, 0
  s_cbranch_scc0 L_skip21
  s_mov_b64 exec, 1
  buffer_store_dword v4, v5, s[36:39], s62 offen sc1
  s_mov_b64 exec, -1
L_skip21:
  s_lshl_b32 s48, s4, 2
  s_and_b32 s6, s5, 3
  s_add_u32 s48, s48, s6
  s_lshr_b32 s49, s5, 2
  s_lshl_b32 s50, s48, 2
  s_add_u32 s50, s50, s3
  s_mul_i32 s52, s50, 28672
  s_add_u32 s52, s52, 0x400000
  s_lshl_b32 s6, s49, 11
  s_lshl_b32 s7, s50, 14
  s_add_u32 s6, s6, s7
  s_add_u32 s6, s6, 0x200000
  buffer_load_dwordx4 v[16:19], v1, s[36:39], s6 offen offset:0 sc1
  buffer_load_dwordx4 v[20:23], v1, s[36:39], s6 offen offset:1024 sc1
  s_add_u32 s53, s52, 3584
  s_add_u32 s54, s52, 7168
  s_add_u32 s55, s52, 10752
  s_add_u32 s56, s52, 14336
  s_add_u32 s57, s52, 17920
  s_add_u32 s58, s52, 21504
  s_add_u32 s59, s52, 25088
  v_lshlrev_b32 v6, 3, v0
  v_bfe_u32 v8, v0, 3, 2
  v_lshlrev_b32 v8, 5, v8
  v_and_b32 v4, 3, v0
  v_lshl_add_u32 v8, v4, 3, v8
  v_lshrrev_b32 v4, 2, v0
  v_lshl_add_u32 v8, v4, 7, v8
  v_xor_b32 v9, 32, v8
  v_xor_b32 v10, 64, v8
  v_xor_b32 v11, 96, v8
  v_add_u32 v12, 57344, v8
  v_add_u32 v13, 57344, v9
  v_add_u32 v14, 57344, v10
  v_add_u32 v15, 57344, v11
  v_and_b32 v4, 7, v0
  v_lshlrev_b32 v7, 10, v4
  v_bfe_u32 v4, v0, 3, 1
  v_lshl_add_u32 v7, v4, 6, v7
  v_lshl_add_u32 v7, v2, 4, v7
  s_lshl_b32 s62, s48, 10
  s_add_u32 s62, s62, 0xb24000
  s_waitcnt vmcnt(0)
  v_lshlrev_b32 v192, 16, v16
  v_and_b32 v193, 0xffff0000, v16
  v_lshlrev_b32 v194, 16, v17
  v_and_b32 v195, 0xffff0000, v17
  v_lshlrev_b32 v196, 16, v18
  v_and_b32 v197, 0xffff0000, v18
  v_lshlrev_b32 v198, 16, v19
  v_and_b32 v199, 0xffff0000, v19
  v_lshlrev_b32 v200, 16, v20
  v_and_b32 v201, 0xffff0000, v20
  v_lshlrev_b32 v202, 16, v21
  v_and_b32 v203, 0xffff0000, v21
  v_lshlrev_b32 v204, 16, v22
  v_and_b32 v205, 0xffff0000, v22
  v_lshlrev_b32 v206, 16, v23
  v_and_b32 v207, 0xffff0000, v23
  s_cmp_eq_u32 s3, 0
  s_cbranch_scc0 L_skip22
  v_lshlrev_b32 v5, 7, v0
  s_mov_b32 exec_lo, 0xff
  s_mov_b32 exec_hi, 0
  s_mov_b32 s6, 131072
L_pollS4:
  buffer_load_dword v4, v5, s[36:39], s62 offen sc1
  s_sub_u32 s6, s6, 1
  s_cbranch_scc1 L_pollxS4
  s_waitcnt vmcnt(0)
  v_cmp_eq_u32 vcc, 0, v4
  s_nop 4
  s_cbranch_vccz L_pollxS4
  s_branch L_pollS4
L_pollxS4:
  s_mov_b64 exec, -1
L_skip22:
  s_barrier
  buffer_load_dwordx4 v[32:35], v1, s[36:39], s52 offen offset:0 sc1
  buffer_load_dwordx4 v[36:39], v1, s[36:39], s52 offen offset:1024 sc1
  buffer_load_dwordx4 v[40:43], v1, s[36:39], s52 offen offset:2048 sc1
  buffer_load_dwordx4 v[44:47], v1, s[36:39], s53 offen offset:0 sc1
  buffer_load_dwordx4 v[48:51], v1, s[36:39], s53 offen offset:1024 sc1
  buffer_load_dwordx4 v[52:55], v1, s[36:39], s53 offen offset:2048 sc1
  buffer_load_dwordx2 v[56:57], v6, s[36:39], s52 offen offset:3072 sc1
  buffer_load_dwordx2 v[58:59], v6, s[36:39], s53 offen offset:3072 sc1
  buffer_load_dwordx4 v[60:63], v1, s[36:39], s54 offen offset:0 sc1
  buffer_load_dwordx4 v[64:67], v1, s[36:39], s54 offen offset:1024 sc1
  buffer_load_dwordx4 v[68:71], v1, s[36:39], s54 offen offset:2048 sc1
  ds_read_b64_tr_b16 v[144:145], v8 offset:0
  ds_read_b64_tr_b16 v[146:147], v8 offset:2048
  ds_read_b64_tr_b16 v[148:149], v9 offset:0
  ds_read_b64_tr_b16 v[150:151], v9 offset:2048
  ds_read_b64_tr_b16 v[152:153], v10 offset:0
  ds_read_b64_tr_b16 v[154:155], v10 offset:2048
  ds_read_b64_tr_b16 v[156:157], v11 offset:0
  ds_read_b64_tr_b16 v[158:159], v11 offset:2048
  ds_read_b64_tr_b16 v[160:161], v8 offset:4096
  ds_read_b64_tr_b16 v[162:163], v8 offset:6144
  ds_read_b64_tr_b16 v[164:165], v9 offset:4096
  ds_read_b64_tr_b16 v[166:167], v9 offset:6144
  ds_read_b64_tr_b16 v[168:169], v10 offset:4096
  ds_read_b64_tr_b16 v[170:171], v10 offset:6144
  ds_read_b64_tr_b16 v[172:173], v11 offset:4096
  ds_read_b64_tr_b16 v[174:175], v11 offset:6144
  ds_read_b64_tr_b16 v[176:177], v8 offset:8192
  ds_read_b64_tr_b16 v[178:179], v8 offset:10240
  buffer_load_dwordx4 v[72:75], v1, s[36:39], s55 offen offset:0 sc1
  s_waitcnt vmcnt(11) lgkmcnt(10)
  v_mfma_f32_16x16x32_bf16 v[192:195], v[144:147], v[32:35], v[192:195]
  ds_read_b64_tr_b16 v[180:181], v9 offset:8192
  ds_read_b64_tr_b16 v[182:183], v9 offset:10240
  v_mfma_f32_16x16x32_bf16 v[196:199], v[148:151], v[32:35], v[196:199]
  ds_read_b64_tr_b16 v[184:185], v10 offset:8192
  ds_read_b64_tr_b16 v[186:187], v10 offset:10240
  v_mfma_f32_16x16x32_bf16 v[200:203], v[152:155], v[32:35], v[200:203]
  ds_read_b64_tr_b16 v[188:189], v11 offset:8192
  ds_read_b64_tr_b16 v[190:191], v11 offset:10240
  v_mfma_f32_16x16x32_bf16 v[204:207], v[156:159], v[32:35], v[204:207]
  ds_read_b64_tr_b16 v[144:145], v8 offset:16384
  ds_read_b64_tr_b16 v[146:147], v8 offset:18432
  buffer_load_dwordx4 v[76:79], v1, s[36:39], s55 offen offset:1024 sc1
  s_waitcnt vmcnt(11) lgkmcnt(10)
  v_mfma_f32_16x16x32_bf16 v[192:195], v[160:163], v[36:39], v[192:195]
  ds_read_b64_tr_b16 v[148:149], v9 offset:16384
  ds_read_b64_tr_b16 v[150:151], v9 offset:18432
  v_mfma_f32_16x16x32_bf16 v[196:199], v[164:167], v[36:39], v[196:199]
  ds_read_b64_tr_b16 v[152:153], v10 offset:16384
  ds_read_b64_tr_b16 v[154:155], v10 offset:18432
  v_mfma_f32_16x16x32_bf16 v[200:203], v[168:171], v[36:39], v[200:203]
  ds_read_b64_tr_b16 v[156:157], v11 offset:16384
  ds_read_b64_tr_b16 v[158:159], v11 offset:18432
  v_mfma_f32_16x16x32_bf16 v[204:207], v[172:175], v[36:39], v[204:207]
  ds_read_b64_tr_b16 v[160:161], v8 offset:20480
  ds_read_b64_tr_b16 v[162:163], v8 offset:22528
  buffer_load_dwordx4 v[80:83], v1, s[36:39], s55 offen offset:2048 sc1
  s_waitcnt vmcnt(11) lgkmcnt(10)
  v_mfma_f32_16x16x32_bf16 v[192:195], v[176:179], v[40:43], v[192:195]
  ds_read_b64_tr_b16 v[164:165], v9 offset:20480
  ds_read_b64_tr_b16 v[166:167], v9 offset:22528
  v_mfma_f32_16x16x32_bf16 v[196:199], v[180:183], v[40:43], v[196:199]
  ds_read_b64_tr_b16 v[168:169], v10 offset:20480
  ds_read_b64_tr_b16 v[170:171], v10 offset:22528
  v_mfma_f32_16x16x32_bf16 v[200:203], v[184:187], v[40:43], v[200:203]
  ds_read_b64_tr_b16 v[172:173], v11 offset:20480
  ds_read_b64_tr_b16 v[174:175], v11 offset:22528
  v_mfma_f32_16x16x32_bf16 v[204:207], v[188:191], v[40:43], v[204:207]
  ds_read_b64_tr_b16 v[176:177], v8 offset:24576
  ds_read_b64_tr_b16 v[178:179], v8 offset:26624
  buffer_load_dwordx2 v[84:85], v6, s[36:39], s54 offen offset:3072 sc1
  buffer_load_dwordx2 v[86:87], v6, s[36:39], s55 offen offset:3072 sc1
  s_waitcnt vmcnt(12) lgkmcnt(10)
  v_mfma_f32_16x16x32_bf16 v[192:195], v[144:147], v[44:47], v[192:195]
  ds_read_b64_tr_b16 v[180:181], v9 offset:24576
  ds_read_b64_tr_b16 v[182:183], v9 offset:26624
  v_mfma_f32_16x16x32_bf16 v[196:199], v[148:151], v[44:47], v[196:199]
  ds_read_b64_tr_b16 v[184:185], v10 offset:24576
  ds_read_b64_tr_b16 v[186:187], v10 offset:26624
  v_mfma_f32_16x16x32_bf16 v[200:203], v[152:155], v[44:47], v[200:203]
  ds_read_b64_tr_b16 v[188:189], v11 offset:24576
  ds_read_b64_tr_b16 v[190:191], v11 offset:26624
  v_mfma_f32_16x16x32_bf16 v[204:207], v[156:159], v[44:47], v[204:207]
  ds_read_b64_tr_b16 v[144:145], v8 offset:12288
  ds_read_b64_tr_b16 v[146:147], v8 offset:14336
  buffer_load_dwordx4 v[88:91], v1, s[36:39], s56 offen offset:0 sc1
  s_waitcnt vmcnt(12) lgkmcnt(10)
  v_mfma_f32_16x16x32_bf16 v[192:195], v[160:163], v[48:51], v[192:195]
  ds_read_b64_tr_b16 v[148:149], v9 offset:12288
  ds_read_b64_tr_b16 v[150:151], v9 offset:14336
  v_mfma_f32_16x16x32_bf16 v[196:199], v[164:167], v[48:51], v[196:199]
  ds_read_b64_tr_b16 v[152:153], v10 offset:12288
  ds_read_b64_tr_b16 v[154:155], v10 offset:14336
  v_mfma_f32_16x16x32_bf16 v[200:203], v[168:171], v[48:51], v[200:203]
  ds_read_b64_tr_b16 v[156:157], v11 offset:12288
  ds_read_b64_tr_b16 v[158:159], v11 offset:14336
  v_mfma_f32_16x16x32_bf16 v[204:207], v[172:175], v[48:51], v[204:207]
  ds_read_b64_tr_b16 v[160:161], v8 offset:28672
  ds_read_b64_tr_b16 v[162:163], v8 offset:30720
  buffer_load_dwordx4 v[92:95], v1, s[36:39], s56 offen offset:1024 sc1
  s_waitcnt vmcnt(12) lgkmcnt(10)
  v_mfma_f32_16x16x32_bf16 v[192:195], v[176:179], v[52:55], v[192:195]
  ds_read_b64_tr_b16 v[164:165], v9 offset:28672
  ds_read_b64_tr_b16 v[166:167], v9 offset:30720
  v_mfma_f32_16x16x32_bf16 v[196:199], v[180:183], v[52:55], v[196:199]
  ds_read_b64_tr_b16 v[168:169], v10 offset:28672
  ds_read_b64_tr_b16 v[170:171], v10 offset:30720
  v_mfma_f32_16x16x32_bf16 v[200:203], v[184:187], v[52:55], v[200:203]
  ds_read_b64_tr_b16 v[172:173], v11 offset:28672
  ds_read_b64_tr_b16 v[174:175], v11 offset:30720
  v_mfma_f32_16x16x32_bf16 v[204:207], v[188:191], v[52:55], v[204:207]
  ds_read_b64_tr_b16 v[176:177], v8 offset:32768
  ds_read_b64_tr_b16 v[178:179], v8 offset:34816
  buffer_load_dwordx4 v[96:99], v1, s[36:39], s56 offen offset:2048 sc1
  s_waitcnt vmcnt(11) lgkmcnt(10)
  v_mfma_f32_16x16x32_bf16 v[192:195], v[144:147], v[56:59], v[192:195]
  ds_read_b64_tr_b16 v[180:181], v9 offset:32768
  ds_read_b64_tr_b16 v[182:183], v9 offset:34816
  v_mfma_f32_16x16x32_bf16 v[196:199], v[148:151], v[56:59], v[196:199]
  ds_read_b64_tr_b16 v[184:185], v10 offset:32768
  ds_read_b64_tr_b16 v[186:187], v10 offset:34816
  v_mfma_f32_16x16x32_bf16 v[200:203], v[152:155], v[56:59], v[200:203]
  ds_read_b64_tr_b16 v[188:189], v11 offset:32768
  ds_read_b64_tr_b16 v[190:191], v11 offset:34816
  v_mfma_f32_16x16x32_bf16 v[204:207], v[156:159], v[56:59], v[204:207]
  ds_read_b64_tr_b16 v[144:145], v8 offset:36864
  ds_read_b64_tr_b16 v[146:147], v8 offset:38912
  buffer_load_dwordx4 v[100:103], v1, s[36:39], s57 offen offset:0 sc1
  s_waitcnt vmcnt(11) lgkmcnt(10)
  v_mfma_f32_16x16x32_bf16 v[192:195], v[160:163], v[60:63], v[192:195]
  ds_read_b64_tr_b16 v[148:149], v9 offset:36864
  ds_read_b64_tr_b16 v[150:151], v9 offset:38912
  v_mfma_f32_16x16x32_bf16 v[196:199], v[164:167], v[60:63], v[196:199]
  ds_read_b64_tr_b16 v[152:153], v10 offset:36864
  ds_read_b64_tr_b16 v[154:155], v10 offset:38912
  v_mfma_f32_16x16x32_bf16 v[200:203], v[168:171], v[60:63], v[200:203]
  ds_read_b64_tr_b16 v[156:157], v11 offset:36864
  ds_read_b64_tr_b16 v[158:159], v11 offset:38912
  v_mfma_f32_16x16x32_bf16 v[204:207], v[172:175], v[60:63], v[204:207]
  ds_read_b64_tr_b16 v[160:161], v8 offset:43008
  ds_read_b64_tr_b16 v[162:163], v8 offset:45056
  buffer_load_dwordx4 v[104:107], v1, s[36:39], s57 offen offset:1024 sc1
  s_waitcnt vmcnt(11) lgkmcnt(10)
  v_mfma_f32_16x16x32_bf16 v[192:195], v[176:179], v[64:67], v[192:195]
  ds_read_b64_tr_b16 v[164:165], v9 offset:43008
  ds_read_b64_tr_b16 v[166:167], v9 offset:45056
  v_mfma_f32_16x16x32_bf16 v[196:199], v[180:183], v[64:67], v[196:199]
  ds_read_b64_tr_b16 v[168:169], v10 offset:43008
  ds_read_b64_tr_b16 v[170:171], v10 offset:45056
  v_mfma_f32_16x16x32_bf16 v[200:203], v[184:187], v[64:67], v[200:203]
  ds_read_b64_tr_b16 v[172:173], v11 offset:43008
  ds_read_b64_tr_b16 v[174:175], v11 offset:45056
  v_mfma_f32_16x16x32_bf16 v[204:207], v[188:191], v[64:67], v[204:207]
  ds_read_b64_tr_b16 v[176:177], v8 offset:49152
  ds_read_b64_tr_b16 v[178:179], v8 offset:51200
  buffer_load_dwordx4 v[108:111], v1, s[36:39], s57 offen offset:2048 sc1
  s_waitcnt vmcnt(11) lgkmcnt(10)
  v_mfma_f32_16x16x32_bf16 v[192:195], v[144:147], v[68:71], v[192:195]
  ds_read_b64_tr_b16 v[180:181], v9 offset:49152
  ds_read_b64_tr_b16 v[182:183], v9 offset:51200
  v_mfma_f32_16x16x32_bf16 v[196:199], v[148:151], v[68:71], v[196:199]
  ds_read_b64_tr_b16 v[184:185], v10 offset:49152
  ds_read_b64_tr_b16 v[186:187], v10 offset:51200
  v_mfma_f32_16x16x32_bf16 v[200:203], v[152:155], v[68:71], v[200:203]
  ds_read_b64_tr_b16 v[188:189], v11 offset:49152
  ds_read_b64_tr_b16 v[190:191], v11 offset:51200
  v_mfma_f32_16x16x32_bf16 v[204:207], v[156:159], v[68:71], v[204:207]
  ds_read_b64_tr_b16 v[144:145], v8 offset:53248
  ds_read_b64_tr_b16 v[146:147], v8 offset:55296
  buffer_load_dwordx2 v[112:113], v6, s[36:39], s56 offen offset:3072 sc1
  buffer_load_dwordx2 v[114:115], v6, s[36:39], s57 offen offset:3072 sc1
  s_waitcnt vmcnt(12) lgkmcnt(10)
  v_mfma_f32_16x16x32_bf16 v[192:195], v[160:163], v[72:75], v[192:195]
  ds_read_b64_tr_b16 v[148:149], v9 offset:53248
  ds_read_b64_tr_b16 v[150:151], v9 offset:55296
  v_mfma_f32_16x16x32_bf16 v[196:199], v[164:167], v[72:75], v[196:199]
  ds_read_b64_tr_b16 v[152:153], v10 offset:53248
  ds_read_b64_tr_b16 v[154:155], v10 offset:55296
  v_mfma_f32_16x16x32_bf16 v[200:203], v[168:171], v[72:75], v[200:203]
  ds_read_b64_tr_b16 v[156:157], v11 offset:53248
  ds_read_b64_tr_b16 v[158:159], v11 offset:55296
  v_mfma_f32_16x16x32_bf16 v[204:207], v[172:175], v[72:75], v[204:207]
  ds_read_b64_tr_b16 v[160:161], v8 offset:40960
  ds_read_b64_tr_b16 v[162:163], v8 offset:47104
  buffer_load_dwordx4 v[116:119], v1, s[36:39], s58 offen offset:0 sc1
  s_waitcnt vmcnt(12) lgkmcnt(10)
  v_mfma_f32_16x16x32_bf16 v[192:195], v[176:179], v[76:79], v[192:195]
  ds_read_b64_tr_b16 v[164:165], v9 offset:40960
  ds_read_b64_tr_b16 v[166:167], v9 offset:47104
  v_mfma_f32_16x16x32_bf16 v[196:199], v[180:183], v[76:79], v[196:199]
  ds_read_b64_tr_b16 v[168:169], v10 offset:40960
  ds_read_b64_tr_b16 v[170:171], v10 offset:47104
  v_mfma_f32_16x16x32_bf16 v[200:203], v[184:187], v[76:79], v[200:203]
  ds_read_b64_tr_b16 v[172:173], v11 offset:40960
  ds_read_b64_tr_b16 v[174:175], v11 offset:47104
  v_mfma_f32_16x16x32_bf16 v[204:207], v[188:191], v[76:79], v[204:207]
  ds_read_b64_tr_b16 v[176:177], v12 offset:0
  ds_read_b64_tr_b16 v[178:179], v12 offset:2048
  buffer_load_dwordx4 v[120:123], v1, s[36:39], s58 offen offset:1024 sc1
  s_waitcnt vmcnt(12) lgkmcnt(10)
  v_mfma_f32_16x16x32_bf16 v[192:195], v[144:147], v[80:83], v[192:195]
  ds_read_b64_tr_b16 v[180:181], v13 offset:0
  ds_read_b64_tr_b16 v[182:183], v13 offset:2048
  v_mfma_f32_16x16x32_bf16 v[196:199], v[148:151], v[80:83], v[196:199]
  ds_read_b64_tr_b16 v[184:185], v14 offset:0
  ds_read_b64_tr_b16 v[186:187], v14 offset:2048
  v_mfma_f32_16x16x32_bf16 v[200:203], v[152:155], v[80:83], v[200:203]
  ds_read_b64_tr_b16 v[188:189], v15 offset:0
  ds_read_b64_tr_b16 v[190:191], v15 offset:2048
  v_mfma_f32_16x16x32_bf16 v[204:207], v[156:159], v[80:83], v[204:207]
  ds_read_b64_tr_b16 v[144:145], v12 offset:4096
  ds_read_b64_tr_b16 v[146:147], v12 offset:6144
  buffer_load_dwordx4 v[124:127], v1, s[36:39], s58 offen offset:2048 sc1
  s_waitcnt vmcnt(11) lgkmcnt(10)
  v_mfma_f32_16x16x32_bf16 v[192:195], v[160:163], v[84:87], v[192:195]
  ds_read_b64_tr_b16 v[148:149], v13 offset:4096
  ds_read_b64_tr_b16 v[150:151], v13 offset:6144
  v_mfma_f32_16x16x32_bf16 v[196:199], v[164:167], v[84:87], v[196:199]
  ds_read_b64_tr_b16 v[152:153], v14 offset:4096
  ds_read_b64_tr_b16 v[154:155], v14 offset:6144
  v_mfma_f32_16x16x32_bf16 v[200:203], v[168:171], v[84:87], v[200:203]
  ds_read_b64_tr_b16 v[156:157], v15 offset:4096
  ds_read_b64_tr_b16 v[158:159], v15 offset:6144
  v_mfma_f32_16x16x32_bf16 v[204:207], v[172:175], v[84:87], v[204:207]
  ds_read_b64_tr_b16 v[160:161], v12 offset:8192
  ds_read_b64_tr_b16 v[162:163], v12 offset:10240
  buffer_load_dwordx4 v[128:131], v1, s[36:39], s59 offen offset:0 sc1
  s_waitcnt vmcnt(11) lgkmcnt(10)
  v_mfma_f32_16x16x32_bf16 v[192:195], v[176:179], v[88:91], v[192:195]
  ds_read_b64_tr_b16 v[164:165], v13 offset:8192
  ds_read_b64_tr_b16 v[166:167], v13 offset:10240
  v_mfma_f32_16x16x32_bf16 v[196:199], v[180:183], v[88:91], v[196:199]
  ds_read_b64_tr_b16 v[168:169], v14 offset:8192
  ds_read_b64_tr_b16 v[170:171], v14 offset:10240
  v_mfma_f32_16x16x32_bf16 v[200:203], v[184:187], v[88:91], v[200:203]
  ds_read_b64_tr_b16 v[172:173], v15 offset:8192
  ds_read_b64_tr_b16 v[174:175], v15 offset:10240
  v_mfma_f32_16x16x32_bf16 v[204:207], v[188:191], v[88:91], v[204:207]
  ds_read_b64_tr_b16 v[176:177], v12 offset:16384
  ds_read_b64_tr_b16 v[178:179], v12 offset:18432
  buffer_load_dwordx4 v[132:135], v1, s[36:39], s59 offen offset:1024 sc1
  s_waitcnt vmcnt(11) lgkmcnt(10)
  v_mfma_f32_16x16x32_bf16 v[192:195], v[144:147], v[92:95], v[192:195]
  ds_read_b64_tr_b16 v[180:181], v13 offset:16384
  ds_read_b64_tr_b16 v[182:183], v13 offset:18432
  v_mfma_f32_16x16x32_bf16 v[196:199], v[148:151], v[92:95], v[196:199]
  ds_read_b64_tr_b16 v[184:185], v14 offset:16384
  ds_read_b64_tr_b16 v[186:187], v14 offset:18432
  v_mfma_f32_16x16x32_bf16 v[200:203], v[152:155], v[92:95], v[200:203]
  ds_read_b64_tr_b16 v[188:189], v15 offset:16384
  ds_read_b64_tr_b16 v[190:191], v15 offset:18432
  v_mfma_f32_16x16x32_bf16 v[204:207], v[156:159], v[92:95], v[204:207]
  ds_read_b64_tr_b16 v[144:145], v12 offset:20480
  ds_read_b64_tr_b16 v[146:147], v12 offset:22528
  buffer_load_dwordx4 v[136:139], v1, s[36:39], s59 offen offset:2048 sc1
  s_waitcnt vmcnt(11) lgkmcnt(10)
  v_mfma_f32_16x16x32_bf16 v[192:195], v[160:163], v[96:99], v[192:195]
  ds_read_b64_tr_b16 v[148:149], v13 offset:20480
  ds_read_b64_tr_b16 v[150:151], v13 offset:22528
  v_mfma_f32_16x16x32_bf16 v[196:199], v[164:167], v[96:99], v[196:199]
  ds_read_b64_tr_b16 v[152:153], v14 offset:20480
  ds_read_b64_tr_b16 v[154:155], v14 offset:22528
  v_mfma_f32_16x16x32_bf16 v[200:203], v[168:171], v[96:99], v[200:203]
  ds_read_b64_tr_b16 v[156:157], v15 offset:20480
  ds_read_b64_tr_b16 v[158:159], v15 offset:22528
  v_mfma_f32_16x16x32_bf16 v[204:207], v[172:175], v[96:99], v[204:207]
  ds_read_b64_tr_b16 v[160:161], v12 offset:24576
  ds_read_b64_tr_b16 v[162:163], v12 offset:26624
  buffer_load_dwordx2 v[140:141], v6, s[36:39], s58 offen offset:3072 sc1
  buffer_load_dwordx2 v[142:143], v6, s[36:39], s59 offen offset:3072 sc1
  s_waitcnt vmcnt(12) lgkmcnt(10)
  v_mfma_f32_16x16x32_bf16 v[192:195], v[176:179], v[100:103], v[192:195]
  ds_read_b64_tr_b16 v[164:165], v13 offset:24576
  ds_read_b64_tr_b16 v[166:167], v13 offset:26624
  v_mfma_f32_16x16x32_bf16 v[196:199], v[180:183], v[100:103], v[196:199]
  ds_read_b64_tr_b16 v[168:169], v14 offset:24576
  ds_read_b64_tr_b16 v[170:171], v14 offset:26624
  v_mfma_f32_16x16x32_bf16 v[200:203], v[184:187], v[100:103], v[200:203]
  ds_read_b64_tr_b16 v[172:173], v15 offset:24576
  ds_read_b64_tr_b16 v[174:175], v15 offset:26624
  v_mfma_f32_16x16x32_bf16 v[204:207], v[188:191], v[100:103], v[204:207]
  ds_read_b64_tr_b16 v[176:177], v12 offset:12288
  ds_read_b64_tr_b16 v[178:179], v12 offset:14336
  s_waitcnt vmcnt(11) lgkmcnt(10)
  v_mfma_f32_16x16x32_bf16 v[192:195], v[144:147], v[104:107], v[192:195]
  ds_read_b64_tr_b16 v[180:181], v13 offset:12288
  ds_read_b64_tr_b16 v[182:183], v13 offset:14336
  v_mfma_f32_16x16x32_bf16 v[196:199], v[148:151], v[104:107], v[196:199]
  ds_read_b64_tr_b16 v[184:185], v14 offset:12288
  ds_read_b64_tr_b16 v[186:187], v14 offset:14336
  v_mfma_f32_16x16x32_bf16 v[200:203], v[152:155], v[104:107], v[200:203]
  ds_read_b64_tr_b16 v[188:189], v15 offset:12288
  ds_read_b64_tr_b16 v[190:191], v15 offset:14336
  v_mfma_f32_16x16x32_bf16 v[204:207], v[156:159], v[104:107], v[204:207]
  ds_read_b64_tr_b16 v[144:145], v12 offset:28672
  ds_read_b64_tr_b16 v[146:147], v12 offset:30720
  s_waitcnt vmcnt(10) lgkmcnt(10)
  v_mfma_f32_16x16x32_bf16 v[192:195], v[160:163], v[108:111], v[192:195]
  ds_read_b64_tr_b16 v[148:149], v13 offset:28672
  ds_read_b64_tr_b16 v[150:151], v13 offset:30720
  v_mfma_f32_16x16x32_bf16 v[196:199], v[164:167], v[108:111], v[196:199]
  ds_read_b64_tr_b16 v[152:153], v14 offset:28672
  ds_read_b64_tr_b16 v[154:155], v14 offset:30720
  v_mfma_f32_16x16x32_bf16 v[200:203], v[168:171], v[108:111], v[200:203]
  ds_read_b64_tr_b16 v[156:157], v15 offset:28672
  ds_read_b64_tr_b16 v[158:159], v15 offset:30720
  v_mfma_f32_16x16x32_bf16 v[204:207], v[172:175], v[108:111], v[204:207]
  ds_read_b64_tr_b16 v[160:161], v12 offset:32768
  ds_read_b64_tr_b16 v[162:163], v12 offset:34816
  s_waitcnt vmcnt(8) lgkmcnt(10)
  v_mfma_f32_16x16x32_bf16 v[192:195], v[176:179], v[112:115], v[192:195]
  ds_read_b64_tr_b16 v[164:165], v13 offset:32768
  ds_read_b64_tr_b16 v[166:167], v13 offset:34816
  v_mfma_f32_16x16x32_bf16 v[196:199], v[180:183], v[112:115], v[196:199]
  ds_read_b64_tr_b16 v[168:169], v14 offset:32768
  ds_read_b64_tr_b16 v[170:171], v14 offset:34816
  v_mfma_f32_16x16x32_bf16 v[200:203], v[184:187], v[112:115], v[200:203]
  ds_read_b64_tr_b16 v[172:173], v15 offset:32768
  ds_read_b64_tr_b16 v[174:175], v15 offset:34816
  v_mfma_f32_16x16x32_bf16 v[204:207], v[188:191], v[112:115], v[204:207]
  ds_read_b64_tr_b16 v[176:177], v12 offset:36864
  ds_read_b64_tr_b16 v[178:179], v12 offset:38912
  s_waitcnt vmcnt(7) lgkmcnt(10)
  v_mfma_f32_16x16x32_bf16 v[192:195], v[144:147], v[116:119], v[192:195]
  ds_read_b64_tr_b16 v[180:181], v13 offset:36864
  ds_read_b64_tr_b16 v[182:183], v13 offset:38912
  v_mfma_f32_16x16x32_bf16 v[196:199], v[148:151], v[116:119], v[196:199]
  ds_read_b64_tr_b16 v[184:185], v14 offset:36864
  ds_read_b64_tr_b16 v[186:187], v14 offset:38912
  v_mfma_f32_16x16x32_bf16 v[200:203], v[152:155], v[116:119], v[200:203]
  ds_read_b64_tr_b16 v[188:189], v15 offset:36864
  ds_read_b64_tr_b16 v[190:191], v15 offset:38912
  v_mfma_f32_16x16x32_bf16 v[204:207], v[156:159], v[116:119], v[204:207]
  ds_read_b64_tr_b16 v[144:145], v12 offset:43008
  ds_read_b64_tr_b16 v[146:147], v12 offset:45056
  s_waitcnt vmcnt(6) lgkmcnt(10)
  v_mfma_f32_16x16x32_bf16 v[192:195], v[160:163], v[120:123], v[192:195]
  ds_read_b64_tr_b16 v[148:149], v13 offset:43008
  ds_read_b64_tr_b16 v[150:151], v13 offset:45056
  v_mfma_f32_16x16x32_bf16 v[196:199], v[164:167], v[120:123], v[196:199]
  ds_read_b64_tr_b16 v[152:153], v14 offset:43008
  ds_read_b64_tr_b16 v[154:155], v14 offset:45056
  v_mfma_f32_16x16x32_bf16 v[200:203], v[168:171], v[120:123], v[200:203]
  ds_read_b64_tr_b16 v[156:157], v15 offset:43008
  ds_read_b64_tr_b16 v[158:159], v15 offset:45056
  v_mfma_f32_16x16x32_bf16 v[204:207], v[172:175], v[120:123], v[204:207]
  ds_read_b64_tr_b16 v[160:161], v12 offset:49152
  ds_read_b64_tr_b16 v[162:163], v12 offset:51200
  s_waitcnt vmcnt(5) lgkmcnt(10)
  v_mfma_f32_16x16x32_bf16 v[192:195], v[176:179], v[124:127], v[192:195]
  ds_read_b64_tr_b16 v[164:165], v13 offset:49152
  ds_read_b64_tr_b16 v[166:167], v13 offset:51200
  v_mfma_f32_16x16x32_bf16 v[196:199], v[180:183], v[124:127], v[196:199]
  ds_read_b64_tr_b16 v[168:169], v14 offset:49152
  ds_read_b64_tr_b16 v[170:171], v14 offset:51200
  v_mfma_f32_16x16x32_bf16 v[200:203], v[184:187], v[124:127], v[200:203]
  ds_read_b64_tr_b16 v[172:173], v15 offset:49152
  ds_read_b64_tr_b16 v[174:175], v15 offset:51200
  v_mfma_f32_16x16x32_bf16 v[204:207], v[188:191], v[124:127], v[204:207]
  ds_read_b64_tr_b16 v[176:177], v12 offset:53248
  ds_read_b64_tr_b16 v[178:179], v12 offset:55296
  s_waitcnt vmcnt(4) lgkmcnt(10)
  v_mfma_f32_16x16x32_bf16 v[192:195], v[144:147], v[128:131], v[192:195]
  ds_read_b64_tr_b16 v[180:181], v13 offset:53248
  ds_read_b64_tr_b16 v[182:183], v13 offset:55296
  v_mfma_f32_16x16x32_bf16 v[196:199], v[148:151], v[128:131], v[196:199]
  ds_read_b64_tr_b16 v[184:185], v14 offset:53248
  ds_read_b64_tr_b16 v[186:187], v14 offset:55296
  v_mfma_f32_16x16x32_bf16 v[200:203], v[152:155], v[128:131], v[200:203]
  ds_read_b64_tr_b16 v[188:189], v15 offset:53248
  ds_read_b64_tr_b16 v[190:191], v15 offset:55296
  v_mfma_f32_16x16x32_bf16 v[204:207], v[156:159], v[128:131], v[204:207]
  ds_read_b64_tr_b16 v[144:145], v12 offset:40960
  ds_read_b64_tr_b16 v[146:147], v12 offset:47104
  s_waitcnt vmcnt(3) lgkmcnt(10)
  v_mfma_f32_16x16x32_bf16 v[192:195], v[160:163], v[132:135], v[192:195]
  ds_read_b64_tr_b16 v[148:149], v13 offset:40960
  ds_read_b64_tr_b16 v[150:151], v13 offset:47104
  v_mfma_f32_16x16x32_bf16 v[196:199], v[164:167], v[132:135], v[196:199]
  ds_read_b64_tr_b16 v[152:153], v14 offset:40960
  ds_read_b64_tr_b16 v[154:155], v14 offset:47104
  v_mfma_f32_16x16x32_bf16 v[200:203], v[168:171], v[132:135], v[200:203]
  ds_read_b64_tr_b16 v[156:157], v15 offset:40960
  ds_read_b64_tr_b16 v[158:159], v15 offset:47104
  v_mfma_f32_16x16x32_bf16 v[204:207], v[172:175], v[132:135], v[204:207]
  s_waitcnt vmcnt(2) lgkmcnt(8)
  v_mfma_f32_16x16x32_bf16 v[192:195], v[176:179], v[136:139], v[192:195]
  v_mfma_f32_16x16x32_bf16 v[196:199], v[180:183], v[136:139], v[196:199]
  v_mfma_f32_16x16x32_bf16 v[200:203], v[184:187], v[136:139], v[200:203]
  v_mfma_f32_16x16x32_bf16 v[204:207], v[188:191], v[136:139], v[204:207]
  s_waitcnt vmcnt(0) lgkmcnt(0)
  v_mfma_f32_16x16x32_bf16 v[192:195], v[144:147], v[140:143], v[192:195]
  v_mfma_f32_16x16x32_bf16 v[196:199], v[148:151], v[140:143], v[196:199]
  v_mfma_f32_16x16x32_bf16 v[200:203], v[152:155], v[140:143], v[200:203]
  v_mfma_f32_16x16x32_bf16 v[204:207], v[156:159], v[140:143], v[204:207]
  s_lshl_b32 s6, s50, 14
  s_lshl_b32 s7, s49, 7
  s_add_u32 s6, s6, s7
  s_nop 1
  v_cvt_pk_bf16_f32 v24, v192, v193
  v_cvt_pk_bf16_f32 v25, v194, v195
  v_cvt_pk_bf16_f32 v26, v196, v197
  v_cvt_pk_bf16_f32 v27, v198, v199
  s_nop 0
  v_permlane32_swap_b32 v24, v26
  v_permlane32_swap_b32 v25, v27
  s_nop 0
  v_permlane16_swap_b32 v24, v26
  v_permlane16_swap_b32 v25, v27
  v_cvt_pk_bf16_f32 v28, v200, v201
  v_cvt_pk_bf16_f32 v29, v202, v203
  v_cvt_pk_bf16_f32 v30, v204, v205
  v_cvt_pk_bf16_f32 v31, v206, v207
  s_nop 0
  v_permlane32_swap_b32 v28, v30
  v_permlane32_swap_b32 v29, v31
  s_nop 0
  v_permlane16_swap_b32 v28, v30
  v_permlane16_swap_b32 v29, v31
  v_mov_b32 v32, v24
  v_mov_b32 v33, v25
  v_mov_b32 v34, v26
  v_mov_b32 v35, v27
  v_mov_b32_dpp v24, v28 row_ror:8 row_mask:0xf bank_mask:0xc
  v_mov_b32_dpp v25, v29 row_ror:8 row_mask:0xf bank_mask:0xc
  v_mov_b32_dpp v26, v30 row_ror:8 row_mask:0xf bank_mask:0xc
  v_mov_b32_dpp v27, v31 row_ror:8 row_mask:0xf bank_mask:0xc
  buffer_store_dwordx4 v[24:27], v7, s[32:35], s6 offen sc0 sc1
  v_mov_b32_dpp v28, v32 row_ror:8 row_mask:0xf bank_mask:0x3
  v_mov_b32_dpp v29, v33 row_ror:8 row_mask:0xf bank_mask:0x3
  v_mov_b32_dpp v30, v34 row_ror:8 row_mask:0xf bank_mask:0x3
  v_mov_b32_dpp v31, v35 row_ror:8 row_mask:0xf bank_mask:0x3
  s_add_u32 s6, s6, 8192
  buffer_store_dwordx4 v[28:31], v7, s[32:35], s6 offen sc0 sc1
  s_branch L_end
L_loader:
  s_sub_u32 s3, s3, 4
  v_lshrrev_b32 v6, 3, v0
  v_and_b32 v7, 7, v0
  v_and_b32 v5, 2, v6
  v_xor_b32 v5, v5, v7
  v_mul_u32_u24 v10, 3072, v6
  v_lshl_add_u32 v10, v5, 4, v10
  v_xor_b32 v11, 64, v10
  v_add_u32 v11, 24576, v11
  s_mul_i32 s50, s3, 49152
  s_lshl_b32 s6, s71, 7
  s_add_u32 s50, s50, s6
  s_lshl_b32 s51, s3, 11
  s_add_u32 s51, s51, 0x10000
  v_mov_b32 v248, 0
  s_lshl_b32 s52, s2, 2
  s_add_u32 s52, s52, s3
  s_getpc_b64 s[58:59]
L_pc:
  s_sub_u32 s88, s58, L_pc-sequential_preLN__linear_attn_block__mixer_gmlp__prompt_kernel
  s_subb_u32 s89, s59, 0
  s_lshl_b32 s6, s5, 2
  s_add_u32 s6, s6, s3
  s_lshl_b32 s6, s6, 9
  v_and_b32 v247, 3, v0
  v_lshlrev_b32 v247, 7, v247
  v_add_u32 v247, s6, v247
  v_min_u32 v247, L_code_end-sequential_preLN__linear_attn_block__mixer_gmlp__prompt_kernel-4, v247
  s_mov_b64 exec, 15
  global_load_dword v250, v247, s[88:89]
  s_mov_b64 exec, -1
  s_barrier
  s_cmp_eq_u32 s3, 3
  s_cbranch_scc0 L_skip23
  s_sub_u32 s6, s2, 128
  s_cmp_lt_u32 s6, 124
  s_cbranch_scc0 L_skip24
  v_mov_b32 v27, 1
  s_waitcnt vmcnt(0)
  s_mov_b64 exec, 1
  buffer_atomic_add v27, v248, s[44:47], 0 offen
  s_mov_b64 exec, -1
L_skip24:
L_skip23:
  s_add_u32 s53, s70, 0
  s_and_b32 s53, s53, 7
  s_mul_i32 s53, s53, 196608
  s_add_u32 s53, s53, s50
  s_add_u32 m0, s51, 0
  s_nop 0
  buffer_load_dwordx4 v10, s[12:15], s53 offen offset:0  lds
  s_add_u32 m0, s51, 1024
  s_nop 0
  buffer_load_dwordx4 v11, s[12:15], s53 offen offset:0  lds
  s_add_u32 m0, s51, 7168
  s_nop 0
  buffer_load_dwordx4 v10, s[12:15], s53 offen offset:1024  lds
  s_add_u32 m0, s51, 8192
  s_nop 0
  buffer_load_dwordx4 v11, s[12:15], s53 offen offset:1024  lds
  s_add_u32 m0, s51, 14336
  s_nop 0
  buffer_load_dwordx4 v10, s[12:15], s53 offen offset:2048  lds
  s_add_u32 m0, s51, 15360
  s_nop 0
  buffer_load_dwordx4 v11, s[12:15], s53 offen offset:2048  lds
  s_add_u32 s53, s70, 1
  s_and_b32 s53, s53, 7
  s_mul_i32 s53, s53, 196608
  s_add_u32 s53, s53, s50
  s_add_u32 m0, s51, 24576
  s_nop 0
  buffer_load_dwordx4 v10, s[12:15], s53 offen offset:0  lds
  s_add_u32 m0, s51, 25600
  s_nop 0
  buffer_load_dwordx4 v11, s[12:15], s53 offen offset:0  lds
  s_add_u32 m0, s51, 31744
  s_nop 0
  buffer_load_dwordx4 v10, s[12:15], s53 offen offset:1024  lds
  s_add_u32 m0, s51, 32768
  s_nop 0
  buffer_load_dwordx4 v11, s[12:15], s53 offen offset:1024  lds
  s_add_u32 m0, s51, 38912
  s_nop 0
  buffer_load_dwordx4 v10, s[12:15], s53 offen offset:2048  lds
  s_add_u32 m0, s51, 39936
  s_nop 0
  buffer_load_dwordx4 v11, s[12:15], s53 offen offset:2048  lds
  s_mul_i32 s6, s52, 512
  s_add_u32 s72, s16, s6
  s_addc_u32 s73, s17, 0
  s_mov_b32 s74, 512
  s_mov_b32 s75, 0x20000
  s_mul_i32 s6, s52, 1792
  s_add_u32 s76, s20, s6
  s_addc_u32 s77, s21, 0
  s_mov_b32 s78, 1792
  s_mov_b32 s79, 0x20000
  v_lshlrev_b32 v249, 7, v0
  s_mul_i32 s6, s52, 512
  s_mov_b64 exec, 15
  buffer_load_dword v250, v249, s[16:19], s6 offen
  s_mul_i32 s6, s52, 1792
  s_mov_b64 exec, 0x3fff
  buffer_load_dword v250, v249, s[20:23], s6 offen
  s_mov_b64 exec, -1
  s_waitcnt vmcnt(8)
  s_barrier
  s_add_u32 s53, s70, 2
  s_and_b32 s53, s53, 7
  s_mul_i32 s53, s53, 196608
  s_add_u32 s53, s53, s50
  s_add_u32 m0, s51, 49152
  s_nop 0
  buffer_load_dwordx4 v10, s[12:15], s53 offen offset:0  lds
  s_add_u32 m0, s51, 50176
  s_nop 0
  buffer_load_dwordx4 v11, s[12:15], s53 offen offset:0  lds
  s_add_u32 m0, s51, 56320
  s_nop 0
  buffer_load_dwordx4 v10, s[12:15], s53 offen offset:1024  lds
  s_add_u32 m0, s51, 57344
  s_nop 0
  buffer_load_dwordx4 v11, s[12:15], s53 offen offset:1024  lds
  s_add_u32 m0, s51, 63488
  s_nop 0
  buffer_load_dwordx4 v10, s[12:15], s53 offen offset:2048  lds
  s_add_u32 m0, s51, 64512
  s_nop 0
  buffer_load_dwordx4 v11, s[12:15], s53 offen offset:2048  lds
  s_waitcnt vmcnt(8)
  s_barrier
  s_add_u32 s53, s70, 3
  s_and_b32 s53, s53, 7
  s_mul_i32 s53, s53, 196608
  s_add_u32 s53, s53, s50
  s_add_u32 m0, s51, 73728
  s_nop 0
  buffer_load_dwordx4 v10, s[12:15], s53 offen offset:0  lds
  s_add_u32 m0, s51, 74752
  s_nop 0
  buffer_load_dwordx4 v11, s[12:15], s53 offen offset:0  lds
  s_add_u32 m0, s51, 80896
  s_nop 0
  buffer_load_dwordx4 v10, s[12:15], s53 offen offset:1024  lds
  s_add_u32 m0, s51, 81920
  s_nop 0
  buffer_load_dwordx4 v11, s[12:15], s53 offen offset:1024  lds
  s_add_u32 m0, s51, 88064
  s_nop 0
  buffer_load_dwordx4 v10, s[12:15], s53 offen offset:2048  lds
  s_add_u32 m0, s51, 89088
  s_nop 0
  buffer_load_dwordx4 v11, s[12:15], s53 offen offset:2048  lds
  s_waitcnt vmcnt(6)
  s_barrier
  s_add_u32 s53, s70, 4
  s_and_b32 s53, s53, 7
  s_mul_i32 s53, s53, 196608
  s_add_u32 s53, s53, s50
  s_add_u32 m0, s51, 0
  s_nop 0
  buffer_load_dwordx4 v10, s[12:15], s53 offen offset:0  lds
  s_add_u32 m0, s51, 1024
  s_nop 0
  buffer_load_dwordx4 v11, s[12:15], s53 offen offset:0  lds
  s_add_u32 m0, s51, 7168
  s_nop 0
  buffer_load_dwordx4 v10, s[12:15], s53 offen offset:1024  lds
  s_add_u32 m0, s51, 8192
  s_nop 0
  buffer_load_dwordx4 v11, s[12:15], s53 offen offset:1024  lds
  s_add_u32 m0, s51, 14336
  s_nop 0
  buffer_load_dwordx4 v10, s[12:15], s53 offen offset:2048  lds
  s_add_u32 m0, s51, 15360
  s_nop 0
  buffer_load_dwordx4 v11, s[12:15], s53 offen offset:2048  lds
  s_waitcnt vmcnt(6)
  s_barrier
  s_add_u32 s53, s70, 5
  s_and_b32 s53, s53, 7
  s_mul_i32 s53, s53, 196608
  s_add_u32 s53, s53, s50
  s_add_u32 m0, s51, 24576
  s_nop 0
  buffer_load_dwordx4 v10, s[12:15], s53 offen offset:0  lds
  s_add_u32 m0, s51, 25600
  s_nop 0
  buffer_load_dwordx4 v11, s[12:15], s53 offen offset:0  lds
  s_add_u32 m0, s51, 31744
  s_nop 0
  buffer_load_dwordx4 v10, s[12:15], s53 offen offset:1024  lds
  s_add_u32 m0, s51, 32768
  s_nop 0
  buffer_load_dwordx4 v11, s[12:15], s53 offen offset:1024  lds
  s_add_u32 m0, s51, 38912
  s_nop 0
  buffer_load_dwordx4 v10, s[12:15], s53 offen offset:2048  lds
  s_add_u32 m0, s51, 39936
  s_nop 0
  buffer_load_dwordx4 v11, s[12:15], s53 offen offset:2048  lds
  s_waitcnt vmcnt(6)
  s_barrier
  s_add_u32 s53, s70, 6
  s_and_b32 s53, s53, 7
  s_mul_i32 s53, s53, 196608
  s_add_u32 s53, s53, s50
  s_add_u32 m0, s51, 49152
  s_nop 0
  buffer_load_dwordx4 v10, s[12:15], s53 offen offset:0  lds
  s_add_u32 m0, s51, 50176
  s_nop 0
  buffer_load_dwordx4 v11, s[12:15], s53 offen offset:0  lds
  s_add_u32 m0, s51, 56320
  s_nop 0
  buffer_load_dwordx4 v10, s[12:15], s53 offen offset:1024  lds
  s_add_u32 m0, s51, 57344
  s_nop 0
  buffer_load_dwordx4 v11, s[12:15], s53 offen offset:1024  lds
  s_add_u32 m0, s51, 63488
  s_nop 0
  buffer_load_dwordx4 v10, s[12:15], s53 offen offset:2048  lds
  s_add_u32 m0, s51, 64512
  s_nop 0
  buffer_load_dwordx4 v11, s[12:15], s53 offen offset:2048  lds
  s_waitcnt vmcnt(6)
  s_barrier
  s_add_u32 s53, s70, 7
  s_and_b32 s53, s53, 7
  s_mul_i32 s53, s53, 196608
  s_add_u32 s53, s53, s50
  s_add_u32 m0, s51, 73728
  s_nop 0
  buffer_load_dwordx4 v10, s[12:15], s53 offen offset:0  lds
  s_add_u32 m0, s51, 74752
  s_nop 0
  buffer_load_dwordx4 v11, s[12:15], s53 offen offset:0  lds
  s_add_u32 m0, s51, 80896
  s_nop 0
  buffer_load_dwordx4 v10, s[12:15], s53 offen offset:1024  lds
  s_add_u32 m0, s51, 81920
  s_nop 0
  buffer_load_dwordx4 v11, s[12:15], s53 offen offset:1024  lds
  s_add_u32 m0, s51, 88064
  s_nop 0
  buffer_load_dwordx4 v10, s[12:15], s53 offen offset:2048  lds
  s_add_u32 m0, s51, 89088
  s_nop 0
  buffer_load_dwordx4 v11, s[12:15], s53 offen offset:2048  lds
  buffer_load_dword v26, v248, s[44:47], 0 offen sc1
  v_lshlrev_b32 v5, 1, v2
  v_xor_b32 v4, v3, v5
  v_mul_u32_u24 v24, 1024, v2
  v_lshl_add_u32 v24, v4, 4, v24
  v_xor_b32 v25, 128, v24
  v_add_u32 v25, 4096, v25
  s_lshl_b32 s56, s3, 13
  s_lshr_b32 s6, s5, 3
  s_lshl_b32 s6, s6, 8
  s_add_u32 s56, s56, s6
  s_add_u32 s6, s56, 0
  buffer_load_dwordx4 v[28:31], v24, s[16:19], s6 offen
  buffer_load_dwordx4 v[32:35], v25, s[16:19], s6 offen
  s_add_u32 s6, s56, 32768
  buffer_load_dwordx4 v[36:39], v24, s[16:19], s6 offen
  buffer_load_dwordx4 v[40:43], v25, s[16:19], s6 offen
  s_add_u32 s6, s56, 65536
  buffer_load_dwordx4 v[44:47], v24, s[16:19], s6 offen
  buffer_load_dwordx4 v[48:51], v25, s[16:19], s6 offen
  s_add_u32 s6, s56, 98304
  buffer_load_dwordx4 v[52:55], v24, s[16:19], s6 offen
  buffer_load_dwordx4 v[56:59], v25, s[16:19], s6 offen
  s_waitcnt vmcnt(15)
  s_barrier
  s_waitcnt vmcnt(8)
  v_readfirstlane_b32 s54, v26
  s_add_u32 s6, s56, 131072
  buffer_load_dwordx4 v[60:63], v24, s[16:19], s6 offen
  buffer_load_dwordx4 v[64:67], v25, s[16:19], s6 offen
  s_add_u32 s6, s56, 163840
  buffer_load_dwordx4 v[68:71], v24, s[16:19], s6 offen
  buffer_load_dwordx4 v[72:75], v25, s[16:19], s6 offen
  s_add_u32 s6, s56, 196608
  buffer_load_dwordx4 v[76:79], v24, s[16:19], s6 offen
  buffer_load_dwordx4 v[80:83], v25, s[16:19], s6 offen
  s_add_u32 s6, s56, 229376
  buffer_load_dwordx4 v[84:87], v24, s[16:19], s6 offen
  buffer_load_dwordx4 v[88:91], v25, s[16:19], s6 offen
  s_barrier
  s_add_u32 s6, s56, 262144
  buffer_load_dwordx4 v[92:95], v24, s[16:19], s6 offen
  buffer_load_dwordx4 v[96:99], v25, s[16:19], s6 offen
  s_add_u32 s6, s56, 294912
  buffer_load_dwordx4 v[100:103], v24, s[16:19], s6 offen
  buffer_load_dwordx4 v[104:107], v25, s[16:19], s6 offen
  s_add_u32 s6, s56, 327680
  buffer_load_dwordx4 v[108:111], v24, s[16:19], s6 offen
  buffer_load_dwordx4 v[112:115], v25, s[16:19], s6 offen
  s_add_u32 s6, s56, 360448
  buffer_load_dwordx4 v[116:119], v24, s[16:19], s6 offen
  buffer_load_dwordx4 v[120:123], v25, s[16:19], s6 offen
  s_cmp_lt_u32 s54, 124
  s_cbranch_scc0 L_skip25
  s_mov_b32 s6, 131072
L_zpoll:
  buffer_load_dword v4, v248, s[44:47], 0 offen sc1
  s_sub_u32 s6, s6, 1
  s_cbranch_scc1 L_zpollx
  s_waitcnt vmcnt(0)
  v_cmp_gt_u32 vcc, 124, v4
  s_nop 4
  s_cbranch_vccnz L_zpoll
L_zpollx:
L_skip25:
  s_barrier
  s_add_u32 s6, s56, 393216
  buffer_load_dwordx4 v[124:127], v24, s[16:19], s6 offen
  buffer_load_dwordx4 v[128:131], v25, s[16:19], s6 offen
  s_add_u32 s6, s56, 425984
  buffer_load_dwordx4 v[132:135], v24, s[16:19], s6 offen
  buffer_load_dwordx4 v[136:139], v25, s[16:19], s6 offen
  s_add_u32 s6, s56, 458752
  buffer_load_dwordx4 v[140:143], v24, s[16:19], s6 offen
  buffer_load_dwordx4 v[144:147], v25, s[16:19], s6 offen
  s_add_u32 s6, s56, 491520
  buffer_load_dwordx4 v[148:151], v24, s[16:19], s6 offen
  buffer_load_dwordx4 v[152:155], v25, s[16:19], s6 offen
  s_lshl_b32 s6, s3, 11
  v_add_u32 v4, s6, v1
  v_add_u32 v5, 0x10000, v4
  s_waitcnt vmcnt(30)
  ds_write_b128 v4, v[28:31] offset:0
  ds_write_b128 v4, v[32:35] offset:1024
  s_waitcnt vmcnt(28)
  ds_write_b128 v4, v[36:39] offset:8192
  ds_write_b128 v4, v[40:43] offset:9216
  s_waitcnt vmcnt(26)
  ds_write_b128 v4, v[44:47] offset:16384
  ds_write_b128 v4, v[48:51] offset:17408
  s_waitcnt vmcnt(24)
  ds_write_b128 v4, v[52:55] offset:24576
  ds_write_b128 v4, v[56:59] offset:25600
  s_waitcnt vmcnt(22)
  ds_write_b128 v4, v[60:63] offset:32768
  ds_write_b128 v4, v[64:67] offset:33792
  s_waitcnt vmcnt(20)
  ds_write_b128 v4, v[68:71] offset:40960
  ds_write_b128 v4, v[72:75] offset:41984
  s_waitcnt vmcnt(18)
  ds_write_b128 v4, v[76:79] offset:49152
  ds_write_b128 v4, v[80:83] offset:50176
  s_waitcnt vmcnt(16)
  ds_write_b128 v4, v[84:87] offset:57344
  ds_write_b128 v4, v[88:91] offset:58368
  s_waitcnt vmcnt(14)
  ds_write_b128 v5, v[92:95] offset:0
  ds_write_b128 v5, v[96:99] offset:1024
  s_waitcnt vmcnt(12)
  ds_write_b128 v5, v[100:103] offset:8192
  ds_write_b128 v5, v[104:107] offset:9216
  s_waitcnt vmcnt(10)
  ds_write_b128 v5, v[108:111] offset:16384
  ds_write_b128 v5, v[112:115] offset:17408
  s_waitcnt vmcnt(8)
  ds_write_b128 v5, v[116:119] offset:24576
  ds_write_b128 v5, v[120:123] offset:25600
  s_waitcnt vmcnt(6)
  ds_write_b128 v5, v[124:127] offset:32768
  ds_write_b128 v5, v[128:131] offset:33792
  s_waitcnt vmcnt(4)
  ds_write_b128 v5, v[132:135] offset:40960
  ds_write_b128 v5, v[136:139] offset:41984
  s_waitcnt vmcnt(2)
  ds_write_b128 v5, v[140:143] offset:49152
  ds_write_b128 v5, v[144:147] offset:50176
  s_waitcnt vmcnt(0)
  ds_write_b128 v5, v[148:151] offset:57344
  ds_write_b128 v5, v[152:155] offset:58368
  s_lshl_b32 s57, s3, 11
  v_mov_b32 v22, v24
  v_mov_b32 v23, v25
  s_mov_b64 exec, 15
  global_load_dword v250, v247, s[88:89]
  s_mov_b64 exec, -1
  s_barrier
  s_waitcnt lgkmcnt(0)
  s_lshr_b32 s48, s4, 1
  s_lshl_b32 s48, s48, 2
  s_and_b32 s6, s5, 3
  s_add_u32 s48, s48, s6
  s_and_b32 s49, s4, 1
  s_lshl_b32 s49, s49, 3
  s_lshr_b32 s6, s5, 2
  s_add_u32 s49, s49, s6
  s_lshr_b32 s6, s49, 1
  s_mul_i32 s6, s6, 224
  s_and_b32 s6, s6, 0xffffffc0
  s_mul_i32 s50, s3, 28672
  s_add_u32 s50, s50, s6
  v_and_b32 v4, 7, v0
  v_lshlrev_b32 v5, 1, v2
  v_xor_b32 v4, v4, v5
  v_lshrrev_b32 v26, 2, v4
  v_lshrrev_b32 v5, 3, v0
  v_mul_u32_u24 v5, 3584, v5
  v_lshl_add_u32 v4, v4, 4, v5
  s_bfe_u32 s6, s49, 0x20001
  s_lshl_b32 s6, s6, 3
  s_lshr_b32 s52, 0x80404000, s6
  s_and_b32 s52, s52, 0xff
  s_lshr_b32 s53, 0x00000080, s6
  s_and_b32 s53, s53, 0xff
  s_lshr_b32 s54, 0x00808000, s6
  s_and_b32 s54, s54, 0xff
  v_mul_u32_u24 v26, s54, v26
  v_add_u32 v26, s53, v26
  v_add_u32 v26, v26, v4
  v_add_u32 v27, s52, v4
  s_lshr_b32 s6, s49, 1
  s_xor_b32 s6, s6, s49
  s_and_b32 s6, s6, 1
  s_cmp_eq_u32 s6, 0
  s_cselect_b64 vcc, -1, 0
  v_cndmask_b32 v24, v26, v27, vcc
  v_cndmask_b32 v25, v27, v26, vcc
  v_add_u32 v24, 1792, v24
  s_lshl_b32 s6, s2, 2
  s_add_u32 s6, s6, s3
  s_mul_i32 s7, s6, 896
  s_lshl_b32 s6, s6, 13
  v_lshlrev_b32 v249, 7, v0
  s_mov_b32 exec_lo, 0x3ffff
  s_mov_b32 exec_hi, 0x3ffff
  buffer_load_dword v250, v249, s[24:27], s6 offen
  s_mov_b64 exec, 0x7f
  buffer_load_dword v250, v249, s[28:31], s7 offen
  s_mov_b64 exec, -1
  s_barrier
  s_barrier
  s_barrier
  s_mov_b64 exec, 15
  global_load_dword v250, v247, s[88:89]
  s_mov_b64 exec, -1
  s_add_u32 s6, s50, 0
  buffer_load_dwordx4 v[28:31], v24, s[20:23], s6 offen
  buffer_load_dwordx4 v[32:35], v25, s[20:23], s6 offen
  s_add_u32 s6, s50, 114688
  buffer_load_dwordx4 v[36:39], v24, s[20:23], s6 offen
  buffer_load_dwordx4 v[40:43], v25, s[20:23], s6 offen
  s_add_u32 s6, s50, 229376
  buffer_load_dwordx4 v[44:47], v24, s[20:23], s6 offen
  buffer_load_dwordx4 v[48:51], v25, s[20:23], s6 offen
  s_add_u32 s6, s50, 344064
  buffer_load_dwordx4 v[52:55], v24, s[20:23], s6 offen
  buffer_load_dwordx4 v[56:59], v25, s[20:23], s6 offen
  s_add_u32 s6, s50, 458752
  buffer_load_dwordx4 v[60:63], v24, s[20:23], s6 offen
  buffer_load_dwordx4 v[64:67], v25, s[20:23], s6 offen
  s_add_u32 s6, s50, 573440
  buffer_load_dwordx4 v[68:71], v24, s[20:23], s6 offen
  buffer_load_dwordx4 v[72:75], v25, s[20:23], s6 offen
  s_add_u32 s6, s50, 688128
  buffer_load_dwordx4 v[76:79], v24, s[20:23], s6 offen
  buffer_load_dwordx4 v[80:83], v25, s[20:23], s6 offen
  s_add_u32 s6, s50, 802816
  buffer_load_dwordx4 v[84:87], v24, s[20:23], s6 offen
  buffer_load_dwordx4 v[88:91], v25, s[20:23], s6 offen
  s_add_u32 s6, s50, 917504
  buffer_load_dwordx4 v[92:95], v24, s[20:23], s6 offen
  buffer_load_dwordx4 v[96:99], v25, s[20:23], s6 offen
  s_barrier
  s_add_u32 s6, s50, 1032192
  buffer_load_dwordx4 v[100:103], v24, s[20:23], s6 offen
  buffer_load_dwordx4 v[104:107], v25, s[20:23], s6 offen
  s_add_u32 s6, s50, 1146880
  buffer_load_dwordx4 v[108:111], v24, s[20:23], s6 offen
  buffer_load_dwordx4 v[112:115], v25, s[20:23], s6 offen
  s_add_u32 s6, s50, 1261568
  buffer_load_dwordx4 v[116:119], v24, s[20:23], s6 offen
  buffer_load_dwordx4 v[120:123], v25, s[20:23], s6 offen
  s_add_u32 s6, s50, 1376256
  buffer_load_dwordx4 v[124:127], v24, s[20:23], s6 offen
  buffer_load_dwordx4 v[128:131], v25, s[20:23], s6 offen
  s_add_u32 s6, s50, 1490944
  buffer_load_dwordx4 v[132:135], v24, s[20:23], s6 offen
  buffer_load_dwordx4 v[136:139], v25, s[20:23], s6 offen
  s_add_u32 s6, s50, 1605632
  buffer_load_dwordx4 v[140:143], v24, s[20:23], s6 offen
  buffer_load_dwordx4 v[144:147], v25, s[20:23], s6 offen
  s_add_u32 s6, s50, 1720320
  buffer_load_dwordx4 v[148:151], v24, s[20:23], s6 offen
  buffer_load_dwordx4 v[152:155], v25, s[20:23], s6 offen
  s_barrier
  s_lshl_b32 s6, s3, 10
  v_add_u32 v4, s6, v1
  v_add_u32 v5, 0x10000, v4
  s_waitcnt vmcnt(30)
  ds_write_b128 v4, v[28:31] offset:0
  ds_write_b128 v5, v[32:35] offset:0
  s_waitcnt vmcnt(28)
  ds_write_b128 v4, v[36:39] offset:4096
  ds_write_b128 v5, v[40:43] offset:4096
  s_waitcnt vmcnt(26)
  ds_write_b128 v4, v[44:47] offset:8192
  ds_write_b128 v5, v[48:51] offset:8192
  s_waitcnt vmcnt(24)
  ds_write_b128 v4, v[52:55] offset:12288
  ds_write_b128 v5, v[56:59] offset:12288
  s_waitcnt vmcnt(22)
  ds_write_b128 v4, v[60:63] offset:16384
  ds_write_b128 v5, v[64:67] offset:16384
  s_waitcnt vmcnt(20)
  ds_write_b128 v4, v[68:71] offset:20480
  ds_write_b128 v5, v[72:75] offset:20480
  s_waitcnt vmcnt(18)
  ds_write_b128 v4, v[76:79] offset:24576
  ds_write_b128 v5, v[80:83] offset:24576
  s_waitcnt vmcnt(16)
  ds_write_b128 v4, v[84:87] offset:28672
  ds_write_b128 v5, v[88:91] offset:28672
  s_waitcnt vmcnt(14)
  ds_write_b128 v4, v[92:95] offset:32768
  ds_write_b128 v5, v[96:99] offset:32768
  s_waitcnt vmcnt(12)
  ds_write_b128 v4, v[100:103] offset:36864
  ds_write_b128 v5, v[104:107] offset:36864
  s_waitcnt vmcnt(10)
  ds_write_b128 v4, v[108:111] offset:40960
  ds_write_b128 v5, v[112:115] offset:40960
  s_waitcnt vmcnt(8)
  ds_write_b128 v4, v[116:119] offset:45056
  ds_write_b128 v5, v[120:123] offset:45056
  s_waitcnt vmcnt(6)
  ds_write_b128 v4, v[124:127] offset:49152
  ds_write_b128 v5, v[128:131] offset:49152
  s_waitcnt vmcnt(4)
  ds_write_b128 v4, v[132:135] offset:53248
  ds_write_b128 v5, v[136:139] offset:53248
  s_waitcnt vmcnt(2)
  ds_write_b128 v4, v[140:143] offset:57344
  ds_write_b128 v5, v[144:147] offset:57344
  s_waitcnt vmcnt(0)
  ds_write_b128 v4, v[148:151] offset:61440
  ds_write_b128 v5, v[152:155] offset:61440
  v_bfe_u32 v4, v0, 3, 2
  v_xor_b32 v4, s3, v4
  v_lshlrev_b32 v8, 5, v4
  v_and_b32 v4, 3, v0
  v_lshl_add_u32 v8, v4, 3, v8
  v_lshrrev_b32 v4, 2, v0
  v_lshl_add_u32 v8, v4, 7, v8
  v_add_u32 v9, 0x10000, v8
  s_lshl_b32 s6, s3, 6
  s_add_u32 s6, s6, 150528
  v_lshlrev_b32 v12, 2, v3
  v_add_u32 v12, s6, v12
  v_mov_b32 v16, 0x3f803f80
  v_mov_b32 v17, 0x3f803f80
  v_mov_b32 v18, 0x3f803f80
  v_mov_b32 v19, 0x3f803f80
  s_lshl_b32 s58, s48, 2
  s_add_u32 s58, s58, s3
  s_lshl_b32 s58, s58, 8
  s_add_u32 s58, s58, 0xb10000
  v_and_b32 v14, 31, v0
  v_lshlrev_b32 v15, 3, v14
  s_lshl_b32 s7, s3, 7
  s_add_u32 s7, s7, 148480
  v_lshl_add_u32 v14, v14, 2, s7
  s_waitcnt lgkmcnt(0)
  s_barrier
  ds_read_b64_tr_b16 v[160:161], v8 offset:0
  ds_read_b64_tr_b16 v[162:163], v8 offset:2048
  ds_read_b64_tr_b16 v[164:165], v9 offset:0
  ds_read_b64_tr_b16 v[166:167], v9 offset:2048
  ds_read_b64_tr_b16 v[168:169], v8 offset:4096
  ds_read_b64_tr_b16 v[170:171], v8 offset:6144
  ds_read_b64_tr_b16 v[172:173], v9 offset:4096
  ds_read_b64_tr_b16 v[174:175], v9 offset:6144
  ds_read_b64_tr_b16 v[176:177], v8 offset:8192
  ds_read_b64_tr_b16 v[178:179], v8 offset:10240
  ds_read_b64_tr_b16 v[180:181], v9 offset:8192
  ds_read_b64_tr_b16 v[182:183], v9 offset:10240
  ds_read_b64_tr_b16 v[184:185], v8 offset:12288
  ds_read_b64_tr_b16 v[186:187], v8 offset:14336
  ds_read_b64_tr_b16 v[188:189], v9 offset:12288
  ds_read_b64_tr_b16 v[190:191], v9 offset:14336
  s_waitcnt lgkmcnt(12)
  v_mfma_f32_16x16x32_bf16 v[20:23], v[16:19], v[160:163], 0
  v_mfma_f32_16x16x32_bf16 v[24:27], v[16:19], v[164:167], 0
  ds_read_b64_tr_b16 v[160:161], v8 offset:16384
  ds_read_b64_tr_b16 v[162:163], v8 offset:18432
  ds_read_b64_tr_b16 v[164:165], v9 offset:16384
  ds_read_b64_tr_b16 v[166:167], v9 offset:18432
  s_waitcnt lgkmcnt(12)
  v_mfma_f32_16x16x32_bf16 v[20:23], v[16:19], v[168:171], v[20:23]
  v_mfma_f32_16x16x32_bf16 v[24:27], v[16:19], v[172:175], v[24:27]
  ds_read_b64_tr_b16 v[168:169], v8 offset:20480
  ds_read_b64_tr_b16 v[170:171], v8 offset:22528
  ds_read_b64_tr_b16 v[172:173], v9 offset:20480
  ds_read_b64_tr_b16 v[174:175], v9 offset:22528
  s_waitcnt lgkmcnt(12)
  v_mfma_f32_16x16x32_bf16 v[20:23], v[16:19], v[176:179], v[20:23]
  v_mfma_f32_16x16x32_bf16 v[24:27], v[16:19], v[180:183], v[24:27]
  ds_read_b64_tr_b16 v[176:177], v8 offset:24576
  ds_read_b64_tr_b16 v[178:179], v8 offset:26624
  ds_read_b64_tr_b16 v[180:181], v9 offset:24576
  ds_read_b64_tr_b16 v[182:183], v9 offset:26624
  s_waitcnt lgkmcnt(12)
  v_mfma_f32_16x16x32_bf16 v[20:23], v[16:19], v[184:187], v[20:23]
  v_mfma_f32_16x16x32_bf16 v[24:27], v[16:19], v[188:191], v[24:27]
  ds_read_b64_tr_b16 v[184:185], v8 offset:28672
  ds_read_b64_tr_b16 v[186:187], v8 offset:30720
  ds_read_b64_tr_b16 v[188:189], v9 offset:28672
  ds_read_b64_tr_b16 v[190:191], v9 offset:30720
  s_waitcnt lgkmcnt(12)
  v_mfma_f32_16x16x32_bf16 v[20:23], v[16:19], v[160:163], v[20:23]
  v_mfma_f32_16x16x32_bf16 v[24:27], v[16:19], v[164:167], v[24:27]
  ds_read_b64_tr_b16 v[160:161], v8 offset:32768
  ds_read_b64_tr_b16 v[162:163], v8 offset:34816
  ds_read_b64_tr_b16 v[164:165], v9 offset:32768
  ds_read_b64_tr_b16 v[166:167], v9 offset:34816
  s_waitcnt lgkmcnt(12)
  v_mfma_f32_16x16x32_bf16 v[20:23], v[16:19], v[168:171], v[20:23]
  v_mfma_f32_16x16x32_bf16 v[24:27], v[16:19], v[172:175], v[24:27]
  ds_read_b64_tr_b16 v[168:169], v8 offset:36864
  ds_read_b64_tr_b16 v[170:171], v8 offset:38912
  ds_read_b64_tr_b16 v[172:173], v9 offset:36864
  ds_read_b64_tr_b16 v[174:175], v9 offset:38912
  s_waitcnt lgkmcnt(12)
  v_mfma_f32_16x16x32_bf16 v[20:23], v[16:19], v[176:179], v[20:23]
  v_mfma_f32_16x16x32_bf16 v[24:27], v[16:19], v[180:183], v[24:27]
  ds_read_b64_tr_b16 v[176:177], v8 offset:40960
  ds_read_b64_tr_b16 v[178:179], v8 offset:43008
  ds_read_b64_tr_b16 v[180:181], v9 offset:40960
  ds_read_b64_tr_b16 v[182:183], v9 offset:43008
  s_waitcnt lgkmcnt(12)
  v_mfma_f32_16x16x32_bf16 v[20:23], v[16:19], v[184:187], v[20:23]
  v_mfma_f32_16x16x32_bf16 v[24:27], v[16:19], v[188:191], v[24:27]
  ds_read_b64_tr_b16 v[184:185], v8 offset:45056
  ds_read_b64_tr_b16 v[186:187], v8 offset:47104
  ds_read_b64_tr_b16 v[188:189], v9 offset:45056
  ds_read_b64_tr_b16 v[190:191], v9 offset:47104
  s_waitcnt lgkmcnt(12)
  v_mfma_f32_16x16x32_bf16 v[20:23], v[16:19], v[160:163], v[20:23]
  v_mfma_f32_16x16x32_bf16 v[24:27], v[16:19], v[164:167], v[24:27]
  ds_read_b64_tr_b16 v[160:161], v8 offset:49152
  ds_read_b64_tr_b16 v[162:163], v8 offset:51200
  ds_read_b64_tr_b16 v[164:165], v9 offset:49152
  ds_read_b64_tr_b16 v[166:167], v9 offset:51200
  s_waitcnt lgkmcnt(12)
  v_mfma_f32_16x16x32_bf16 v[20:23], v[16:19], v[168:171], v[20:23]
  v_mfma_f32_16x16x32_bf16 v[24:27], v[16:19], v[172:175], v[24:27]
  ds_read_b64_tr_b16 v[168:169], v8 offset:53248
  ds_read_b64_tr_b16 v[170:171], v8 offset:55296
  ds_read_b64_tr_b16 v[172:173], v9 offset:53248
  ds_read_b64_tr_b16 v[174:175], v9 offset:55296
  s_waitcnt lgkmcnt(12)
  v_mfma_f32_16x16x32_bf16 v[20:23], v[16:19], v[176:179], v[20:23]
  v_mfma_f32_16x16x32_bf16 v[24:27], v[16:19], v[180:183], v[24:27]
  ds_read_b64_tr_b16 v[176:177], v8 offset:57344
  ds_read_b64_tr_b16 v[178:179], v8 offset:59392
  ds_read_b64_tr_b16 v[180:181], v9 offset:57344
  ds_read_b64_tr_b16 v[182:183], v9 offset:59392
  s_waitcnt lgkmcnt(12)
  v_mfma_f32_16x16x32_bf16 v[20:23], v[16:19], v[184:187], v[20:23]
  v_mfma_f32_16x16x32_bf16 v[24:27], v[16:19], v[188:191], v[24:27]
  ds_read_b64_tr_b16 v[184:185], v8 offset:61440
  ds_read_b64_tr_b16 v[186:187], v8 offset:63488
  ds_read_b64_tr_b16 v[188:189], v9 offset:61440
  ds_read_b64_tr_b16 v[190:191], v9 offset:63488
  s_waitcnt lgkmcnt(12)
  v_mfma_f32_16x16x32_bf16 v[20:23], v[16:19], v[160:163], v[20:23]
  v_mfma_f32_16x16x32_bf16 v[24:27], v[16:19], v[164:167], v[24:27]
  s_waitcnt lgkmcnt(8)
  v_mfma_f32_16x16x32_bf16 v[20:23], v[16:19], v[168:171], v[20:23]
  v_mfma_f32_16x16x32_bf16 v[24:27], v[16:19], v[172:175], v[24:27]
  s_waitcnt lgkmcnt(4)
  v_mfma_f32_16x16x32_bf16 v[20:23], v[16:19], v[176:179], v[20:23]
  v_mfma_f32_16x16x32_bf16 v[24:27], v[16:19], v[180:183], v[24:27]
  s_waitcnt lgkmcnt(0)
  v_mfma_f32_16x16x32_bf16 v[20:23], v[16:19], v[184:187], v[20:23]
  v_mfma_f32_16x16x32_bf16 v[24:27], v[16:19], v[188:191], v[24:27]
  s_nop 6
  ds_write_b32 v12, v20
  ds_write_b32 v12, v24 offset:256
  s_barrier
  buffer_load_dwordx2 v[10:11], v15, s[36:39], s58 offen sc1
  s_waitcnt vmcnt(0)
  v_mul_f32 v13, 0xbb000000, v10
  v_mul_f32 v11, 0x3b000000, v11
  v_fma_f32 v11, -v13, v13, v11
  v_max_f32 v11, 0, v11
  v_add_f32 v11, 0x3727c5ac, v11
  v_rsq_f32 v10, v11
  s_nop 0
  v_mul_f32 v11, v11, v10
  v_mul_f32 v12, v10, v10
  v_mul_f32 v10, 0xc0135761, v10
  v_mul_f32 v12, 0x3d372713, v12
  v_mul_f32 v12, v12, v10
  ds_write_b32 v14, v10
  ds_write_b32 v14, v12 offset:512
  ds_write_b32 v14, v11 offset:1024
  ds_write_b32 v14, v13 offset:1536
  s_waitcnt lgkmcnt(0)
  s_lshl_b32 s86, s48, 7
  s_add_u32 s86, s86, 0xb1b000
  s_lshl_b32 s87, s48, 4
  s_add_u32 s87, s87, s49
  s_lshl_b32 s87, s87, 7
  s_add_u32 s87, s87, 0xb2c000
  s_barrier
  s_lshr_b32 s48, s4, 1
  s_lshl_b32 s48, s48, 3
  s_and_b32 s6, s5, 7
  s_add_u32 s48, s48, s6
  s_and_b32 s49, s4, 1
  s_lshl_b32 s49, s49, 2
  s_lshr_b32 s6, s5, 3
  s_add_u32 s49, s49, s6
  s_lshl_b32 s50, s48, 2
  s_add_u32 s50, s50, s3
  s_lshl_b32 s50, s50, 16
  s_add_u32 s52, s50, 2304
  s_lshl_b32 s51, s3, 12
  v_add_u32 v4, 0, v2
  v_xor_b32 v5, v4, v3
  v_lshlrev_b32 v5, 4, v5
  v_lshl_add_u32 v8, v4, 12, v5
  v_add_u32 v4, 4, v2
  v_xor_b32 v5, v4, v3
  v_lshlrev_b32 v5, 4, v5
  v_lshl_add_u32 v9, v4, 12, v5
  v_add_u32 v4, 8, v2
  v_xor_b32 v5, v4, v3
  v_lshlrev_b32 v5, 4, v5
  v_lshl_add_u32 v10, v4, 12, v5
  v_add_u32 v4, 12, v2
  v_xor_b32 v5, v4, v3
  v_lshlrev_b32 v5, 4, v5
  v_lshl_add_u32 v11, v4, 12, v5
  v_and_b32 v4, 7, v0
  v_lshlrev_b32 v5, 1, v2
  v_xor_b32 v4, v4, v5
  v_lshrrev_b32 v16, 3, v0
  v_lshlrev_b32 v16, 10, v16
  v_lshl_add_u32 v16, v4, 4, v16
  s_lshl_b32 s56, s3, 13
  s_lshr_b32 s6, s5, 2
  s_lshl_b32 s6, s6, 7
  s_add_u32 s56, s56, s6
  s_lshl_b32 s6, s3, 10
  v_add_u32 v17, s6, v1
  v_add_u32 v18, 57344, v17
  s_add_u32 s6, s56, 0
  buffer_load_dwordx4 v[28:31], v16, s[28:31], s6 offen
  s_add_u32 s6, s56, 32768
  buffer_load_dwordx4 v[32:35], v16, s[28:31], s6 offen
  s_add_u32 s6, s56, 65536
  buffer_load_dwordx4 v[36:39], v16, s[28:31], s6 offen
  s_add_u32 s6, s56, 98304
  buffer_load_dwordx4 v[40:43], v16, s[28:31], s6 offen
  s_add_u32 s6, s56, 131072
  buffer_load_dwordx4 v[44:47], v16, s[28:31], s6 offen
  s_add_u32 s6, s56, 163840
  buffer_load_dwordx4 v[48:51], v16, s[28:31], s6 offen
  s_barrier
  s_mov_b64 exec, 15
  global_load_dword v250, v247, s[88:89]
  s_mov_b64 exec, -1
  s_lshl_b32 s6, s2, 2
  s_add_u32 s6, s6, s3
  s_mul_i32 s7, s6, 896
  s_lshl_b32 s6, s6, 13
  v_lshlrev_b32 v249, 7, v0
  s_mov_b32 exec_lo, 0xfffc0000
  s_mov_b32 exec_hi, 0xfffc0000
  buffer_load_dword v250, v249, s[24:27], s6 offen
  s_mov_b64 exec, -1
  s_add_u32 m0, s51, 0
  s_nop 0
  buffer_load_dwordx4 v8, s[24:27], s50 offen offset:0  lds
  s_add_u32 m0, s51, 1024
  s_nop 0
  buffer_load_dwordx4 v9, s[24:27], s50 offen offset:0  lds
  s_add_u32 m0, s51, 2048
  s_nop 0
  buffer_load_dwordx4 v10, s[24:27], s50 offen offset:0  lds
  s_add_u32 m0, s51, 3072
  s_nop 0
  buffer_load_dwordx4 v11, s[24:27], s50 offen offset:0  lds
  s_add_u32 m0, s51, 16128
  s_nop 0
  buffer_load_dwordx4 v8, s[24:27], s50 offen offset:256  lds
  s_add_u32 m0, s51, 17152
  s_nop 0
  buffer_load_dwordx4 v9, s[24:27], s50 offen offset:256  lds
  s_add_u32 m0, s51, 18176
  s_nop 0
  buffer_load_dwordx4 v10, s[24:27], s50 offen offset:256  lds
  s_add_u32 m0, s51, 19200
  s_nop 0
  buffer_load_dwordx4 v11, s[24:27], s50 offen offset:256  lds
  s_add_u32 m0, s51, 32256
  s_nop 0
  buffer_load_dwordx4 v8, s[24:27], s50 offen offset:512  lds
  s_add_u32 m0, s51, 33280
  s_nop 0
  buffer_load_dwordx4 v9, s[24:27], s50 offen offset:512  lds
  s_add_u32 m0, s51, 34304
  s_nop 0
  buffer_load_dwordx4 v10, s[24:27], s50 offen offset:512  lds
  s_add_u32 m0, s51, 35328
  s_nop 0
  buffer_load_dwordx4 v11, s[24:27], s50 offen offset:512  lds
  s_add_u32 m0, s51, 48384
  s_nop 0
  buffer_load_dwordx4 v8, s[24:27], s50 offen offset:768  lds
  s_add_u32 m0, s51, 49408
  s_nop 0
  buffer_load_dwordx4 v9, s[24:27], s50 offen offset:768  lds
  s_add_u32 m0, s51, 50432
  s_nop 0
  buffer_load_dwordx4 v10, s[24:27], s50 offen offset:768  lds
  s_add_u32 m0, s51, 51456
  s_nop 0
  buffer_load_dwordx4 v11, s[24:27], s50 offen offset:768  lds
  s_add_u32 m0, s51, 130048
  s_nop 0
  buffer_load_dwordx4 v8, s[24:27], s50 offen offset:1024  lds
  s_add_u32 m0, s51, 131072
  s_nop 0
  buffer_load_dwordx4 v9, s[24:27], s50 offen offset:1024  lds
  s_add_u32 m0, s51, 132096
  s_nop 0
  buffer_load_dwordx4 v10, s[24:27], s50 offen offset:1024  lds
  s_add_u32 m0, s51, 133120
  s_nop 0
  buffer_load_dwordx4 v11, s[24:27], s50 offen offset:1024  lds
  s_add_u32 s6, s56, 196608
  buffer_load_dwordx4 v[52:55], v16, s[28:31], s6 offen
  s_add_u32 s6, s56, 229376
  buffer_load_dwordx4 v[56:59], v16, s[28:31], s6 offen
  s_add_u32 s6, s56, 262144
  buffer_load_dwordx4 v[60:63], v16, s[28:31], s6 offen
  s_add_u32 s6, s56, 294912
  buffer_load_dwordx4 v[64:67], v16, s[28:31], s6 offen
  s_add_u32 s6, s56, 327680
  buffer_load_dwordx4 v[68:71], v16, s[28:31], s6 offen
  s_add_u32 s6, s56, 360448
  buffer_load_dwordx4 v[72:75], v16, s[28:31], s6 offen
  s_add_u32 s6, s56, 393216
  buffer_load_dwordx4 v[76:79], v16, s[28:31], s6 offen
  s_add_u32 s6, s56, 425984
  buffer_load_dwordx4 v[80:83], v16, s[28:31], s6 offen
  s_add_u32 s6, s56, 458752
  buffer_load_dwordx4 v[84:87], v16, s[28:31], s6 offen
  s_add_u32 s6, s56, 491520
  buffer_load_dwordx4 v[88:91], v16, s[28:31], s6 offen
  s_lshr_b32 s85, s48, 1
  s_lshl_b32 s85, s85, 3
  s_add_u32 s85, s85, s49
  s_lshl_b32 s85, s85, 8
  s_add_u32 s85, s85, 0xb2c000
  v_lshlrev_b32 v26, 7, v0
  s_barrier
  s_barrier
  s_add_u32 m0, s51, 64256
  s_nop 0
  buffer_load_dwordx4 v8, s[24:27], s50 offen offset:1280  lds
  s_add_u32 m0, s51, 65280
  s_nop 0
  buffer_load_dwordx4 v9, s[24:27], s50 offen offset:1280  lds
  s_add_u32 m0, s51, 66304
  s_nop 0
  buffer_load_dwordx4 v10, s[24:27], s50 offen offset:1280  lds
  s_add_u32 m0, s51, 67328
  s_nop 0
  buffer_load_dwordx4 v11, s[24:27], s50 offen offset:1280  lds
  s_add_u32 m0, s51, 80384
  s_nop 0
  buffer_load_dwordx4 v8, s[24:27], s50 offen offset:1536  lds
  s_add_u32 m0, s51, 81408
  s_nop 0
  buffer_load_dwordx4 v9, s[24:27], s50 offen offset:1536  lds
  s_add_u32 m0, s51, 82432
  s_nop 0
  buffer_load_dwordx4 v10, s[24:27], s50 offen offset:1536  lds
  s_add_u32 m0, s51, 83456
  s_nop 0
  buffer_load_dwordx4 v11, s[24:27], s50 offen offset:1536  lds
  s_add_u32 m0, s51, 96512
  s_nop 0
  buffer_load_dwordx4 v8, s[24:27], s50 offen offset:1792  lds
  s_add_u32 m0, s51, 97536
  s_nop 0
  buffer_load_dwordx4 v9, s[24:27], s50 offen offset:1792  lds
  s_add_u32 m0, s51, 98560
  s_nop 0
  buffer_load_dwordx4 v10, s[24:27], s50 offen offset:1792  lds
  s_add_u32 m0, s51, 99584
  s_nop 0
  buffer_load_dwordx4 v11, s[24:27], s50 offen offset:1792  lds
  s_add_u32 m0, s51, 112640
  s_nop 0
  buffer_load_dwordx4 v8, s[24:27], s50 offen offset:2048  lds
  s_add_u32 m0, s51, 113664
  s_nop 0
  buffer_load_dwordx4 v9, s[24:27], s50 offen offset:2048  lds
  s_add_u32 m0, s51, 114688
  s_nop 0
  buffer_load_dwordx4 v10, s[24:27], s50 offen offset:2048  lds
  s_add_u32 m0, s51, 115712
  s_nop 0
  buffer_load_dwordx4 v11, s[24:27], s50 offen offset:2048  lds
  s_waitcnt vmcnt(42)
  s_barrier
  s_waitcnt vmcnt(38)
  s_barrier
  s_waitcnt vmcnt(34)
  s_barrier
  s_add_u32 m0, s51, 0
  s_nop 0
  buffer_load_dwordx4 v8, s[24:27], s52 offen offset:0  lds
  s_add_u32 m0, s51, 1024
  s_nop 0
  buffer_load_dwordx4 v9, s[24:27], s52 offen offset:0  lds
  s_add_u32 m0, s51, 2048
  s_nop 0
  buffer_load_dwordx4 v10, s[24:27], s52 offen offset:0  lds
  s_waitcnt vmcnt(33)
  s_barrier
  s_add_u32 m0, s51, 3072
  s_nop 0
  buffer_load_dwordx4 v11, s[24:27], s52 offen offset:0  lds
  s_add_u32 m0, s51, 16128
  s_nop 0
  buffer_load_dwordx4 v8, s[24:27], s52 offen offset:256  lds
  s_waitcnt vmcnt(31)
  s_barrier
  s_cmp_eq_u32 s3, 1
  s_cbranch_scc0 L_skip26
  v_mov_b32 v27, 1
  s_mov_b64 exec, 1
  buffer_store_dword v27, v248, s[36:39], s87 offen sc1
  s_mov_b64 exec, -1
L_skip26:
  s_add_u32 m0, s51, 17152
  s_nop 0
  buffer_load_dwordx4 v9, s[24:27], s52 offen offset:256  lds
  s_add_u32 m0, s51, 18176
  s_nop 0
  buffer_load_dwordx4 v10, s[24:27], s52 offen offset:256  lds
  s_waitcnt vmcnt(19)
  s_barrier
  s_add_u32 m0, s51, 19200
  s_nop 0
  buffer_load_dwordx4 v11, s[24:27], s52 offen offset:256  lds
  s_add_u32 m0, s51, 32256
  s_nop 0
  buffer_load_dwordx4 v8, s[24:27], s52 offen offset:512  lds
  s_add_u32 m0, s51, 33280
  s_nop 0
  buffer_load_dwordx4 v9, s[24:27], s52 offen offset:512  lds
  s_waitcnt vmcnt(18)
  s_barrier
  s_mov_b64 exec, 15
  global_load_dword v250, v247, s[88:89]
  s_mov_b64 exec, -1
  s_add_u32 m0, s51, 34304
  s_nop 0
  buffer_load_dwordx4 v10, s[24:27], s52 offen offset:512  lds
  s_add_u32 m0, s51, 35328
  s_nop 0
  buffer_load_dwordx4 v11, s[24:27], s52 offen offset:512  lds
  s_add_u32 s6, s56, 524288
  buffer_load_dwordx4 v[92:95], v16, s[28:31], s6 offen
  s_waitcnt vmcnt(18)
  s_barrier
  s_add_u32 m0, s51, 48384
  s_nop 0
  buffer_load_dwordx4 v8, s[24:27], s52 offen offset:768  lds
  s_add_u32 m0, s51, 49408
  s_nop 0
  buffer_load_dwordx4 v9, s[24:27], s52 offen offset:768  lds
  s_add_u32 s6, s56, 557056
  buffer_load_dwordx4 v[96:99], v16, s[28:31], s6 offen
  s_waitcnt vmcnt(17)
  s_barrier
  s_add_u32 m0, s51, 50432
  s_nop 0
  buffer_load_dwordx4 v10, s[24:27], s52 offen offset:768  lds
  s_add_u32 m0, s51, 51456
  s_nop 0
  buffer_load_dwordx4 v11, s[24:27], s52 offen offset:768  lds
  s_add_u32 m0, s51, 130048
  s_nop 0
  buffer_load_dwordx4 v8, s[24:27], s52 offen offset:1024  lds
  s_add_u32 s6, s56, 589824
  buffer_load_dwordx4 v[100:103], v16, s[28:31], s6 offen
  s_waitcnt vmcnt(17)
  s_barrier
  s_add_u32 m0, s51, 131072
  s_nop 0
  buffer_load_dwordx4 v9, s[24:27], s52 offen offset:1024  lds
  s_add_u32 m0, s51, 132096
  s_nop 0
  buffer_load_dwordx4 v10, s[24:27], s52 offen offset:1024  lds
  s_add_u32 s6, s56, 622592
  buffer_load_dwordx4 v[104:107], v16, s[28:31], s6 offen
  s_waitcnt vmcnt(16)
  s_barrier
  s_add_u32 m0, s51, 133120
  s_nop 0
  buffer_load_dwordx4 v11, s[24:27], s52 offen offset:1024  lds
  s_add_u32 m0, s51, 64256
  s_nop 0
  buffer_load_dwordx4 v8, s[24:27], s52 offen offset:1280  lds
  s_add_u32 s6, s56, 655360
  buffer_load_dwordx4 v[108:111], v16, s[28:31], s6 offen
  s_add_u32 s6, s56, 688128
  buffer_load_dwordx4 v[112:115], v16, s[28:31], s6 offen
  s_waitcnt vmcnt(15)
  s_mov_b64 exec, 3
  buffer_load_dword v19, v26, s[36:39], s85 offen sc1
  s_mov_b64 exec, -1
  s_barrier
  s_add_u32 m0, s51, 65280
  s_nop 0
  buffer_load_dwordx4 v9, s[24:27], s52 offen offset:1280  lds
  s_add_u32 m0, s51, 66304
  s_nop 0
  buffer_load_dwordx4 v10, s[24:27], s52 offen offset:1280  lds
  s_add_u32 m0, s51, 67328
  s_nop 0
  buffer_load_dwordx4 v11, s[24:27], s52 offen offset:1280  lds
  s_add_u32 s6, s56, 720896
  buffer_load_dwordx4 v[116:119], v16, s[28:31], s6 offen
  s_waitcnt vmcnt(14)
  s_barrier
  s_mov_b64 exec, 15
  global_load_dword v250, v247, s[88:89]
  s_mov_b64 exec, -1
  s_add_u32 m0, s51, 80384
  s_nop 0
  buffer_load_dwordx4 v8, s[24:27], s52 offen offset:1536  lds
  s_add_u32 m0, s51, 81408
  s_nop 0
  buffer_load_dwordx4 v9, s[24:27], s52 offen offset:1536  lds
  s_add_u32 s6, s56, 753664
  buffer_load_dwordx4 v[120:123], v16, s[28:31], s6 offen
  s_waitcnt vmcnt(12)
  s_waitcnt vmcnt(8)
  v_readlane_b32 s84, v19, 0
  v_readlane_b32 s83, v19, 1
  s_nop 0
  s_min_u32 s84, s84, s83
  s_cmp_eq_u32 s84, 0
  s_cbranch_scc0 L_skip27
  s_mov_b64 exec, 3
  s_mov_b32 s6, 131072
L_pz1:
  buffer_load_dword v27, v26, s[36:39], s85 offen sc1
  s_sub_u32 s6, s6, 1
  s_cbranch_scc1 L_pz1x
  s_waitcnt vmcnt(0)
  v_cmp_eq_u32 vcc, 0, v27
  s_nop 4
  s_cbranch_vccnz L_pz1
L_pz1x:
  s_mov_b64 exec, -1
L_skip27:
  s_barrier
  s_add_u32 m0, s51, 82432
  s_nop 0
  buffer_load_dwordx4 v10, s[24:27], s52 offen offset:1536  lds
  s_add_u32 m0, s51, 83456
  s_nop 0
  buffer_load_dwordx4 v11, s[24:27], s52 offen offset:1536  lds
  s_add_u32 s6, s56, 786432
  buffer_load_dwordx4 v[124:127], v16, s[28:31], s6 offen
  s_waitcnt vmcnt(8)
  s_barrier
  s_add_u32 s6, s56, 819200
  buffer_load_dwordx4 v[128:131], v16, s[28:31], s6 offen
  s_waitcnt vmcnt(2)
  s_barrier
  s_add_u32 s6, s56, 851968
  buffer_load_dwordx4 v[132:135], v16, s[28:31], s6 offen
  s_add_u32 s6, s56, 884736
  buffer_load_dwordx4 v[136:139], v16, s[28:31], s6 offen
  s_barrier
  ds_write_b128 v17, v[28:31] offset:0
  ds_write_b128 v17, v[32:35] offset:4096
  ds_write_b128 v17, v[36:39] offset:8192
  ds_write_b128 v17, v[40:43] offset:12288
  ds_write_b128 v17, v[44:47] offset:16384
  ds_write_b128 v17, v[48:51] offset:20480
  ds_write_b128 v17, v[52:55] offset:24576
  ds_write_b128 v17, v[56:59] offset:28672
  ds_write_b128 v17, v[60:63] offset:32768
  ds_write_b128 v17, v[64:67] offset:36864
  ds_write_b128 v17, v[68:71] offset:40960
  ds_write_b128 v17, v[72:75] offset:45056
  ds_write_b128 v17, v[76:79] offset:49152
  ds_write_b128 v17, v[80:83] offset:53248
  ds_write_b128 v18, v[84:87] offset:0
  ds_write_b128 v18, v[88:91] offset:4096
  ds_write_b128 v18, v[92:95] offset:8192
  ds_write_b128 v18, v[96:99] offset:12288
  ds_write_b128 v18, v[100:103] offset:16384
  ds_write_b128 v18, v[104:107] offset:20480
  ds_write_b128 v18, v[108:111] offset:24576
  ds_write_b128 v18, v[112:115] offset:28672
  ds_write_b128 v18, v[116:119] offset:32768
  ds_write_b128 v18, v[120:123] offset:36864
  s_waitcnt vmcnt(0)
  ds_write_b128 v18, v[124:127] offset:40960
  ds_write_b128 v18, v[128:131] offset:45056
  ds_write_b128 v18, v[132:135] offset:49152
  ds_write_b128 v18, v[136:139] offset:53248
  s_barrier
  s_waitcnt lgkmcnt(0)
  s_barrier
L_end:
L_exit:
  s_endpgm
L_code_end:
.section .rodata,"a"
.p2align 6
.amdhsa_kernel sequential_preLN__linear_attn_block__mixer_gmlp__prompt_kernel
  .amdhsa_next_free_vgpr 256
  .amdhsa_next_free_sgpr 96
  .amdhsa_accum_offset 256
  .amdhsa_group_segment_fixed_size 0
  .amdhsa_kernarg_size 88
  .amdhsa_user_sgpr_count 2
  .amdhsa_user_sgpr_kernarg_segment_ptr 1
  .amdhsa_system_sgpr_workgroup_id_x 1
.end_amdhsa_kernel
```
